```python
import torch

def _softmax(x, axis=-1):
    return torch.softmax(x, dim=axis)

def _gelu(x):
    return torch.nn.functional.gelu(x, approximate='tanh')

def _silu(x):
    return torch.nn.functional.silu(x)

def _sigmoid(x):
    return torch.sigmoid(x)

def _layernorm(x, axis=-1, eps=1e-05):
    m = x.mean(dim=axis, keepdim=True)
    v = x.var(dim=axis, keepdim=True, unbiased=False)
    return (x - m) / torch.sqrt(v + eps)

def _scatter_add(tgt, idx, src, axis=0):
    return tgt.clone().index_add_(axis, idx, src)

def _segment_sum(src, seg, n):
    out = torch.zeros((n,) + src.shape[1:], dtype=src.dtype)
    return out.index_add_(0, seg, src)

def _pad(x, pw):
    flat = tuple((v for pair in reversed(pw) for v in pair))
    return torch.nn.functional.pad(x, flat)
kernel_name = 'parallel_sum__memory_aug_recurrent_mem_tr__dense_activation_mish__prompt'

def setup_inputs():

    _w = lambda a: (lambda t: t.to(torch.bfloat16) if t.is_floating_point() else t)(torch.as_tensor(a))

    def _A_setup():
        B, S, Dm = (1, 2048, 1024)
        H, Dh = (32, 128)
        M, seg = (8, 32)
        seg = min(seg, S)
        S = S // seg * seg
        return {'x': _w((lambda *s: torch.randn(*s, dtype=torch.bfloat16) * 0.05)(B, S, Dm)), 'mem0': _w((lambda *s: torch.randn(*s, dtype=torch.bfloat16) * 0.2)(B, M, Dm)), 'Wq': _w((lambda *s: torch.randn(*s, dtype=torch.bfloat16) * 1.6)(Dm, H, Dh) * Dm ** (-0.5)), 'Wk': _w((lambda *s: torch.randn(*s, dtype=torch.bfloat16) * 1.6)(Dm, H, Dh) * Dm ** (-0.5)), 'Wv': _w((lambda *s: torch.randn(*s, dtype=torch.bfloat16) * 0.2)(Dm, H, Dh) * Dm ** (-0.5)), 'Wo': _w((lambda *s: torch.randn(*s, dtype=torch.bfloat16) * 0.2)(H, Dh, Dm) * (H * Dh) ** (-0.5)), 'seg_len': seg}
    _A_in = _A_setup()

    def _B_setup():
        B, S, D, F = (1, 2048, 1024, 3584)
        return {'x': _w((lambda *s: torch.randn(*s, dtype=torch.bfloat16) * 0.05)(B, S, D)), 'w1': _w((lambda *s: torch.randn(*s, dtype=torch.bfloat16) * 0.4)(D, F) * D ** (-0.5)), 'b1': _w((lambda *s: torch.randn(*s, dtype=torch.bfloat16) * 0.1)(F)), 'w2': _w((lambda *s: torch.randn(*s, dtype=torch.bfloat16) * 0.1)(F, D) * F ** (-0.5))}
    _B_in = _B_setup()
    return {'A_x': _A_in['x'], 'A_mem0': _A_in['mem0'], 'A_Wq': _A_in['Wq'], 'A_Wk': _A_in['Wk'], 'A_Wv': _A_in['Wv'], 'A_Wo': _A_in['Wo'], 'A_seg_len': _A_in['seg_len'], 'B_x': _B_in['x'], 'B_w1': _B_in['w1'], 'B_b1': _B_in['b1'], 'B_w2': _B_in['w2']}

def reference(A_x, A_mem0, A_Wq, A_Wk, A_Wv, A_Wo, A_seg_len, B_x, B_w1, B_b1, B_w2):

    def _A_ref(x, mem0, Wq, Wk, Wv, Wo, seg_len):
        B, S, Dm = x.shape
        H, Dh = (Wq.shape[1], Wq.shape[2])
        M = mem0.shape[1]
        scale = Dh ** (-0.5)
        n_seg = S // seg_len
        L = M + seg_len
        idx = torch.arange(L)
        mask = (idx[:, None] < M) | (idx[:, None] >= idx[None, :])
        mem = mem0
        outs = []
        for s in range(n_seg):
            xs = x[:, s * seg_len:(s + 1) * seg_len, :].clone()
            h = torch.concatenate([mem, xs], axis=1)
            q = torch.einsum('btd,dhe->bhte', h, Wq)
            k = torch.einsum('btd,dhe->bhte', h, Wk)
            v = torch.einsum('btd,dhe->bhte', h, Wv)
            scores = torch.einsum('bhqe,bhke->bhqk', q, k) * scale
            scores = torch.where(mask[None, None], scores, -1000000000.0)
            p = _softmax(scores, axis=-1)
            o = torch.einsum('bhqk,bhke->bhqe', p, v)
            o = torch.einsum('bhte,hed->btd', o, Wo)
            mem = o[:, :M, :].clone()
            outs.append(o[:, M:, :])
        return torch.concatenate(outs, axis=1)

    def _B_ref(x, w1, b1, w2):
        h = torch.einsum('bsd,df->bsf', x, w1) + b1
        sp = torch.log1p(torch.exp(-torch.abs(h))) + torch.where(h > 0, h, torch.zeros_like(h))
        act = h * torch.tanh(sp)
        return torch.einsum('bsf,fd->bsd', act, w2)
    x = A_x
    xn = _layernorm(x, axis=-1)
    return x + _A_ref(xn, A_mem0, A_Wq, A_Wk, A_Wv, A_Wo, A_seg_len) + _B_ref(xn, B_w1, B_b1, B_w2)
```

```asm
; @launch grid=(256,1,1) block=(512,1,1) lds=131328
.amdgcn_target "amdgcn-amd-amdhsa--gfx950"
.text
.globl parallel_sum__memory_aug_recurrent_mem_tr__dense_activation_mish__prompt_kernel
.p2align 8
.type parallel_sum__memory_aug_recurrent_mem_tr__dense_activation_mish__prompt_kernel,@function
parallel_sum__memory_aug_recurrent_mem_tr__dense_activation_mish__prompt_kernel:
    s_cmp_ge_u32 s2, 256
    s_cbranch_scc0 mk_go
    s_endpgm
mk_go:
    s_getpc_b64 s[4:5]
mk_pc0:
    v_lshlrev_b32 v250, 7, v0
    v_min_u32 v250, (mk_codeend - mk_pc0 - 4), v250
    v_mov_b32 v253, s5
    v_add_co_u32 v252, vcc, s4, v250
    s_nop 1
    v_addc_co_u32 v253, vcc, 0, v253, vcc
    global_load_dword v251, v[252:253], off
    s_and_b32 s20, s2, 0x7e
    s_and_b32 s21, s2, 1
    s_bfe_u32 s22, s2, 0x10007
    s_lshl_b32 s21, s21, 7
    s_or_b32 s20, s20, s21
    s_or_b32 s2, s20, s22
    s_cmp_ge_u32 s2, 128
    s_cbranch_scc1 mk_worker
    s_and_b32 s30, s2, 7
    s_lshr_b32 s31, s2, 3
    s_setprio 3
    s_load_dwordx2 s[26:27], s[0:1], 104
    s_and_b32 s45, s31, 3
    s_lshr_b32 s46, s31, 2
    s_lshl_b32 s47, s30, 2
    s_add_u32 s46, s46, s47
    s_lshr_b32 s28, s45, 1
    s_lshl_b32 s28, s28, 3
    s_add_u32 s28, s28, 16
    s_load_dwordx2 s[28:29], s[0:1], s28
    s_load_dwordx2 s[60:61], s[0:1], 32
    s_load_dwordx2 s[40:41], s[0:1], 40
    s_load_dwordx2 s[48:49], s[0:1], 96
    s_load_dwordx2 s[62:63], s[0:1], 8
    v_and_b32 v1, 63, v0
    v_lshrrev_b32 v16, 6, v0
    s_nop 0
    v_readfirstlane_b32 s20, v16
    s_mov_b32 s35, 400000
    v_lshlrev_b32 v3, 4, v1
    s_lshl_b32 s22, s45, 10
    s_lshl_b32 s90, s46, 12
    s_add_u32 s90, s90, s22
    s_mul_i32 s36, s46, 6144
    s_add_u32 s36, s36, 131072
    s_add_u32 s91, s36, s22
    s_add_u32 s92, s91, 4096
    s_lshl_b32 s93, s46, 11
    s_add_u32 s93, s93, s22
    s_add_u32 s93, s93, 456704
    s_cmp_ge_u32 s45, 2
    s_cselect_b32 s92, s93, s92
    v_lshrrev_b32 v63, 4, v1
    v_lshlrev_b32 v63, 11, v63
    v_and_b32 v16, 15, v1
    v_lshl_add_u32 v63, v16, 4, v63
    s_lshl_b32 s25, s31, 13
    s_lshl_b32 s22, s30, 8
    s_add_u32 s25, s25, s22
    s_add_u32 s25, s25, 109051904
    s_and_b32 s23, s20, 3
    s_mul_i32 s23, s23, 524288
    s_add_u32 s23, s23, 88080384
    v_mov_b32 v20, -1
    v_mov_b32 v21, -1
    v_mov_b32 v22, -1
    v_mov_b32 v23, -1
    v_mov_b32 v24, -1
    v_mov_b32 v25, -1
    v_mov_b32 v26, -1
    v_mov_b32 v27, -1
    s_waitcnt lgkmcnt(0)
    s_mov_b32 s4, s26
    s_and_b32 s5, s27, 0xffff
    s_mov_b32 s6, 268435456
    s_mov_b32 s7, 0x00020000
    s_mov_b32 s8, s28
    s_and_b32 s9, s29, 0xffff
    s_mov_b32 s10, 8388608
    s_mov_b32 s11, 0x00020000
    s_mov_b32 s64, s60
    s_and_b32 s65, s61, 0xffff
    s_mov_b32 s66, 8388608
    s_mov_b32 s67, 0x00020000
    s_mov_b32 s12, s40
    s_and_b32 s13, s41, 0xffff
    s_mov_b32 s14, 8388608
    s_mov_b32 s15, 0x00020000
    s_mov_b32 s52, s48
    s_and_b32 s53, s49, 0xffff
    s_mov_b32 s54, 256
    s_mov_b32 s55, 0x00020000
    s_mov_b32 s68, s62
    s_and_b32 s69, s63, 0xffff
    s_mov_b32 s70, 16384
    s_mov_b32 s71, 0x00020000
    s_cmp_ge_u32 s20, 4
    s_cbranch_scc1 ch_i4
    s_cmp_lg_u32 s20, 0
    s_cbranch_scc1 ch_i1
    v_and_b32 v16, 7, v1
    v_lshlrev_b32 v16, 11, v16
    v_lshrrev_b32 v17, 3, v1
    v_lshl_add_u32 v16, v17, 4, v16
    s_lshl_b32 s22, s31, 7
    buffer_load_dwordx4 v[20:23], v16, s[68:71], s22 offen
    s_waitcnt vmcnt(0)
    v_min_u32 v20, -2, v20
    v_min_u32 v21, -2, v21
    v_min_u32 v22, -2, v22
    v_min_u32 v23, -2, v23
ch_i1:
    s_add_u32 s22, s23, s90
    buffer_store_dwordx4 v[20:23], v3, s[4:7], s22 offen sc1
    s_add_u32 s22, s23, s91
    buffer_store_dwordx4 v[24:27], v3, s[4:7], s22 offen sc1
    s_branch ch_i8
ch_i4:
    s_add_u32 s22, s23, s92
    buffer_store_dwordx4 v[24:27], v3, s[4:7], s22 offen sc1
    s_cmp_ge_u32 s20, 6
    s_cbranch_scc1 ch_i6
    s_and_b32 s22, s20, 1
    s_lshl_b32 s22, s22, 17
    s_add_u32 s22, s22, s25
    buffer_store_dwordx4 v[24:27], v63, s[4:7], s22 offen sc1
    s_branch ch_i8
ch_i6:
    s_and_b32 s21, s45, 1
    s_lshl_b32 s21, s21, 10
    s_add_u32 s21, s21, s36
    s_add_u32 s21, s21, 4096
    s_cmp_eq_u32 s20, 6
    s_cselect_b32 s22, s91, s21
    s_add_u32 s22, s22, 104529920
    buffer_store_dwordx4 v[24:27], v3, s[4:7], s22 offen sc1
    s_sub_u32 s22, s22, 0x30000
    buffer_store_dwordx4 v[24:27], v3, s[4:7], s22 offen sc1
    s_sub_u32 s22, s22, 0x30000
    buffer_store_dwordx4 v[24:27], v3, s[4:7], s22 offen sc1
    s_sub_u32 s22, s22, 0x30000
    buffer_store_dwordx4 v[24:27], v3, s[4:7], s22 offen sc1
    s_sub_u32 s22, s22, 0x30000
    buffer_store_dwordx4 v[24:27], v3, s[4:7], s22 offen sc1
    s_cmp_lg_u32 s20, 6
    s_cbranch_scc1 ch_i8
    v_mov_b32 v20, 0
    v_mov_b32 v21, 0
    v_mov_b32 v22, 0
    v_mov_b32 v23, 0
    s_add_u32 s22, s90, 167772160
    buffer_store_dwordx4 v[20:23], v3, s[4:7], s22 offen sc1
ch_i8:
    v_lshrrev_b32 v16, 3, v1
    v_and_b32 v18, 7, v1
    v_lshlrev_b32 v17, 4, v18
    v_lshl_add_u32 v28, v16, 13, v17
    s_lshl_b32 s21, s20, 20
    s_lshl_b32 s22, s46, 8
    s_add_u32 s22, s21, s22
    s_and_b32 s24, s45, 1
    s_lshl_b32 s24, s24, 7
    s_add_u32 s21, s22, s24
    v_add_u32 v28, s21, v28
    v_lshrrev_b32 v19, 2, v1
    v_and_b32 v17, 3, v1
    v_lshlrev_b32 v17, 4, v17
    v_lshl_add_u32 v29, v19, 13, v17
    s_lshl_b32 s24, s45, 6
    s_add_u32 s21, s22, s24
    v_add_u32 v29, s21, v29
    v_and_b32 v17, 6, v16
    v_xor_b32 v18, v18, v17
    v_lshlrev_b32 v18, 4, v18
    v_lshl_add_u32 v30, v16, 11, v18
    s_lshl_b32 s21, s20, 14
    s_lshl_b32 s22, s30, 20
    s_add_u32 s21, s21, s22
    s_lshl_b32 s22, s31, 7
    s_add_u32 s21, s21, s22
    v_add_u32 v30, s21, v30
    s_lshl_b32 s24, s20, 10
    s_waitcnt vmcnt(0)
    s_barrier
    v_min_u32 v54, 1, v1
    v_lshlrev_b32 v54, 30, v54
    s_cmp_lg_u32 s20, 0
    s_cbranch_scc1 ch_ann
    s_getreg_b32 s21, hwreg(HW_REG_XCC_ID)
    s_and_b32 s21, s21, 15
    s_mul_i32 s22, s21, s21
    s_lshl_b32 s22, s22, 16
    s_lshl_b32 s21, s21, 8
    s_add_u32 s21, s21, s22
    s_add_u32 s21, s21, 1
    v_mov_b32 v31, s21
    s_lshl_b32 s50, s30, 2
    buffer_atomic_add v31, v54, s[52:55], s50 offen sc1
ch_ann:
    s_load_dwordx4 s[68:71], s[0:1], 16
    v_lshrrev_b32 v16, 3, v1
    v_and_b32 v17, 7, v1
    v_lshlrev_b32 v17, 4, v17
    v_lshl_add_u32 v17, v16, 13, v17
    s_lshl_b32 s21, s31, 19
    s_lshl_b32 s22, s20, 16
    s_add_u32 s21, s21, s22
    s_lshl_b32 s22, s30, 10
    s_add_u32 s21, s21, s22
    s_add_u32 s21, s21, 384
    buffer_load_dwordx4 v[148:151], v17, s[64:67], s21 offen
    s_waitcnt lgkmcnt(0)
    s_mov_b32 s56, s70
    s_and_b32 s57, s71, 0xffff
    s_mov_b32 s58, 8388608
    s_mov_b32 s59, 0x00020000
    buffer_load_dwordx4 v[148:151], v17, s[56:59], s21 offen
    s_mov_b32 s56, s68
    s_and_b32 s57, s69, 0xffff
    s_mov_b32 s58, 8388608
    s_mov_b32 s59, 0x00020000
    buffer_load_dwordx4 v[148:151], v17, s[56:59], s21 offen
    s_cmp_lt_u32 s45, 2
    s_cbranch_scc1 ch_wl1
    s_mov_b32 s21, 0
    buffer_load_dwordx4 v[160:163], v28, s[8:11], s21 offen
    s_mov_b32 s21, 65536
    buffer_load_dwordx4 v[164:167], v28, s[8:11], s21 offen
    s_mov_b32 s21, 131072
    buffer_load_dwordx4 v[168:171], v28, s[8:11], s21 offen
    s_mov_b32 s21, 196608
    buffer_load_dwordx4 v[172:175], v28, s[8:11], s21 offen
    s_mov_b32 s21, 262144
    buffer_load_dwordx4 v[176:179], v28, s[8:11], s21 offen
    s_mov_b32 s21, 327680
    buffer_load_dwordx4 v[180:183], v28, s[8:11], s21 offen
    s_mov_b32 s21, 393216
    buffer_load_dwordx4 v[184:187], v28, s[8:11], s21 offen
    s_mov_b32 s21, 458752
    buffer_load_dwordx4 v[188:191], v28, s[8:11], s21 offen
    s_mov_b32 s21, 0
    buffer_load_dwordx4 v[224:227], v29, s[64:67], s21 offen
    s_mov_b32 s21, 131072
    buffer_load_dwordx4 v[228:231], v29, s[64:67], s21 offen
    s_mov_b32 s21, 262144
    buffer_load_dwordx4 v[232:235], v29, s[64:67], s21 offen
    s_mov_b32 s21, 393216
    buffer_load_dwordx4 v[236:239], v29, s[64:67], s21 offen
    s_mov_b32 s21, 524288
    buffer_load_dwordx4 v[240:243], v29, s[64:67], s21 offen
    s_mov_b32 s21, 655360
    buffer_load_dwordx4 v[244:247], v29, s[64:67], s21 offen
    s_mov_b32 s21, 786432
    buffer_load_dwordx4 v[248:251], v29, s[64:67], s21 offen
    s_mov_b32 s21, 917504
    buffer_load_dwordx4 v[252:255], v29, s[64:67], s21 offen
    s_mov_b32 s21, 524288
    buffer_load_dwordx4 v[192:195], v28, s[8:11], s21 offen
    s_mov_b32 s21, 589824
    buffer_load_dwordx4 v[196:199], v28, s[8:11], s21 offen
    s_mov_b32 s21, 655360
    buffer_load_dwordx4 v[200:203], v28, s[8:11], s21 offen
    s_mov_b32 s21, 720896
    buffer_load_dwordx4 v[204:207], v28, s[8:11], s21 offen
    s_mov_b32 s21, 786432
    buffer_load_dwordx4 v[208:211], v28, s[8:11], s21 offen
    s_mov_b32 s21, 851968
    buffer_load_dwordx4 v[212:215], v28, s[8:11], s21 offen
    s_mov_b32 s21, 917504
    buffer_load_dwordx4 v[216:219], v28, s[8:11], s21 offen
    s_mov_b32 s21, 983040
    buffer_load_dwordx4 v[220:223], v28, s[8:11], s21 offen
    s_branch ch_wl2
ch_wl1:
    s_mov_b32 s21, 0
    buffer_load_dwordx4 v[160:163], v28, s[8:11], s21 offen nt
    s_mov_b32 s21, 65536
    buffer_load_dwordx4 v[164:167], v28, s[8:11], s21 offen nt
    s_mov_b32 s21, 131072
    buffer_load_dwordx4 v[168:171], v28, s[8:11], s21 offen nt
    s_mov_b32 s21, 196608
    buffer_load_dwordx4 v[172:175], v28, s[8:11], s21 offen nt
    s_mov_b32 s21, 262144
    buffer_load_dwordx4 v[176:179], v28, s[8:11], s21 offen nt
    s_mov_b32 s21, 327680
    buffer_load_dwordx4 v[180:183], v28, s[8:11], s21 offen nt
    s_mov_b32 s21, 393216
    buffer_load_dwordx4 v[184:187], v28, s[8:11], s21 offen nt
    s_mov_b32 s21, 458752
    buffer_load_dwordx4 v[188:191], v28, s[8:11], s21 offen nt
    s_mov_b32 s21, 0
    buffer_load_dwordx4 v[224:227], v29, s[64:67], s21 offen
    s_mov_b32 s21, 131072
    buffer_load_dwordx4 v[228:231], v29, s[64:67], s21 offen
    s_mov_b32 s21, 262144
    buffer_load_dwordx4 v[232:235], v29, s[64:67], s21 offen
    s_mov_b32 s21, 393216
    buffer_load_dwordx4 v[236:239], v29, s[64:67], s21 offen
    s_mov_b32 s21, 524288
    buffer_load_dwordx4 v[240:243], v29, s[64:67], s21 offen
    s_mov_b32 s21, 655360
    buffer_load_dwordx4 v[244:247], v29, s[64:67], s21 offen
    s_mov_b32 s21, 786432
    buffer_load_dwordx4 v[248:251], v29, s[64:67], s21 offen
    s_mov_b32 s21, 917504
    buffer_load_dwordx4 v[252:255], v29, s[64:67], s21 offen
    s_mov_b32 s21, 524288
    buffer_load_dwordx4 v[192:195], v28, s[8:11], s21 offen nt
    s_mov_b32 s21, 589824
    buffer_load_dwordx4 v[196:199], v28, s[8:11], s21 offen nt
    s_mov_b32 s21, 655360
    buffer_load_dwordx4 v[200:203], v28, s[8:11], s21 offen nt
    s_mov_b32 s21, 720896
    buffer_load_dwordx4 v[204:207], v28, s[8:11], s21 offen nt
    s_mov_b32 s21, 786432
    buffer_load_dwordx4 v[208:211], v28, s[8:11], s21 offen nt
    s_mov_b32 s21, 851968
    buffer_load_dwordx4 v[212:215], v28, s[8:11], s21 offen nt
    s_mov_b32 s21, 917504
    buffer_load_dwordx4 v[216:219], v28, s[8:11], s21 offen nt
    s_mov_b32 s21, 983040
    buffer_load_dwordx4 v[220:223], v28, s[8:11], s21 offen nt
ch_wl2:
    s_add_u32 m0, s24, 0
    s_mov_b32 s21, 0
    buffer_load_dwordx4 v30, s[12:15], s21 offen nt lds
    s_add_u32 m0, s24, 8192
    s_mov_b32 s21, 131072
    buffer_load_dwordx4 v30, s[12:15], s21 offen nt lds
    s_add_u32 m0, s24, 16384
    s_mov_b32 s21, 262144
    buffer_load_dwordx4 v30, s[12:15], s21 offen nt lds
    s_add_u32 m0, s24, 24576
    s_mov_b32 s21, 393216
    buffer_load_dwordx4 v30, s[12:15], s21 offen nt lds
    s_add_u32 m0, s24, 32768
    s_mov_b32 s21, 524288
    buffer_load_dwordx4 v30, s[12:15], s21 offen nt lds
    s_add_u32 m0, s24, 40960
    s_mov_b32 s21, 655360
    buffer_load_dwordx4 v30, s[12:15], s21 offen nt lds
    s_add_u32 m0, s24, 49152
    s_mov_b32 s21, 786432
    buffer_load_dwordx4 v30, s[12:15], s21 offen nt lds
    s_add_u32 m0, s24, 57344
    s_mov_b32 s21, 917504
    buffer_load_dwordx4 v30, s[12:15], s21 offen nt lds
    s_cmp_ge_u32 s20, 4
    s_cselect_b32 s21, s92, s90
    s_cselect_b32 s22, s92, s91
    s_add_u32 s21, s21, s23
    s_add_u32 s22, s22, s23
    buffer_load_dwordx4 v[32:35], v3, s[4:7], s21 offen sc1
    buffer_load_dwordx4 v[36:39], v3, s[4:7], s22 offen sc1
    s_add_u32 s25, s25, 0x40000
    v_bfe_u32 v16, v1, 2, 1
    v_bfe_u32 v17, v1, 3, 1
    v_bfe_u32 v18, v1, 4, 1
    v_bfe_u32 v19, v1, 5, 1
    v_lshl_add_u32 v22, v19, 4, v16
    v_lshl_add_u32 v22, v17, 3, v22
    v_lshl_add_u32 v22, v18, 2, v22
    s_lshl_b32 s21, s20, 13
    s_add_u32 s21, s21, 0x10000
    v_and_b32 v20, 3, v1
    v_lshlrev_b32 v23, 3, v20
    v_lshlrev_b32 v24, 5, v18
    v_lshl_add_u32 v25, v17, 6, v24
    v_lshl_add_u32 v26, v22, 7, v23
    v_add_u32 v26, s21, v26
    v_xor_b32 v21, 0, v25
    v_add_u32 v40, v26, v21
    v_xor_b32 v21, 32, v25
    v_add_u32 v41, v26, v21
    v_xor_b32 v21, 64, v25
    v_add_u32 v42, v26, v21
    v_xor_b32 v21, 96, v25
    v_add_u32 v43, v26, v21
    v_lshl_add_u32 v26, v22, 6, v23
    v_add_u32 v26, s21, v26
    v_xor_b32 v21, 0, v24
    v_add_u32 v44, v26, v21
    v_xor_b32 v21, 32, v24
    v_add_u32 v45, v26, v21
    v_lshlrev_b32 v21, 5, v19
    v_xor_b32 v46, v3, v21
    v_add_u32 v46, s21, v46
    v_xor_b32 v47, 64, v46
    v_xor_b32 v48, v3, v24
    v_add_u32 v48, s21, v48
    v_lshlrev_b32 v22, 4, v16
    v_lshl_add_u32 v22, v19, 3, v22
    v_lshl_add_u32 v22, v17, 2, v22
    v_lshl_add_u32 v22, v18, 1, v22
    v_lshl_add_u32 v24, v17, 6, v24
    s_and_b32 s21, s20, 3
    s_lshl_b32 s21, s21, 5
    v_lshlrev_b32 v23, 3, v20
    v_add_u32 v23, s21, v23
    v_xor_b32 v23, v23, v24
    v_lshl_add_u32 v53, v22, 7, v23
    v_and_b32 v16, 15, v1
    v_lshrrev_b32 v17, 4, v1
    v_mov_b32 v2, 0x4444
    v_mov_b32 v20, 0xeeee
    v_cmp_gt_u32 vcc, 8, v16
    s_nop 1
    v_cndmask_b32 v2, v20, v2, vcc
    s_and_b32 s21, s20, 1
    s_lshl_b32 s78, s21, 10
    s_lshl_b32 s22, s46, 11
    s_lshl_b32 s21, s45, 9
    s_add_u32 s21, s21, s22
    s_add_u32 s21, s21, 458752
    v_lshlrev_b32 v20, 7, v17
    v_lshl_add_u32 v20, v16, 4, v20
    v_add_u32 v20, s21, v20
    v_mov_b32 v21, 1073741824
    v_cndmask_b32 v9, v21, v20, vcc
    s_lshl_b32 s76, s30, 13
    s_add_u32 s76, s76, s24
    s_add_u32 s76, s76, 458752
    v_add_u32 v10, 0x10000, v3
    v_add_u32 v11, s24, v10
    v_lshrrev_b32 v20, 2, v16
    v_lshlrev_b32 v20, 8, v20
    v_lshl_add_u32 v20, v18, 6, v20
    v_lshl_add_u32 v20, v19, 5, v20
    v_and_b32 v21, 3, v16
    v_lshl_add_u32 v20, v21, 2, v20
    s_and_b32 s21, s45, 1
    s_lshl_b32 s21, s21, 11
    s_and_b32 s22, s20, 2
    s_lshl_b32 s22, s22, 9
    s_add_u32 s21, s21, s22
    s_and_b32 s22, s20, 1
    s_lshl_b32 s22, s22, 4
    s_add_u32 s21, s21, s22
    s_lshr_b32 s22, s45, 1
    s_lshl_b32 s22, s22, 7
    s_add_u32 s21, s21, s22
    v_add_u32 v20, s21, v20
    s_lshr_b32 s21, s45, 1
    s_lshl_b32 s21, s21, 10
    s_and_b32 s22, s45, 1
    s_lshl_b32 s22, s22, 3
    s_add_u32 s21, s21, s22
    s_and_b32 s22, s20, 1
    s_lshl_b32 s22, s22, 2
    s_add_u32 s21, s21, s22
    s_add_u32 s21, s21, 4096
    v_add_u32 v21, s21, v3
    s_cmp_ge_u32 s20, 4
    s_cselect_b64 vcc, -1, 0
    v_cndmask_b32 v4, v20, v21, vcc
    v_add_u32 v4, s36, v4
    s_and_b32 s21, s20, 2
    s_lshl_b32 s21, s21, 9
    s_and_b32 s22, s20, 1
    s_lshl_b32 s22, s22, 3
    s_add_u32 s21, s21, s22
    v_add_u32 v5, s21, v10
    s_lshl_b32 s43, s31, 2
    s_and_b32 s21, s20, 3
    s_add_u32 s43, s43, s21
    s_lshl_b32 s51, s43, 8
    s_lshl_b32 s43, s43, 11
    s_add_u32 s43, s43, 109051904
    s_lshl_b32 s21, s30, 8
    s_add_u32 s21, s21, s43
    v_lshlrev_b32 v6, 2, v1
    v_add_u32 v6, s21, v6
    v_bfe_u32 v20, v1, 1, 1
    v_lshlrev_b32 v20, 7, v20
    v_bfe_u32 v21, v1, 2, 1
    v_lshl_add_u32 v20, v21, 6, v20
    v_bfe_u32 v21, v1, 3, 1
    v_lshl_add_u32 v20, v21, 5, v20
    v_lshl_add_u32 v20, v19, 4, v20
    v_and_b32 v21, 1, v1
    v_lshl_add_u32 v20, v21, 3, v20
    v_lshl_add_u32 v20, v18, 2, v20
    s_lshl_b32 s42, s30, 14
    s_add_u32 s21, s51, s42
    v_add_u32 v7, s21, v20
    s_lshl_b32 s21, s20, 11
    v_add_u32 v52, s21, v10
    s_add_u32 s42, s42, s21
    v_lshlrev_b32 v8, 9, v17
    v_lshl_add_u32 v8, v16, 4, v8
    s_mov_b32 s37, 0x3e0293ee
    s_mov_b32 s94, s37
    s_mov_b32 s95, s37
    s_lshl_b32 s38, s46, 13
    s_lshl_b32 s39, s45, 11
    s_add_u32 s39, s39, s38
    s_add_u32 s39, s39, 37748736
    s_add_u32 s38, s38, 20971520
    s_lshl_b32 s78, s45, 9
    v_lshlrev_b32 v62, 3, v1
    s_add_u32 s78, s78, 4096
    s_mov_b32 s33, 88080384
    s_mov_b32 s88, 88604672
    s_mov_b32 s23, 89128960
    s_mov_b32 s89, 89653248
    s_add_u32 s74, s36, 92143616
    s_mov_b32 s34, 0
    s_lshl_b32 s86, s46, 7
    s_add_u32 s86, s86, 167854080
    s_cmp_eq_u32 s20, 3
    s_cselect_b32 s79, 1, 0
    s_waitcnt vmcnt(33)
    ds_write_b128 v46, v[160:163] offset:0
    s_waitcnt vmcnt(32)
    ds_write_b128 v47, v[164:167] offset:1024
    s_waitcnt vmcnt(31)
    ds_write_b128 v46, v[168:171] offset:2048
    s_waitcnt vmcnt(30)
    ds_write_b128 v47, v[172:175] offset:3072
    s_waitcnt vmcnt(29)
    ds_write_b128 v46, v[176:179] offset:4096
    s_waitcnt vmcnt(28)
    ds_write_b128 v47, v[180:183] offset:5120
    s_waitcnt vmcnt(27)
    ds_write_b128 v46, v[184:187] offset:6144
    s_waitcnt vmcnt(26)
    ds_write_b128 v47, v[188:191] offset:7168
    s_waitcnt lgkmcnt(0)
    ds_read_b64_tr_b16 v[160:161], v40 offset:0
    ds_read_b64_tr_b16 v[162:163], v40 offset:256
    ds_read_b64_tr_b16 v[164:165], v40 offset:4096
    ds_read_b64_tr_b16 v[166:167], v40 offset:4352
    ds_read_b64_tr_b16 v[168:169], v41 offset:0
    ds_read_b64_tr_b16 v[170:171], v41 offset:256
    ds_read_b64_tr_b16 v[172:173], v41 offset:4096
    ds_read_b64_tr_b16 v[174:175], v41 offset:4352
    ds_read_b64_tr_b16 v[176:177], v42 offset:0
    ds_read_b64_tr_b16 v[178:179], v42 offset:256
    ds_read_b64_tr_b16 v[180:181], v42 offset:4096
    ds_read_b64_tr_b16 v[182:183], v42 offset:4352
    ds_read_b64_tr_b16 v[184:185], v43 offset:0
    ds_read_b64_tr_b16 v[186:187], v43 offset:256
    ds_read_b64_tr_b16 v[188:189], v43 offset:4096
    ds_read_b64_tr_b16 v[190:191], v43 offset:4352
    s_waitcnt lgkmcnt(0)
    s_waitcnt vmcnt(25)
    ds_write_b128 v48, v[224:227] offset:0
    s_waitcnt vmcnt(24)
    ds_write_b128 v48, v[228:231] offset:1024
    s_waitcnt vmcnt(23)
    ds_write_b128 v48, v[232:235] offset:2048
    s_waitcnt vmcnt(22)
    ds_write_b128 v48, v[236:239] offset:3072
    s_waitcnt vmcnt(21)
    ds_write_b128 v48, v[240:243] offset:4096
    s_waitcnt vmcnt(20)
    ds_write_b128 v48, v[244:247] offset:5120
    s_waitcnt vmcnt(19)
    ds_write_b128 v48, v[248:251] offset:6144
    s_waitcnt vmcnt(18)
    ds_write_b128 v48, v[252:255] offset:7168
    s_waitcnt lgkmcnt(0)
    ds_read_b64_tr_b16 v[224:225], v44 offset:0
    ds_read_b64_tr_b16 v[226:227], v44 offset:128
    ds_read_b64_tr_b16 v[228:229], v44 offset:2048
    ds_read_b64_tr_b16 v[230:231], v44 offset:2176
    ds_read_b64_tr_b16 v[232:233], v45 offset:0
    ds_read_b64_tr_b16 v[234:235], v45 offset:128
    ds_read_b64_tr_b16 v[236:237], v45 offset:2048
    ds_read_b64_tr_b16 v[238:239], v45 offset:2176
    ds_read_b64_tr_b16 v[240:241], v44 offset:4096
    ds_read_b64_tr_b16 v[242:243], v44 offset:4224
    ds_read_b64_tr_b16 v[244:245], v44 offset:6144
    ds_read_b64_tr_b16 v[246:247], v44 offset:6272
    ds_read_b64_tr_b16 v[248:249], v45 offset:4096
    ds_read_b64_tr_b16 v[250:251], v45 offset:4224
    ds_read_b64_tr_b16 v[252:253], v45 offset:6144
    ds_read_b64_tr_b16 v[254:255], v45 offset:6272
    s_waitcnt lgkmcnt(0)
    s_waitcnt vmcnt(17)
    ds_write_b128 v46, v[192:195] offset:0
    s_waitcnt vmcnt(16)
    ds_write_b128 v47, v[196:199] offset:1024
    s_waitcnt vmcnt(15)
    ds_write_b128 v46, v[200:203] offset:2048
    s_waitcnt vmcnt(14)
    ds_write_b128 v47, v[204:207] offset:3072
    s_waitcnt vmcnt(13)
    ds_write_b128 v46, v[208:211] offset:4096
    s_waitcnt vmcnt(12)
    ds_write_b128 v47, v[212:215] offset:5120
    s_waitcnt vmcnt(11)
    ds_write_b128 v46, v[216:219] offset:6144
    s_waitcnt vmcnt(10)
    ds_write_b128 v47, v[220:223] offset:7168
    s_waitcnt lgkmcnt(0)
    ds_read_b64_tr_b16 v[192:193], v40 offset:0
    ds_read_b64_tr_b16 v[194:195], v40 offset:256
    ds_read_b64_tr_b16 v[196:197], v40 offset:4096
    ds_read_b64_tr_b16 v[198:199], v40 offset:4352
    ds_read_b64_tr_b16 v[200:201], v41 offset:0
    ds_read_b64_tr_b16 v[202:203], v41 offset:256
    ds_read_b64_tr_b16 v[204:205], v41 offset:4096
    ds_read_b64_tr_b16 v[206:207], v41 offset:4352
    ds_read_b64_tr_b16 v[208:209], v42 offset:0
    ds_read_b64_tr_b16 v[210:211], v42 offset:256
    ds_read_b64_tr_b16 v[212:213], v42 offset:4096
    ds_read_b64_tr_b16 v[214:215], v42 offset:4352
    ds_read_b64_tr_b16 v[216:217], v43 offset:0
    ds_read_b64_tr_b16 v[218:219], v43 offset:256
    ds_read_b64_tr_b16 v[220:221], v43 offset:4096
    ds_read_b64_tr_b16 v[222:223], v43 offset:4352
    s_waitcnt lgkmcnt(0)
    s_waitcnt vmcnt(0)
    s_barrier
    v_mov_b32 v136, -1
    v_mov_b32 v137, -1
    v_mov_b32 v138, -1
    v_mov_b32 v139, -1
    v_mov_b32 v20, 0xf149f2ca
    v_cmp_eq_u32 vcc, 0, v19
    s_nop 1
    v_cndmask_b32 v132, 0, v20, vcc
    v_cndmask_b32 v133, 0, v20, vcc
    v_cndmask_b32 v134, 0, v20, vcc
    v_cndmask_b32 v135, 0, v20, vcc
    s_cmp_lt_u32 s20, 4
    s_cbranch_scc1 ch_n67
    ds_read_b64_tr_b16 v[64:65], v53 offset:0
    ds_read_b64_tr_b16 v[66:67], v53 offset:128
    ds_read_b64_tr_b16 v[68:69], v53 offset:4096
    ds_read_b64_tr_b16 v[70:71], v53 offset:4224
    ds_read_b64_tr_b16 v[72:73], v53 offset:8192
    ds_read_b64_tr_b16 v[74:75], v53 offset:8320
    ds_read_b64_tr_b16 v[76:77], v53 offset:12288
    ds_read_b64_tr_b16 v[78:79], v53 offset:12416
    ds_read_b64_tr_b16 v[80:81], v53 offset:16384
    ds_read_b64_tr_b16 v[82:83], v53 offset:16512
    ds_read_b64_tr_b16 v[84:85], v53 offset:20480
    ds_read_b64_tr_b16 v[86:87], v53 offset:20608
    ds_read_b64_tr_b16 v[88:89], v53 offset:24576
    ds_read_b64_tr_b16 v[90:91], v53 offset:24704
    ds_read_b64_tr_b16 v[92:93], v53 offset:28672
    ds_read_b64_tr_b16 v[94:95], v53 offset:28800
    ds_read_b64_tr_b16 v[96:97], v53 offset:32768
    ds_read_b64_tr_b16 v[98:99], v53 offset:32896
    ds_read_b64_tr_b16 v[100:101], v53 offset:36864
    ds_read_b64_tr_b16 v[102:103], v53 offset:36992
    ds_read_b64_tr_b16 v[104:105], v53 offset:40960
    ds_read_b64_tr_b16 v[106:107], v53 offset:41088
    ds_read_b64_tr_b16 v[108:109], v53 offset:45056
    ds_read_b64_tr_b16 v[110:111], v53 offset:45184
    ds_read_b64_tr_b16 v[112:113], v53 offset:49152
    ds_read_b64_tr_b16 v[114:115], v53 offset:49280
    ds_read_b64_tr_b16 v[116:117], v53 offset:53248
    ds_read_b64_tr_b16 v[118:119], v53 offset:53376
    ds_read_b64_tr_b16 v[120:121], v53 offset:57344
    ds_read_b64_tr_b16 v[122:123], v53 offset:57472
    ds_read_b64_tr_b16 v[124:125], v53 offset:61440
    ds_read_b64_tr_b16 v[126:127], v53 offset:61568
ch_n67:
    v_and_b32 v18, 7, v1
    v_lshlrev_b32 v18, 2, v18
ch_xid:
    buffer_load_dword v16, v18, s[52:55], 0 offen sc1
    s_waitcnt vmcnt(0)
    v_and_b32 v17, 0xff, v16
    v_cmp_gt_u32 vcc, 16, v17
    s_cbranch_vccz ch_xid_ok
    s_sleep 4
    s_sub_u32 s35, s35, 1
    s_cbranch_scc0 ch_xid
    s_mov_b32 s35, 0
ch_xid_ok:
    v_readlane_b32 s21, v16, s30
    s_bfe_u32 s22, s21, 0x80008
    s_mul_i32 s22, s22, s22
    s_lshr_b32 s21, s21, 16
    s_lshl_b32 s21, s21, 4
    s_cmp_eq_u32 s21, s22
    s_cselect_b32 s44, 1, 0
    s_add_u32 s96, s33, s42
    s_mov_b32 s77, 0
    s_mov_b32 s97, s33
    buffer_load_dwordx4 v[40:43], v3, s[4:7], s96 offen offset:0 sc1
    buffer_load_dwordx4 v[44:47], v3, s[4:7], s96 offen offset:1024 sc1
    s_cmp_eq_u32 s44, 1
    s_cbranch_scc0 ch_loop_g
.p2align 6
ch_loop:
    v_mov_b32 v16, 0
    v_mov_b32 v17, 0
    v_mov_b32 v18, 0
    v_mov_b32 v19, 0
    v_mov_b32 v20, 0
    v_mov_b32 v21, 0
    v_mov_b32 v22, 0
    v_mov_b32 v23, 0
    v_mov_b32 v24, 0
    v_mov_b32 v25, 0
    v_mov_b32 v26, 0
    v_mov_b32 v27, 0
    v_mov_b32 v28, 0
    v_mov_b32 v29, 0
    v_mov_b32 v30, 0
    v_mov_b32 v31, 0
    v_mov_b32 v140, 0
    v_mov_b32 v141, 0
    v_mov_b32 v142, 0
    v_mov_b32 v143, 0
    v_mov_b32 v144, 0
    v_mov_b32 v145, 0
    v_mov_b32 v146, 0
    v_mov_b32 v147, 0
chk_1:
    s_waitcnt vmcnt(1)
    v_max3_u32 v48, v40, v41, v42
    v_max_u32 v48, v48, v43
    v_cmp_eq_u32 vcc, -1, v48
    s_cbranch_vccnz rt_5
go_3:
    v_smfmac_f32_16x16x64_bf16 v[16:19], v[40:43], v[160:167], v2
    v_smfmac_f32_16x16x64_bf16 v[20:23], v[40:43], v[168:175], v2
    v_smfmac_f32_16x16x64_bf16 v[24:27], v[40:43], v[176:183], v2
    v_smfmac_f32_16x16x64_bf16 v[28:31], v[40:43], v[184:191], v2
chk_2:
    s_waitcnt vmcnt(0)
    v_max3_u32 v48, v44, v45, v46
    v_max_u32 v48, v48, v47
    v_cmp_eq_u32 vcc, -1, v48
    s_cbranch_vccnz rt_6
go_4:
    v_smfmac_f32_16x16x64_bf16 v[16:19], v[44:47], v[192:199], v2
    v_smfmac_f32_16x16x64_bf16 v[20:23], v[44:47], v[200:207], v2
    v_smfmac_f32_16x16x64_bf16 v[24:27], v[44:47], v[208:215], v2
    v_smfmac_f32_16x16x64_bf16 v[28:31], v[44:47], v[216:223], v2
    s_nop 4
    v_permlane32_swap_b32 v16, v18
    v_permlane32_swap_b32 v17, v19
    v_add_f32 v32, v16, v18
    v_add_f32 v34, v17, v19
    v_permlane32_swap_b32 v20, v22
    v_permlane32_swap_b32 v21, v23
    v_add_f32 v33, v20, v22
    v_add_f32 v35, v21, v23
    ds_write_b128 v52, v[32:35] offset:0
    v_permlane32_swap_b32 v24, v26
    v_permlane32_swap_b32 v25, v27
    v_add_f32 v36, v24, v26
    v_add_f32 v38, v25, v27
    v_permlane32_swap_b32 v28, v30
    v_permlane32_swap_b32 v29, v31
    v_add_f32 v37, v28, v30
    v_add_f32 v39, v29, v31
    ds_write_b128 v52, v[36:39] offset:1024
    v_smfmac_f32_16x16x64_bf16 v[140:143], v[40:43], v[224:231], v2
    v_smfmac_f32_16x16x64_bf16 v[144:147], v[40:43], v[232:239], v2
    v_smfmac_f32_16x16x64_bf16 v[140:143], v[44:47], v[240:247], v2
    v_smfmac_f32_16x16x64_bf16 v[144:147], v[44:47], v[248:255], v2
    s_cmp_ge_u32 s20, 4
    s_waitcnt lgkmcnt(0)
    s_barrier
    s_nop 2
    s_cbranch_scc1 ch_pv
    ds_read_b64 v[16:17], v5 offset:0
    ds_read_b64 v[18:19], v5 offset:2048
    ds_read_b64 v[20:21], v5 offset:4096
    ds_read_b64 v[22:23], v5 offset:6144
    ds_read_b64 v[24:25], v5 offset:8192
    ds_read_b64 v[26:27], v5 offset:10240
    ds_read_b64 v[28:29], v5 offset:12288
    ds_read_b64 v[30:31], v5 offset:14336
    s_waitcnt lgkmcnt(6)
    v_pk_add_f32 v[16:17], v[16:17], v[18:19]
    s_waitcnt lgkmcnt(4)
    v_pk_add_f32 v[20:21], v[20:21], v[22:23]
    v_pk_add_f32 v[16:17], v[16:17], v[20:21]
    s_waitcnt lgkmcnt(2)
    v_pk_add_f32 v[24:25], v[24:25], v[26:27]
    s_waitcnt lgkmcnt(0)
    v_pk_add_f32 v[28:29], v[28:29], v[30:31]
    v_pk_add_f32 v[24:25], v[24:25], v[28:29]
    v_pk_add_f32 v[16:17], v[16:17], v[24:25]
    v_cvt_pk_bf16_f32 v16, v16, v17
    buffer_store_dword v16, v4, s[4:7], s97 offen
ch_pv:
    v_permlane32_swap_b32 v140, v142
    v_permlane32_swap_b32 v141, v143
    v_permlane32_swap_b32 v144, v146
    v_permlane32_swap_b32 v145, v147
    v_pk_add_f32 v[32:33], v[140:141], v[142:143]
    v_pk_add_f32 v[34:35], v[144:145], v[146:147]
    ds_write_b128 v11, v[32:35] offset:24576
    s_add_u32 s21, s33, s36
    s_cmp_lg_u32 s77, 1
    s_waitcnt lgkmcnt(0)
    s_barrier
    s_cbranch_scc1 ch_oth
ch_att2:
    buffer_load_dwordx4 v[112:115], v3, s[4:7], s21 offen offset:0 sc1
    buffer_load_dwordx4 v[116:119], v3, s[4:7], s21 offen offset:1024 sc1
    buffer_load_dwordx4 v[120:123], v3, s[4:7], s21 offen offset:2048 sc1
    buffer_load_dwordx4 v[124:127], v3, s[4:7], s21 offen offset:3072 sc1
    ds_read_b128 v[16:19], v10 offset:24576
    ds_read_b128 v[20:23], v10 offset:25600
    ds_read_b128 v[24:27], v10 offset:26624
    ds_read_b128 v[28:31], v10 offset:27648
    ds_read_b128 v[32:35], v10 offset:28672
    ds_read_b128 v[36:39], v10 offset:29696
    ds_read_b128 v[40:43], v10 offset:30720
    ds_read_b128 v[44:47], v10 offset:31744
    s_waitcnt lgkmcnt(6)
    v_pk_add_f32 v[16:17], v[16:17], v[20:21]
    v_pk_add_f32 v[18:19], v[18:19], v[22:23]
    s_waitcnt lgkmcnt(4)
    v_pk_add_f32 v[24:25], v[24:25], v[28:29]
    v_pk_add_f32 v[26:27], v[26:27], v[30:31]
    v_pk_add_f32 v[16:17], v[16:17], v[24:25]
    v_pk_add_f32 v[18:19], v[18:19], v[26:27]
    s_waitcnt lgkmcnt(2)
    v_pk_add_f32 v[32:33], v[32:33], v[36:37]
    v_pk_add_f32 v[34:35], v[34:35], v[38:39]
    s_waitcnt lgkmcnt(0)
    v_pk_add_f32 v[40:41], v[40:41], v[44:45]
    v_pk_add_f32 v[42:43], v[42:43], v[46:47]
    v_pk_add_f32 v[32:33], v[32:33], v[40:41]
    v_pk_add_f32 v[34:35], v[34:35], v[42:43]
    v_pk_add_f32 v[16:17], v[16:17], v[32:33]
    v_pk_add_f32 v[18:19], v[18:19], v[34:35]
    v_cvt_pk_bf16_f32 v128, v16, v17
    v_cvt_pk_bf16_f32 v129, v18, v19
chk_9:
    s_waitcnt vmcnt(3)
    v_max3_u32 v30, v112, v113, v114
    v_max_u32 v30, v30, v115
    v_cmp_eq_u32 vcc, -1, v30
    s_cbranch_vccnz rt_17
go_13:
    v_mfma_f32_16x16x32_bf16 v[16:19], v[112:115], v[112:115], v[132:135]
    v_mfma_f32_16x16x32_bf16 v[20:23], v[64:67], v[112:115], 0
    v_mfma_f32_16x16x32_bf16 v[24:27], v[80:83], v[112:115], 0
chk_10:
    s_waitcnt vmcnt(2)
    v_max3_u32 v30, v116, v117, v118
    v_max_u32 v30, v30, v119
    v_cmp_eq_u32 vcc, -1, v30
    s_cbranch_vccnz rt_18
go_14:
    v_mfma_f32_16x16x32_bf16 v[16:19], v[116:119], v[116:119], v[16:19]
    v_mfma_f32_16x16x32_bf16 v[20:23], v[68:71], v[116:119], v[20:23]
    v_mfma_f32_16x16x32_bf16 v[24:27], v[84:87], v[116:119], v[24:27]
chk_11:
    s_waitcnt vmcnt(1)
    v_max3_u32 v30, v120, v121, v122
    v_max_u32 v30, v30, v123
    v_cmp_eq_u32 vcc, -1, v30
    s_cbranch_vccnz rt_19
go_15:
    v_mfma_f32_16x16x32_bf16 v[16:19], v[120:123], v[120:123], v[16:19]
    v_mfma_f32_16x16x32_bf16 v[20:23], v[72:75], v[120:123], v[20:23]
    v_mfma_f32_16x16x32_bf16 v[24:27], v[88:91], v[120:123], v[24:27]
chk_12:
    s_waitcnt vmcnt(0)
    v_max3_u32 v30, v124, v125, v126
    v_max_u32 v30, v30, v127
    v_cmp_eq_u32 vcc, -1, v30
    s_cbranch_vccnz rt_20
go_16:
    v_mfma_f32_16x16x32_bf16 v[16:19], v[124:127], v[124:127], v[16:19]
    v_mfma_f32_16x16x32_bf16 v[20:23], v[76:79], v[124:127], v[20:23]
    v_mfma_f32_16x16x32_bf16 v[24:27], v[92:95], v[124:127], v[24:27]
    v_mov_b32 v47, 0
    s_nop 4
    v_max3_f32 v30, v16, v17, v18
    v_max3_f32 v31, v19, v20, v21
    v_max3_f32 v30, v30, v22, v23
    v_max3_f32 v31, v31, v24, v25
    v_max3_f32 v30, v30, v26, v27
    v_max_f32 v30, v30, v31
    v_mov_b32 v31, v30
    s_nop 1
    v_permlane32_swap_b32 v30, v31
    v_max_f32 v30, v30, v31
    v_mov_b32 v31, v30
    s_nop 1
    v_permlane16_swap_b32 v30, v31
    v_max_f32 v30, v30, v31
    v_mul_f32 v30, s37, v30
    v_pk_fma_f32 v[20:21], v[20:21], s[94:95], v[30:31] op_sel_hi:[1,1,0] neg_lo:[0,0,1] neg_hi:[0,0,1]
    v_pk_fma_f32 v[22:23], v[22:23], s[94:95], v[30:31] op_sel_hi:[1,1,0] neg_lo:[0,0,1] neg_hi:[0,0,1]
    v_pk_fma_f32 v[24:25], v[24:25], s[94:95], v[30:31] op_sel_hi:[1,1,0] neg_lo:[0,0,1] neg_hi:[0,0,1]
    v_pk_fma_f32 v[26:27], v[26:27], s[94:95], v[30:31] op_sel_hi:[1,1,0] neg_lo:[0,0,1] neg_hi:[0,0,1]
    v_pk_fma_f32 v[16:17], v[16:17], s[94:95], v[30:31] op_sel_hi:[1,1,0] neg_lo:[0,0,1] neg_hi:[0,0,1]
    v_pk_fma_f32 v[18:19], v[18:19], s[94:95], v[30:31] op_sel_hi:[1,1,0] neg_lo:[0,0,1] neg_hi:[0,0,1]
    v_exp_f32 v20, v20
    v_exp_f32 v21, v21
    v_exp_f32 v22, v22
    v_exp_f32 v23, v23
    v_exp_f32 v24, v24
    v_exp_f32 v25, v25
    v_exp_f32 v26, v26
    v_exp_f32 v27, v27
    v_exp_f32 v16, v16
    v_cvt_pk_bf16_f32 v40, v20, v21
    v_cvt_pk_bf16_f32 v41, v22, v23
    v_cvt_pk_bf16_f32 v42, v24, v25
    v_cvt_pk_bf16_f32 v43, v26, v27
    v_exp_f32 v17, v17
    v_exp_f32 v18, v18
    v_mfma_f32_16x16x32_bf16 v[64:67], v[96:99], v[40:43], 0
    v_exp_f32 v19, v19
    v_pk_add_f32 v[20:21], v[20:21], v[22:23]
    v_cvt_pk_bf16_f32 v44, v16, v17
    v_cvt_pk_bf16_f32 v45, v18, v19
    v_pk_add_f32 v[24:25], v[24:25], v[26:27]
    v_pk_add_f32 v[16:17], v[16:17], v[18:19]
    v_mfma_f32_16x16x32_bf16 v[68:71], v[100:103], v[40:43], 0
    v_permlane32_swap_b32 v44, v45
    v_pk_add_f32 v[20:21], v[20:21], v[24:25]
    v_mov_b32 v46, v45
    v_pk_add_f32 v[16:17], v[16:17], v[20:21]
    v_add_f32 v16, v16, v17
    v_mfma_f32_16x16x16_bf16 v[64:67], v[128:129], v[46:47], v[64:67]
    v_mov_b32 v17, v16
    s_nop 1
    v_permlane32_swap_b32 v16, v17
    v_add_f32 v16, v16, v17
    v_mov_b32 v17, v16
    v_mfma_f32_16x16x16_bf16 v[68:71], v[128:129], v[44:45], v[68:71]
    s_nop 0
    v_permlane16_swap_b32 v16, v17
    v_add_f32 v16, v16, v17
    v_rcp_f32 v16, v16
    s_nop 0
    v_pk_mul_f32 v[64:65], v[64:65], v[16:17] op_sel_hi:[1,0]
    v_pk_mul_f32 v[66:67], v[66:67], v[16:17] op_sel_hi:[1,0]
    s_nop 0
    v_pk_mul_f32 v[68:69], v[68:69], v[16:17] op_sel_hi:[1,0]
    v_pk_mul_f32 v[70:71], v[70:71], v[16:17] op_sel_hi:[1,0]
    v_cvt_pk_bf16_f32 v32, v64, v68
    v_cvt_pk_bf16_f32 v33, v65, v69
    v_cvt_pk_bf16_f32 v34, v66, v70
    v_cvt_pk_bf16_f32 v35, v67, v71
    buffer_store_dwordx4 v[32:35], v9, s[4:7], s33 offen offset:0
ch_ba:
    s_barrier
ch_o:
    s_add_u32 s22, s33, s76
    buffer_load_dwordx4 v[12:15], v3, s[4:7], s22 offen sc1
    s_sleep 2
    buffer_load_dwordx4 v[56:59], v3, s[4:7], s22 offen sc1
    v_mov_b32 v16, 0
    v_mov_b32 v17, 0
    v_mov_b32 v18, 0
    v_mov_b32 v19, 0
ch_op:
    s_waitcnt vmcnt(1)
    ds_write_b128 v11, v[12:15] offset:16384
    v_max3_u32 v40, v12, v13, v14
    v_max_u32 v40, v40, v15
    v_cmp_eq_u32 vcc, -1, v40
    s_cbranch_vccz ch_oq
    buffer_load_dwordx4 v[12:15], v3, s[4:7], s22 offen sc1
    s_waitcnt vmcnt(1)
    ds_write_b128 v11, v[56:59] offset:16384
    v_max3_u32 v40, v56, v57, v58
    v_max_u32 v40, v40, v59
    v_cmp_eq_u32 vcc, -1, v40
    s_cbranch_vccz ch_oq
    buffer_load_dwordx4 v[56:59], v3, s[4:7], s22 offen sc1
    s_sub_u32 s35, s35, 1
    s_cbranch_scc0 ch_op
    s_mov_b32 s35, 0
ch_oq:
    s_lshl_b32 s85, s34, 17
    s_add_u32 s22, s85, s43
    s_add_u32 s96, s88, s42
    s_cmp_lt_u32 s20, 4
    s_waitcnt lgkmcnt(0)
    s_barrier
    s_cbranch_scc1 ch_red
    ds_read_b128 v[20:23], v10 offset:16384
    ds_read_b128 v[24:27], v10 offset:17408
    ds_read_b128 v[28:31], v10 offset:18432
    ds_read_b128 v[32:35], v10 offset:19456
    ds_read_b128 v[36:39], v10 offset:20480
    ds_read_b128 v[40:43], v10 offset:21504
    ds_read_b128 v[44:47], v10 offset:22528
    ds_read_b128 v[48:51], v10 offset:23552
    s_waitcnt lgkmcnt(7)
    v_smfmac_f32_16x16x64_bf16 v[16:19], v[20:23], v[64:71], v2
    s_waitcnt lgkmcnt(6)
    v_smfmac_f32_16x16x64_bf16 v[16:19], v[24:27], v[72:79], v2
    s_waitcnt lgkmcnt(5)
    v_smfmac_f32_16x16x64_bf16 v[16:19], v[28:31], v[80:87], v2
    s_waitcnt lgkmcnt(4)
    v_smfmac_f32_16x16x64_bf16 v[16:19], v[32:35], v[88:95], v2
    s_waitcnt lgkmcnt(3)
    v_smfmac_f32_16x16x64_bf16 v[16:19], v[36:39], v[96:103], v2
    s_waitcnt lgkmcnt(2)
    v_smfmac_f32_16x16x64_bf16 v[16:19], v[40:43], v[104:111], v2
    s_waitcnt lgkmcnt(1)
    v_smfmac_f32_16x16x64_bf16 v[16:19], v[44:47], v[112:119], v2
    s_waitcnt lgkmcnt(0)
    v_smfmac_f32_16x16x64_bf16 v[16:19], v[48:51], v[120:127], v2
    s_nop 7
    v_permlane32_swap_b32 v16, v18
    v_permlane32_swap_b32 v17, v19
    v_pk_add_f32 v[16:17], v[16:17], v[18:19]
    v_cvt_pk_bf16_f32 v16, v16, v17
    buffer_store_dword v16, v6, s[4:7], s85 offen sc1
    s_barrier
    s_cmp_eq_u32 s20, 6
    s_cbranch_scc1 ch_h6
    s_cmp_eq_u32 s20, 7
    s_cbranch_scc1 ch_h7
    s_cmp_eq_u32 s20, 4
    s_cbranch_scc1 ch_h4
    s_add_u32 s22, s74, s78
    buffer_store_dwordx2 v[128:129], v62, s[4:7], s22 offen sc1
    s_lshl_b32 s21, s45, 10
    s_add_u32 s21, s21, s74
    s_add_u32 s74, s74, 0x30000
    buffer_store_dwordx4 v[148:151], v3, s[4:7], s21 offen sc1
    s_branch ch_next
ch_h4:
    s_cmp_eq_u32 s45, 1
    s_cbranch_scc1 ch_h41
    s_cmp_lg_u32 s45, 2
    s_cbranch_scc1 ch_next
    s_cmp_eq_u32 s34, 62
    s_cbranch_scc1 ch_next
    s_add_u32 s98, s34, 2
    s_and_b32 s99, s98, 7
    s_cmp_lg_u32 s99, 0
    s_cbranch_scc1 kvok_21
    s_lshl_b32 s98, s98, 9
    s_lshr_b32 s99, s46, 1
    s_lshl_b32 s99, s99, 7
    s_add_u32 s98, s98, s99
    s_add_u32 s98, s98, 167772160
    v_mov_b32 v30, 0
kvp_22:
    buffer_load_dword v16, v30, s[4:7], s98 offen sc1
    buffer_load_dword v17, v30, s[4:7], s98 offen offset:2048 sc1
    s_waitcnt vmcnt(0)
    v_min_u32 v16, v16, v17
    v_cmp_gt_u32 vcc, 4, v16
    s_cbranch_vccz kvok_21
    s_sleep 2
    s_sub_u32 s35, s35, 1
    s_cbranch_scc0 kvp_22
    s_mov_b32 s35, 0
kvok_21:
    s_branch ch_next
ch_h41:
    v_mov_b32 v55, s34
    buffer_store_dword v55, v54, s[4:7], s86 offen sc1
    s_branch ch_next
ch_h6:
    s_add_u32 s22, s23, s90
    buffer_store_dwordx4 v[136:139], v3, s[4:7], s22 offen
    s_add_u32 s22, s23, s91
    buffer_store_dwordx4 v[136:139], v3, s[4:7], s22 offen
    s_branch ch_next
ch_h7:
    buffer_store_dwordx4 v[136:139], v9, s[4:7], s23 offen
    buffer_store_dwordx4 v[136:139], v63, s[4:7], s25 offen sc1
    s_add_u32 s25, s25, 0x20000
    s_branch ch_next
ch_red:
    s_barrier
    s_cmp_eq_u32 s79, 0
    s_cbranch_scc1 ch_rs
    s_add_u32 s21, s38, 4096
    buffer_load_dwordx4 v[64:67], v8, s[4:7], s38 offen offset:0 sc1
    buffer_load_dwordx4 v[80:83], v8, s[4:7], s38 offen offset:256 sc1
    buffer_load_dwordx4 v[68:71], v8, s[4:7], s38 offen offset:2048 sc1
    buffer_load_dwordx4 v[84:87], v8, s[4:7], s38 offen offset:2304 sc1
    buffer_load_dwordx4 v[72:75], v8, s[4:7], s21 offen offset:0 sc1
    buffer_load_dwordx4 v[88:91], v8, s[4:7], s21 offen offset:256 sc1
    buffer_load_dwordx4 v[76:79], v8, s[4:7], s21 offen offset:2048 sc1
    buffer_load_dwordx4 v[92:95], v8, s[4:7], s21 offen offset:2304 sc1
    buffer_load_dwordx4 v[96:99], v8, s[4:7], s39 offen offset:0 sc1
    buffer_load_dwordx4 v[100:103], v8, s[4:7], s39 offen offset:256 sc1
    s_add_u32 s38, s38, 262144
    s_add_u32 s39, s39, 262144
    s_sleep 8
    s_branch ch_rs2
ch_rs:
    s_sleep 10
ch_rs2:
    buffer_load_dwordx4 v[16:19], v3, s[4:7], s22 offen offset:0 sc1
    buffer_load_dwordx4 v[20:23], v3, s[4:7], s22 offen offset:1024 sc1
chk_23:
    s_waitcnt vmcnt(1)
    v_max3_u32 v30, v16, v17, v18
    v_max_u32 v30, v30, v19
    v_cmp_eq_u32 vcc, -1, v30
    s_cbranch_vccnz rt_27
go_25:
    v_lshlrev_b32 v32, 16, v16
    v_and_b32 v36, 0xffff0000, v16
    v_lshlrev_b32 v33, 16, v17
    v_and_b32 v37, 0xffff0000, v17
    v_lshlrev_b32 v34, 16, v18
    v_and_b32 v38, 0xffff0000, v18
    v_lshlrev_b32 v35, 16, v19
    v_and_b32 v39, 0xffff0000, v19
chk_24:
    s_waitcnt vmcnt(0)
    v_max3_u32 v30, v20, v21, v22
    v_max_u32 v30, v30, v23
    v_cmp_eq_u32 vcc, -1, v30
    s_cbranch_vccnz rt_28
go_26:
    v_lshlrev_b32 v40, 16, v20
    v_and_b32 v44, 0xffff0000, v20
    v_lshlrev_b32 v41, 16, v21
    v_and_b32 v45, 0xffff0000, v21
    v_lshlrev_b32 v42, 16, v22
    v_and_b32 v46, 0xffff0000, v22
    v_lshlrev_b32 v43, 16, v23
    v_and_b32 v47, 0xffff0000, v23
    v_pk_add_f32 v[32:33], v[32:33], v[40:41]
    v_pk_add_f32 v[34:35], v[34:35], v[42:43]
    v_pk_add_f32 v[36:37], v[36:37], v[44:45]
    v_pk_add_f32 v[38:39], v[38:39], v[46:47]
    s_nop 0
    v_permlane32_swap_b32 v32, v36
    v_permlane32_swap_b32 v33, v37
    v_permlane32_swap_b32 v34, v38
    v_permlane32_swap_b32 v35, v39
    v_pk_add_f32 v[32:33], v[32:33], v[36:37]
    v_pk_add_f32 v[34:35], v[34:35], v[38:39]
    s_nop 1
    v_permlane16_swap_b32 v32, v34
    v_permlane16_swap_b32 v33, v35
    v_pk_add_f32 v[32:33], v[32:33], v[34:35]
    v_cvt_pk_bf16_f32 v50, v32, v33
    buffer_store_dword v50, v7, s[4:7], s88 offen
ch_next:
    s_barrier
    buffer_load_dwordx4 v[40:43], v3, s[4:7], s96 offen offset:0 sc1
    buffer_load_dwordx4 v[44:47], v3, s[4:7], s96 offen offset:1024 sc1
    s_mov_b32 s21, s89
    s_mov_b32 s89, s33
    s_mov_b32 s33, s88
    s_mov_b32 s88, s23
    s_mov_b32 s23, s21
    s_add_u32 s34, s34, 1
    s_mov_b32 s97, s33
    s_mov_b32 s77, s79
    s_cmp_lg_u32 s34, 63
    s_cbranch_scc1 ch_loop
    s_mov_b32 s77, 0
    s_mov_b32 s97, 104529920
    s_branch ch_loop_g
rt_5:
    s_sub_u32 s35, s35, 1
    s_cbranch_scc1 rt_5x
    buffer_load_dwordx4 v[40:43], v3, s[4:7], s96 offen offset:0 sc1
    s_waitcnt vmcnt(1)
    v_max3_u32 v48, v44, v45, v46
    v_max_u32 v48, v48, v47
    v_cmp_eq_u32 vcc, -1, v48
    s_cbranch_vccz rs_29
    buffer_load_dwordx4 v[44:47], v3, s[4:7], s96 offen offset:1024 sc1
rs_29:
    s_waitcnt vmcnt(0)
    s_branch chk_1
rt_5x:
    s_mov_b32 s35, 0
    s_branch go_3
rt_6:
    s_sub_u32 s35, s35, 1
    s_cbranch_scc1 rt_6x
    buffer_load_dwordx4 v[44:47], v3, s[4:7], s96 offen offset:1024 sc1
    s_waitcnt vmcnt(0)
    s_branch chk_2
rt_6x:
    s_mov_b32 s35, 0
    s_branch go_4
rt_17:
    s_sub_u32 s35, s35, 1
    s_cbranch_scc1 rt_17x
    buffer_load_dwordx4 v[112:115], v3, s[4:7], s21 offen offset:0 sc1
    buffer_load_dwordx4 v[116:119], v3, s[4:7], s21 offen offset:1024 sc1
    buffer_load_dwordx4 v[120:123], v3, s[4:7], s21 offen offset:2048 sc1
    buffer_load_dwordx4 v[124:127], v3, s[4:7], s21 offen offset:3072 sc1
    s_branch chk_9
rt_17x:
    s_mov_b32 s35, 0
    s_branch go_13
rt_18:
    s_sub_u32 s35, s35, 1
    s_cbranch_scc1 rt_18x
    buffer_load_dwordx4 v[116:119], v3, s[4:7], s21 offen offset:1024 sc1
    buffer_load_dwordx4 v[120:123], v3, s[4:7], s21 offen offset:2048 sc1
    buffer_load_dwordx4 v[124:127], v3, s[4:7], s21 offen offset:3072 sc1
    s_branch chk_10
rt_18x:
    s_mov_b32 s35, 0
    s_branch go_14
rt_19:
    s_sub_u32 s35, s35, 1
    s_cbranch_scc1 rt_19x
    buffer_load_dwordx4 v[120:123], v3, s[4:7], s21 offen offset:2048 sc1
    buffer_load_dwordx4 v[124:127], v3, s[4:7], s21 offen offset:3072 sc1
    s_branch chk_11
rt_19x:
    s_mov_b32 s35, 0
    s_branch go_15
rt_20:
    s_sub_u32 s35, s35, 1
    s_cbranch_scc1 rt_20x
    buffer_load_dwordx4 v[124:127], v3, s[4:7], s21 offen offset:3072 sc1
    s_branch chk_12
rt_20x:
    s_mov_b32 s35, 0
    s_branch go_16
rt_27:
    s_sub_u32 s35, s35, 1
    s_cbranch_scc1 rt_27x
    buffer_load_dwordx4 v[16:19], v3, s[4:7], s22 offen offset:0 sc1
    s_waitcnt vmcnt(1)
    v_max3_u32 v30, v20, v21, v22
    v_max_u32 v30, v30, v23
    v_cmp_eq_u32 vcc, -1, v30
    s_cbranch_vccz rs_30
    buffer_load_dwordx4 v[20:23], v3, s[4:7], s22 offen offset:1024 sc1
rs_30:
    s_waitcnt vmcnt(0)
    s_branch chk_23
rt_27x:
    s_mov_b32 s35, 0
    s_branch go_25
rt_28:
    s_sub_u32 s35, s35, 1
    s_cbranch_scc1 rt_28x
    buffer_load_dwordx4 v[20:23], v3, s[4:7], s22 offen offset:1024 sc1
    s_waitcnt vmcnt(0)
    s_branch chk_24
rt_28x:
    s_mov_b32 s35, 0
    s_branch go_26
ch_oth:
    s_cmp_eq_u32 s79, 1
    s_cbranch_scc1 ch_att
    s_cmp_lg_u32 s20, 5
    s_cbranch_scc1 ch_n5
    ds_read_b128 v[16:19], v10 offset:24576
    ds_read_b128 v[20:23], v10 offset:25600
    ds_read_b128 v[24:27], v10 offset:26624
    ds_read_b128 v[28:31], v10 offset:27648
    ds_read_b128 v[32:35], v10 offset:28672
    ds_read_b128 v[36:39], v10 offset:29696
    ds_read_b128 v[40:43], v10 offset:30720
    ds_read_b128 v[44:47], v10 offset:31744
    s_waitcnt lgkmcnt(6)
    v_pk_add_f32 v[16:17], v[16:17], v[20:21]
    v_pk_add_f32 v[18:19], v[18:19], v[22:23]
    s_waitcnt lgkmcnt(4)
    v_pk_add_f32 v[24:25], v[24:25], v[28:29]
    v_pk_add_f32 v[26:27], v[26:27], v[30:31]
    v_pk_add_f32 v[16:17], v[16:17], v[24:25]
    v_pk_add_f32 v[18:19], v[18:19], v[26:27]
    s_waitcnt lgkmcnt(2)
    v_pk_add_f32 v[32:33], v[32:33], v[36:37]
    v_pk_add_f32 v[34:35], v[34:35], v[38:39]
    s_waitcnt lgkmcnt(0)
    v_pk_add_f32 v[40:41], v[40:41], v[44:45]
    v_pk_add_f32 v[42:43], v[42:43], v[46:47]
    v_pk_add_f32 v[32:33], v[32:33], v[40:41]
    v_pk_add_f32 v[34:35], v[34:35], v[42:43]
    v_pk_add_f32 v[16:17], v[16:17], v[32:33]
    v_pk_add_f32 v[18:19], v[18:19], v[34:35]
    v_cvt_pk_bf16_f32 v128, v16, v17
    v_cvt_pk_bf16_f32 v129, v18, v19
    s_cmp_eq_u32 s34, 63
    s_cbranch_scc1 ch_l5
    s_add_u32 s21, s33, s91
    s_barrier
    buffer_load_dwordx4 v[148:151], v3, s[4:7], s21 offen sc1
    s_branch ch_o
ch_l5:
    s_add_u32 s22, s74, s78
    buffer_store_dwordx2 v[128:129], v62, s[4:7], s22 offen sc1
ch_n5:
    s_cmp_eq_u32 s34, 63
    s_cbranch_scc1 ch_end
    s_branch ch_ba
ch_att:
    s_cmp_eq_u32 s34, 63
    s_cbranch_scc1 ch_end
    s_cmp_lg_u32 s34, 0
    s_cbranch_scc1 ch_kv0
    s_add_u32 s98, s34, 0
    s_and_b32 s99, s98, 7
    s_cmp_lg_u32 s99, 0
    s_cbranch_scc1 kvok_7
    s_lshl_b32 s98, s98, 9
    s_lshr_b32 s99, s46, 1
    s_lshl_b32 s99, s99, 7
    s_add_u32 s98, s98, s99
    s_add_u32 s98, s98, 167772160
    v_mov_b32 v30, 0
kvp_8:
    buffer_load_dword v16, v30, s[4:7], s98 offen sc1
    buffer_load_dword v17, v30, s[4:7], s98 offen offset:2048 sc1
    s_waitcnt vmcnt(0)
    v_min_u32 v16, v16, v17
    v_cmp_gt_u32 vcc, 4, v16
    s_cbranch_vccz kvok_7
    s_sleep 2
    s_sub_u32 s35, s35, 1
    s_cbranch_scc0 kvp_8
    s_mov_b32 s35, 0
kvok_7:
    s_add_u32 s21, s38, 4096
    buffer_load_dwordx4 v[64:67], v8, s[4:7], s38 offen offset:0 sc1
    buffer_load_dwordx4 v[80:83], v8, s[4:7], s38 offen offset:256 sc1
    buffer_load_dwordx4 v[68:71], v8, s[4:7], s38 offen offset:2048 sc1
    buffer_load_dwordx4 v[84:87], v8, s[4:7], s38 offen offset:2304 sc1
    buffer_load_dwordx4 v[72:75], v8, s[4:7], s21 offen offset:0 sc1
    buffer_load_dwordx4 v[88:91], v8, s[4:7], s21 offen offset:256 sc1
    buffer_load_dwordx4 v[76:79], v8, s[4:7], s21 offen offset:2048 sc1
    buffer_load_dwordx4 v[92:95], v8, s[4:7], s21 offen offset:2304 sc1
    buffer_load_dwordx4 v[96:99], v8, s[4:7], s39 offen offset:0 sc1
    buffer_load_dwordx4 v[100:103], v8, s[4:7], s39 offen offset:256 sc1
    s_add_u32 s38, s38, 262144
    s_add_u32 s39, s39, 262144
ch_kv0:
    s_add_u32 s21, s33, s36
    s_branch ch_att2
ch_loop_g:
    v_mov_b32 v16, 0
    v_mov_b32 v17, 0
    v_mov_b32 v18, 0
    v_mov_b32 v19, 0
    v_mov_b32 v20, 0
    v_mov_b32 v21, 0
    v_mov_b32 v22, 0
    v_mov_b32 v23, 0
    v_mov_b32 v24, 0
    v_mov_b32 v25, 0
    v_mov_b32 v26, 0
    v_mov_b32 v27, 0
    v_mov_b32 v28, 0
    v_mov_b32 v29, 0
    v_mov_b32 v30, 0
    v_mov_b32 v31, 0
    v_mov_b32 v140, 0
    v_mov_b32 v141, 0
    v_mov_b32 v142, 0
    v_mov_b32 v143, 0
    v_mov_b32 v144, 0
    v_mov_b32 v145, 0
    v_mov_b32 v146, 0
    v_mov_b32 v147, 0
chk_1_g:
    s_waitcnt vmcnt(1)
    v_max3_u32 v48, v40, v41, v42
    v_max_u32 v48, v48, v43
    v_cmp_eq_u32 vcc, -1, v48
    s_cbranch_vccnz rt_5_g
go_3_g:
    v_smfmac_f32_16x16x64_bf16 v[16:19], v[40:43], v[160:167], v2
    v_smfmac_f32_16x16x64_bf16 v[20:23], v[40:43], v[168:175], v2
    v_smfmac_f32_16x16x64_bf16 v[24:27], v[40:43], v[176:183], v2
    v_smfmac_f32_16x16x64_bf16 v[28:31], v[40:43], v[184:191], v2
chk_2_g:
    s_waitcnt vmcnt(0)
    v_max3_u32 v48, v44, v45, v46
    v_max_u32 v48, v48, v47
    v_cmp_eq_u32 vcc, -1, v48
    s_cbranch_vccnz rt_6_g
go_4_g:
    v_smfmac_f32_16x16x64_bf16 v[16:19], v[44:47], v[192:199], v2
    v_smfmac_f32_16x16x64_bf16 v[20:23], v[44:47], v[200:207], v2
    v_smfmac_f32_16x16x64_bf16 v[24:27], v[44:47], v[208:215], v2
    v_smfmac_f32_16x16x64_bf16 v[28:31], v[44:47], v[216:223], v2
    s_nop 4
    v_permlane32_swap_b32 v16, v18
    v_permlane32_swap_b32 v17, v19
    v_add_f32 v32, v16, v18
    v_add_f32 v34, v17, v19
    v_permlane32_swap_b32 v20, v22
    v_permlane32_swap_b32 v21, v23
    v_add_f32 v33, v20, v22
    v_add_f32 v35, v21, v23
    ds_write_b128 v52, v[32:35] offset:0
    v_permlane32_swap_b32 v24, v26
    v_permlane32_swap_b32 v25, v27
    v_add_f32 v36, v24, v26
    v_add_f32 v38, v25, v27
    v_permlane32_swap_b32 v28, v30
    v_permlane32_swap_b32 v29, v31
    v_add_f32 v37, v28, v30
    v_add_f32 v39, v29, v31
    ds_write_b128 v52, v[36:39] offset:1024
    v_smfmac_f32_16x16x64_bf16 v[140:143], v[40:43], v[224:231], v2
    v_smfmac_f32_16x16x64_bf16 v[144:147], v[40:43], v[232:239], v2
    v_smfmac_f32_16x16x64_bf16 v[140:143], v[44:47], v[240:247], v2
    v_smfmac_f32_16x16x64_bf16 v[144:147], v[44:47], v[248:255], v2
    s_cmp_ge_u32 s20, 4
    s_waitcnt lgkmcnt(0)
    s_barrier
    s_nop 2
    s_cbranch_scc1 ch_pv_g
    ds_read_b64 v[16:17], v5 offset:0
    ds_read_b64 v[18:19], v5 offset:2048
    ds_read_b64 v[20:21], v5 offset:4096
    ds_read_b64 v[22:23], v5 offset:6144
    ds_read_b64 v[24:25], v5 offset:8192
    ds_read_b64 v[26:27], v5 offset:10240
    ds_read_b64 v[28:29], v5 offset:12288
    ds_read_b64 v[30:31], v5 offset:14336
    s_waitcnt lgkmcnt(6)
    v_pk_add_f32 v[16:17], v[16:17], v[18:19]
    s_waitcnt lgkmcnt(4)
    v_pk_add_f32 v[20:21], v[20:21], v[22:23]
    v_pk_add_f32 v[16:17], v[16:17], v[20:21]
    s_waitcnt lgkmcnt(2)
    v_pk_add_f32 v[24:25], v[24:25], v[26:27]
    s_waitcnt lgkmcnt(0)
    v_pk_add_f32 v[28:29], v[28:29], v[30:31]
    v_pk_add_f32 v[24:25], v[24:25], v[28:29]
    v_pk_add_f32 v[16:17], v[16:17], v[24:25]
    v_cvt_pk_bf16_f32 v16, v16, v17
    buffer_store_dword v16, v4, s[4:7], s97 offen sc1
ch_pv_g:
    v_permlane32_swap_b32 v140, v142
    v_permlane32_swap_b32 v141, v143
    v_permlane32_swap_b32 v144, v146
    v_permlane32_swap_b32 v145, v147
    v_pk_add_f32 v[32:33], v[140:141], v[142:143]
    v_pk_add_f32 v[34:35], v[144:145], v[146:147]
    ds_write_b128 v11, v[32:35] offset:24576
    s_add_u32 s21, s33, s36
    s_cmp_lg_u32 s77, 1
    s_waitcnt lgkmcnt(0)
    s_barrier
    s_cbranch_scc1 ch_oth_g
ch_att2_g:
    buffer_load_dwordx4 v[112:115], v3, s[4:7], s21 offen offset:0 sc1
    buffer_load_dwordx4 v[116:119], v3, s[4:7], s21 offen offset:1024 sc1
    buffer_load_dwordx4 v[120:123], v3, s[4:7], s21 offen offset:2048 sc1
    buffer_load_dwordx4 v[124:127], v3, s[4:7], s21 offen offset:3072 sc1
    ds_read_b128 v[16:19], v10 offset:24576
    ds_read_b128 v[20:23], v10 offset:25600
    ds_read_b128 v[24:27], v10 offset:26624
    ds_read_b128 v[28:31], v10 offset:27648
    ds_read_b128 v[32:35], v10 offset:28672
    ds_read_b128 v[36:39], v10 offset:29696
    ds_read_b128 v[40:43], v10 offset:30720
    ds_read_b128 v[44:47], v10 offset:31744
    s_waitcnt lgkmcnt(6)
    v_pk_add_f32 v[16:17], v[16:17], v[20:21]
    v_pk_add_f32 v[18:19], v[18:19], v[22:23]
    s_waitcnt lgkmcnt(4)
    v_pk_add_f32 v[24:25], v[24:25], v[28:29]
    v_pk_add_f32 v[26:27], v[26:27], v[30:31]
    v_pk_add_f32 v[16:17], v[16:17], v[24:25]
    v_pk_add_f32 v[18:19], v[18:19], v[26:27]
    s_waitcnt lgkmcnt(2)
    v_pk_add_f32 v[32:33], v[32:33], v[36:37]
    v_pk_add_f32 v[34:35], v[34:35], v[38:39]
    s_waitcnt lgkmcnt(0)
    v_pk_add_f32 v[40:41], v[40:41], v[44:45]
    v_pk_add_f32 v[42:43], v[42:43], v[46:47]
    v_pk_add_f32 v[32:33], v[32:33], v[40:41]
    v_pk_add_f32 v[34:35], v[34:35], v[42:43]
    v_pk_add_f32 v[16:17], v[16:17], v[32:33]
    v_pk_add_f32 v[18:19], v[18:19], v[34:35]
    v_cvt_pk_bf16_f32 v128, v16, v17
    v_cvt_pk_bf16_f32 v129, v18, v19
chk_9_g:
    s_waitcnt vmcnt(3)
    v_max3_u32 v30, v112, v113, v114
    v_max_u32 v30, v30, v115
    v_cmp_eq_u32 vcc, -1, v30
    s_cbranch_vccnz rt_17_g
go_13_g:
    v_mfma_f32_16x16x32_bf16 v[16:19], v[112:115], v[112:115], v[132:135]
    v_mfma_f32_16x16x32_bf16 v[20:23], v[64:67], v[112:115], 0
    v_mfma_f32_16x16x32_bf16 v[24:27], v[80:83], v[112:115], 0
chk_10_g:
    s_waitcnt vmcnt(2)
    v_max3_u32 v30, v116, v117, v118
    v_max_u32 v30, v30, v119
    v_cmp_eq_u32 vcc, -1, v30
    s_cbranch_vccnz rt_18_g
go_14_g:
    v_mfma_f32_16x16x32_bf16 v[16:19], v[116:119], v[116:119], v[16:19]
    v_mfma_f32_16x16x32_bf16 v[20:23], v[68:71], v[116:119], v[20:23]
    v_mfma_f32_16x16x32_bf16 v[24:27], v[84:87], v[116:119], v[24:27]
chk_11_g:
    s_waitcnt vmcnt(1)
    v_max3_u32 v30, v120, v121, v122
    v_max_u32 v30, v30, v123
    v_cmp_eq_u32 vcc, -1, v30
    s_cbranch_vccnz rt_19_g
go_15_g:
    v_mfma_f32_16x16x32_bf16 v[16:19], v[120:123], v[120:123], v[16:19]
    v_mfma_f32_16x16x32_bf16 v[20:23], v[72:75], v[120:123], v[20:23]
    v_mfma_f32_16x16x32_bf16 v[24:27], v[88:91], v[120:123], v[24:27]
chk_12_g:
    s_waitcnt vmcnt(0)
    v_max3_u32 v30, v124, v125, v126
    v_max_u32 v30, v30, v127
    v_cmp_eq_u32 vcc, -1, v30
    s_cbranch_vccnz rt_20_g
go_16_g:
    v_mfma_f32_16x16x32_bf16 v[16:19], v[124:127], v[124:127], v[16:19]
    v_mfma_f32_16x16x32_bf16 v[20:23], v[76:79], v[124:127], v[20:23]
    v_mfma_f32_16x16x32_bf16 v[24:27], v[92:95], v[124:127], v[24:27]
    v_mov_b32 v47, 0
    s_nop 4
    v_max3_f32 v30, v16, v17, v18
    v_max3_f32 v31, v19, v20, v21
    v_max3_f32 v30, v30, v22, v23
    v_max3_f32 v31, v31, v24, v25
    v_max3_f32 v30, v30, v26, v27
    v_max_f32 v30, v30, v31
    v_mov_b32 v31, v30
    s_nop 1
    v_permlane32_swap_b32 v30, v31
    v_max_f32 v30, v30, v31
    v_mov_b32 v31, v30
    s_nop 1
    v_permlane16_swap_b32 v30, v31
    v_max_f32 v30, v30, v31
    v_mul_f32 v30, s37, v30
    v_pk_fma_f32 v[20:21], v[20:21], s[94:95], v[30:31] op_sel_hi:[1,1,0] neg_lo:[0,0,1] neg_hi:[0,0,1]
    v_pk_fma_f32 v[22:23], v[22:23], s[94:95], v[30:31] op_sel_hi:[1,1,0] neg_lo:[0,0,1] neg_hi:[0,0,1]
    v_pk_fma_f32 v[24:25], v[24:25], s[94:95], v[30:31] op_sel_hi:[1,1,0] neg_lo:[0,0,1] neg_hi:[0,0,1]
    v_pk_fma_f32 v[26:27], v[26:27], s[94:95], v[30:31] op_sel_hi:[1,1,0] neg_lo:[0,0,1] neg_hi:[0,0,1]
    v_pk_fma_f32 v[16:17], v[16:17], s[94:95], v[30:31] op_sel_hi:[1,1,0] neg_lo:[0,0,1] neg_hi:[0,0,1]
    v_pk_fma_f32 v[18:19], v[18:19], s[94:95], v[30:31] op_sel_hi:[1,1,0] neg_lo:[0,0,1] neg_hi:[0,0,1]
    v_exp_f32 v20, v20
    v_exp_f32 v21, v21
    v_exp_f32 v22, v22
    v_exp_f32 v23, v23
    v_exp_f32 v24, v24
    v_exp_f32 v25, v25
    v_exp_f32 v26, v26
    v_exp_f32 v27, v27
    v_exp_f32 v16, v16
    v_cvt_pk_bf16_f32 v40, v20, v21
    v_cvt_pk_bf16_f32 v41, v22, v23
    v_cvt_pk_bf16_f32 v42, v24, v25
    v_cvt_pk_bf16_f32 v43, v26, v27
    v_exp_f32 v17, v17
    v_exp_f32 v18, v18
    v_mfma_f32_16x16x32_bf16 v[64:67], v[96:99], v[40:43], 0
    v_exp_f32 v19, v19
    v_pk_add_f32 v[20:21], v[20:21], v[22:23]
    v_cvt_pk_bf16_f32 v44, v16, v17
    v_cvt_pk_bf16_f32 v45, v18, v19
    v_pk_add_f32 v[24:25], v[24:25], v[26:27]
    v_pk_add_f32 v[16:17], v[16:17], v[18:19]
    v_mfma_f32_16x16x32_bf16 v[68:71], v[100:103], v[40:43], 0
    v_permlane32_swap_b32 v44, v45
    v_pk_add_f32 v[20:21], v[20:21], v[24:25]
    v_mov_b32 v46, v45
    v_pk_add_f32 v[16:17], v[16:17], v[20:21]
    v_add_f32 v16, v16, v17
    v_mfma_f32_16x16x16_bf16 v[64:67], v[128:129], v[46:47], v[64:67]
    v_mov_b32 v17, v16
    s_nop 1
    v_permlane32_swap_b32 v16, v17
    v_add_f32 v16, v16, v17
    v_mov_b32 v17, v16
    v_mfma_f32_16x16x16_bf16 v[68:71], v[128:129], v[44:45], v[68:71]
    s_nop 0
    v_permlane16_swap_b32 v16, v17
    v_add_f32 v16, v16, v17
    v_rcp_f32 v16, v16
    s_nop 0
    v_pk_mul_f32 v[64:65], v[64:65], v[16:17] op_sel_hi:[1,0]
    v_pk_mul_f32 v[66:67], v[66:67], v[16:17] op_sel_hi:[1,0]
    s_nop 0
    v_pk_mul_f32 v[68:69], v[68:69], v[16:17] op_sel_hi:[1,0]
    v_pk_mul_f32 v[70:71], v[70:71], v[16:17] op_sel_hi:[1,0]
    v_cvt_pk_bf16_f32 v32, v64, v68
    v_cvt_pk_bf16_f32 v33, v65, v69
    v_cvt_pk_bf16_f32 v34, v66, v70
    v_cvt_pk_bf16_f32 v35, v67, v71
    buffer_store_dwordx4 v[32:35], v9, s[4:7], s33 offen offset:0 sc1
ch_ba_g:
    s_barrier
ch_o_g:
    s_add_u32 s22, s33, s76
    buffer_load_dwordx4 v[12:15], v3, s[4:7], s22 offen sc1
    s_sleep 2
    buffer_load_dwordx4 v[56:59], v3, s[4:7], s22 offen sc1
    v_mov_b32 v16, 0
    v_mov_b32 v17, 0
    v_mov_b32 v18, 0
    v_mov_b32 v19, 0
ch_op_g:
    s_waitcnt vmcnt(1)
    ds_write_b128 v11, v[12:15] offset:16384
    v_max3_u32 v40, v12, v13, v14
    v_max_u32 v40, v40, v15
    v_cmp_eq_u32 vcc, -1, v40
    s_cbranch_vccz ch_oq_g
    buffer_load_dwordx4 v[12:15], v3, s[4:7], s22 offen sc1
    s_waitcnt vmcnt(1)
    ds_write_b128 v11, v[56:59] offset:16384
    v_max3_u32 v40, v56, v57, v58
    v_max_u32 v40, v40, v59
    v_cmp_eq_u32 vcc, -1, v40
    s_cbranch_vccz ch_oq_g
    buffer_load_dwordx4 v[56:59], v3, s[4:7], s22 offen sc1
    s_sub_u32 s35, s35, 1
    s_cbranch_scc0 ch_op_g
    s_mov_b32 s35, 0
ch_oq_g:
    s_lshl_b32 s85, s34, 17
    s_add_u32 s22, s85, s43
    s_add_u32 s96, s88, s42
    s_cmp_lt_u32 s20, 4
    s_waitcnt lgkmcnt(0)
    s_barrier
    s_cbranch_scc1 ch_red_g
    ds_read_b128 v[20:23], v10 offset:16384
    ds_read_b128 v[24:27], v10 offset:17408
    ds_read_b128 v[28:31], v10 offset:18432
    ds_read_b128 v[32:35], v10 offset:19456
    ds_read_b128 v[36:39], v10 offset:20480
    ds_read_b128 v[40:43], v10 offset:21504
    ds_read_b128 v[44:47], v10 offset:22528
    ds_read_b128 v[48:51], v10 offset:23552
    s_waitcnt lgkmcnt(7)
    v_smfmac_f32_16x16x64_bf16 v[16:19], v[20:23], v[64:71], v2
    s_waitcnt lgkmcnt(6)
    v_smfmac_f32_16x16x64_bf16 v[16:19], v[24:27], v[72:79], v2
    s_waitcnt lgkmcnt(5)
    v_smfmac_f32_16x16x64_bf16 v[16:19], v[28:31], v[80:87], v2
    s_waitcnt lgkmcnt(4)
    v_smfmac_f32_16x16x64_bf16 v[16:19], v[32:35], v[88:95], v2
    s_waitcnt lgkmcnt(3)
    v_smfmac_f32_16x16x64_bf16 v[16:19], v[36:39], v[96:103], v2
    s_waitcnt lgkmcnt(2)
    v_smfmac_f32_16x16x64_bf16 v[16:19], v[40:43], v[104:111], v2
    s_waitcnt lgkmcnt(1)
    v_smfmac_f32_16x16x64_bf16 v[16:19], v[44:47], v[112:119], v2
    s_waitcnt lgkmcnt(0)
    v_smfmac_f32_16x16x64_bf16 v[16:19], v[48:51], v[120:127], v2
    s_nop 7
    v_permlane32_swap_b32 v16, v18
    v_permlane32_swap_b32 v17, v19
    v_pk_add_f32 v[16:17], v[16:17], v[18:19]
    v_cvt_pk_bf16_f32 v16, v16, v17
    buffer_store_dword v16, v6, s[4:7], s85 offen sc1
    s_barrier
    s_cmp_eq_u32 s20, 6
    s_cbranch_scc1 ch_h6_g
    s_cmp_eq_u32 s20, 7
    s_cbranch_scc1 ch_h7_g
    s_cmp_eq_u32 s20, 4
    s_cbranch_scc1 ch_h4_g
    s_add_u32 s22, s74, s78
    buffer_store_dwordx2 v[128:129], v62, s[4:7], s22 offen sc1
    s_lshl_b32 s21, s45, 10
    s_add_u32 s21, s21, s74
    s_add_u32 s74, s74, 0x30000
    buffer_store_dwordx4 v[148:151], v3, s[4:7], s21 offen sc1
    s_branch ch_next_g
ch_h4_g:
    s_cmp_eq_u32 s45, 1
    s_cbranch_scc1 ch_h41_g
    s_cmp_lg_u32 s45, 2
    s_cbranch_scc1 ch_next_g
    s_cmp_eq_u32 s34, 62
    s_cbranch_scc1 ch_next_g
    s_add_u32 s98, s34, 2
    s_and_b32 s99, s98, 7
    s_cmp_lg_u32 s99, 0
    s_cbranch_scc1 kvok_21_g
    s_lshl_b32 s98, s98, 9
    s_lshr_b32 s99, s46, 1
    s_lshl_b32 s99, s99, 7
    s_add_u32 s98, s98, s99
    s_add_u32 s98, s98, 167772160
    v_mov_b32 v30, 0
kvp_22_g:
    buffer_load_dword v16, v30, s[4:7], s98 offen sc1
    buffer_load_dword v17, v30, s[4:7], s98 offen offset:2048 sc1
    s_waitcnt vmcnt(0)
    v_min_u32 v16, v16, v17
    v_cmp_gt_u32 vcc, 4, v16
    s_cbranch_vccz kvok_21_g
    s_sleep 2
    s_sub_u32 s35, s35, 1
    s_cbranch_scc0 kvp_22_g
    s_mov_b32 s35, 0
kvok_21_g:
    s_branch ch_next_g
ch_h41_g:
    v_mov_b32 v55, s34
    buffer_store_dword v55, v54, s[4:7], s86 offen sc1
    s_branch ch_next_g
ch_h6_g:
    s_add_u32 s22, s23, s90
    buffer_store_dwordx4 v[136:139], v3, s[4:7], s22 offen sc1
    s_add_u32 s22, s23, s91
    buffer_store_dwordx4 v[136:139], v3, s[4:7], s22 offen sc1
    s_branch ch_next_g
ch_h7_g:
    buffer_store_dwordx4 v[136:139], v9, s[4:7], s23 offen sc1
    buffer_store_dwordx4 v[136:139], v63, s[4:7], s25 offen sc1
    s_add_u32 s25, s25, 0x20000
    s_branch ch_next_g
ch_red_g:
    s_barrier
    s_cmp_eq_u32 s79, 0
    s_cbranch_scc1 ch_rs_g
    s_add_u32 s21, s38, 4096
    buffer_load_dwordx4 v[64:67], v8, s[4:7], s38 offen offset:0 sc1
    buffer_load_dwordx4 v[80:83], v8, s[4:7], s38 offen offset:256 sc1
    buffer_load_dwordx4 v[68:71], v8, s[4:7], s38 offen offset:2048 sc1
    buffer_load_dwordx4 v[84:87], v8, s[4:7], s38 offen offset:2304 sc1
    buffer_load_dwordx4 v[72:75], v8, s[4:7], s21 offen offset:0 sc1
    buffer_load_dwordx4 v[88:91], v8, s[4:7], s21 offen offset:256 sc1
    buffer_load_dwordx4 v[76:79], v8, s[4:7], s21 offen offset:2048 sc1
    buffer_load_dwordx4 v[92:95], v8, s[4:7], s21 offen offset:2304 sc1
    buffer_load_dwordx4 v[96:99], v8, s[4:7], s39 offen offset:0 sc1
    buffer_load_dwordx4 v[100:103], v8, s[4:7], s39 offen offset:256 sc1
    s_add_u32 s38, s38, 262144
    s_add_u32 s39, s39, 262144
    s_sleep 8
    s_branch ch_rs2_g
ch_rs_g:
    s_sleep 10
ch_rs2_g:
    buffer_load_dwordx4 v[16:19], v3, s[4:7], s22 offen offset:0 sc1
    buffer_load_dwordx4 v[20:23], v3, s[4:7], s22 offen offset:1024 sc1
chk_23_g:
    s_waitcnt vmcnt(1)
    v_max3_u32 v30, v16, v17, v18
    v_max_u32 v30, v30, v19
    v_cmp_eq_u32 vcc, -1, v30
    s_cbranch_vccnz rt_27_g
go_25_g:
    v_lshlrev_b32 v32, 16, v16
    v_and_b32 v36, 0xffff0000, v16
    v_lshlrev_b32 v33, 16, v17
    v_and_b32 v37, 0xffff0000, v17
    v_lshlrev_b32 v34, 16, v18
    v_and_b32 v38, 0xffff0000, v18
    v_lshlrev_b32 v35, 16, v19
    v_and_b32 v39, 0xffff0000, v19
chk_24_g:
    s_waitcnt vmcnt(0)
    v_max3_u32 v30, v20, v21, v22
    v_max_u32 v30, v30, v23
    v_cmp_eq_u32 vcc, -1, v30
    s_cbranch_vccnz rt_28_g
go_26_g:
    v_lshlrev_b32 v40, 16, v20
    v_and_b32 v44, 0xffff0000, v20
    v_lshlrev_b32 v41, 16, v21
    v_and_b32 v45, 0xffff0000, v21
    v_lshlrev_b32 v42, 16, v22
    v_and_b32 v46, 0xffff0000, v22
    v_lshlrev_b32 v43, 16, v23
    v_and_b32 v47, 0xffff0000, v23
    v_pk_add_f32 v[32:33], v[32:33], v[40:41]
    v_pk_add_f32 v[34:35], v[34:35], v[42:43]
    v_pk_add_f32 v[36:37], v[36:37], v[44:45]
    v_pk_add_f32 v[38:39], v[38:39], v[46:47]
    s_nop 0
    v_permlane32_swap_b32 v32, v36
    v_permlane32_swap_b32 v33, v37
    v_permlane32_swap_b32 v34, v38
    v_permlane32_swap_b32 v35, v39
    v_pk_add_f32 v[32:33], v[32:33], v[36:37]
    v_pk_add_f32 v[34:35], v[34:35], v[38:39]
    s_nop 1
    v_permlane16_swap_b32 v32, v34
    v_permlane16_swap_b32 v33, v35
    v_pk_add_f32 v[32:33], v[32:33], v[34:35]
    v_cvt_pk_bf16_f32 v50, v32, v33
    buffer_store_dword v50, v7, s[4:7], s88 offen sc1
ch_next_g:
    s_barrier
    buffer_load_dwordx4 v[40:43], v3, s[4:7], s96 offen offset:0 sc1
    buffer_load_dwordx4 v[44:47], v3, s[4:7], s96 offen offset:1024 sc1
    s_mov_b32 s21, s89
    s_mov_b32 s89, s33
    s_mov_b32 s33, s88
    s_mov_b32 s88, s23
    s_mov_b32 s23, s21
    s_add_u32 s34, s34, 1
    s_mov_b32 s97, s33
    s_mov_b32 s77, s79
    s_cmp_lg_u32 s34, 63
    s_cbranch_scc1 ch_loop_g
    s_mov_b32 s77, 0
    s_mov_b32 s97, 104529920
    s_branch ch_loop_g
rt_5_g:
    s_sub_u32 s35, s35, 1
    s_cbranch_scc1 rt_5x_g
    buffer_load_dwordx4 v[40:43], v3, s[4:7], s96 offen offset:0 sc1
    s_waitcnt vmcnt(1)
    v_max3_u32 v48, v44, v45, v46
    v_max_u32 v48, v48, v47
    v_cmp_eq_u32 vcc, -1, v48
    s_cbranch_vccz rs_29_g
    buffer_load_dwordx4 v[44:47], v3, s[4:7], s96 offen offset:1024 sc1
rs_29_g:
    s_waitcnt vmcnt(0)
    s_branch chk_1_g
rt_5x_g:
    s_mov_b32 s35, 0
    s_branch go_3_g
rt_6_g:
    s_sub_u32 s35, s35, 1
    s_cbranch_scc1 rt_6x_g
    buffer_load_dwordx4 v[44:47], v3, s[4:7], s96 offen offset:1024 sc1
    s_waitcnt vmcnt(0)
    s_branch chk_2_g
rt_6x_g:
    s_mov_b32 s35, 0
    s_branch go_4_g
rt_17_g:
    s_sub_u32 s35, s35, 1
    s_cbranch_scc1 rt_17x_g
    buffer_load_dwordx4 v[112:115], v3, s[4:7], s21 offen offset:0 sc1
    buffer_load_dwordx4 v[116:119], v3, s[4:7], s21 offen offset:1024 sc1
    buffer_load_dwordx4 v[120:123], v3, s[4:7], s21 offen offset:2048 sc1
    buffer_load_dwordx4 v[124:127], v3, s[4:7], s21 offen offset:3072 sc1
    s_branch chk_9_g
rt_17x_g:
    s_mov_b32 s35, 0
    s_branch go_13_g
rt_18_g:
    s_sub_u32 s35, s35, 1
    s_cbranch_scc1 rt_18x_g
    buffer_load_dwordx4 v[116:119], v3, s[4:7], s21 offen offset:1024 sc1
    buffer_load_dwordx4 v[120:123], v3, s[4:7], s21 offen offset:2048 sc1
    buffer_load_dwordx4 v[124:127], v3, s[4:7], s21 offen offset:3072 sc1
    s_branch chk_10_g
rt_18x_g:
    s_mov_b32 s35, 0
    s_branch go_14_g
rt_19_g:
    s_sub_u32 s35, s35, 1
    s_cbranch_scc1 rt_19x_g
    buffer_load_dwordx4 v[120:123], v3, s[4:7], s21 offen offset:2048 sc1
    buffer_load_dwordx4 v[124:127], v3, s[4:7], s21 offen offset:3072 sc1
    s_branch chk_11_g
rt_19x_g:
    s_mov_b32 s35, 0
    s_branch go_15_g
rt_20_g:
    s_sub_u32 s35, s35, 1
    s_cbranch_scc1 rt_20x_g
    buffer_load_dwordx4 v[124:127], v3, s[4:7], s21 offen offset:3072 sc1
    s_branch chk_12_g
rt_20x_g:
    s_mov_b32 s35, 0
    s_branch go_16_g
rt_27_g:
    s_sub_u32 s35, s35, 1
    s_cbranch_scc1 rt_27x_g
    buffer_load_dwordx4 v[16:19], v3, s[4:7], s22 offen offset:0 sc1
    s_waitcnt vmcnt(1)
    v_max3_u32 v30, v20, v21, v22
    v_max_u32 v30, v30, v23
    v_cmp_eq_u32 vcc, -1, v30
    s_cbranch_vccz rs_30_g
    buffer_load_dwordx4 v[20:23], v3, s[4:7], s22 offen offset:1024 sc1
rs_30_g:
    s_waitcnt vmcnt(0)
    s_branch chk_23_g
rt_27x_g:
    s_mov_b32 s35, 0
    s_branch go_25_g
rt_28_g:
    s_sub_u32 s35, s35, 1
    s_cbranch_scc1 rt_28x_g
    buffer_load_dwordx4 v[20:23], v3, s[4:7], s22 offen offset:1024 sc1
    s_waitcnt vmcnt(0)
    s_branch chk_24_g
rt_28x_g:
    s_mov_b32 s35, 0
    s_branch go_26_g
ch_oth_g:
    s_cmp_eq_u32 s79, 1
    s_cbranch_scc1 ch_att_g
    s_cmp_lg_u32 s20, 5
    s_cbranch_scc1 ch_n5_g
    ds_read_b128 v[16:19], v10 offset:24576
    ds_read_b128 v[20:23], v10 offset:25600
    ds_read_b128 v[24:27], v10 offset:26624
    ds_read_b128 v[28:31], v10 offset:27648
    ds_read_b128 v[32:35], v10 offset:28672
    ds_read_b128 v[36:39], v10 offset:29696
    ds_read_b128 v[40:43], v10 offset:30720
    ds_read_b128 v[44:47], v10 offset:31744
    s_waitcnt lgkmcnt(6)
    v_pk_add_f32 v[16:17], v[16:17], v[20:21]
    v_pk_add_f32 v[18:19], v[18:19], v[22:23]
    s_waitcnt lgkmcnt(4)
    v_pk_add_f32 v[24:25], v[24:25], v[28:29]
    v_pk_add_f32 v[26:27], v[26:27], v[30:31]
    v_pk_add_f32 v[16:17], v[16:17], v[24:25]
    v_pk_add_f32 v[18:19], v[18:19], v[26:27]
    s_waitcnt lgkmcnt(2)
    v_pk_add_f32 v[32:33], v[32:33], v[36:37]
    v_pk_add_f32 v[34:35], v[34:35], v[38:39]
    s_waitcnt lgkmcnt(0)
    v_pk_add_f32 v[40:41], v[40:41], v[44:45]
    v_pk_add_f32 v[42:43], v[42:43], v[46:47]
    v_pk_add_f32 v[32:33], v[32:33], v[40:41]
    v_pk_add_f32 v[34:35], v[34:35], v[42:43]
    v_pk_add_f32 v[16:17], v[16:17], v[32:33]
    v_pk_add_f32 v[18:19], v[18:19], v[34:35]
    v_cvt_pk_bf16_f32 v128, v16, v17
    v_cvt_pk_bf16_f32 v129, v18, v19
    s_cmp_eq_u32 s34, 63
    s_cbranch_scc1 ch_l5_g
    s_add_u32 s21, s33, s91
    s_barrier
    buffer_load_dwordx4 v[148:151], v3, s[4:7], s21 offen sc1
    s_branch ch_o_g
ch_l5_g:
    s_add_u32 s22, s74, s78
    buffer_store_dwordx2 v[128:129], v62, s[4:7], s22 offen sc1
ch_n5_g:
    s_cmp_eq_u32 s34, 63
    s_cbranch_scc1 ch_end
    s_branch ch_ba_g
ch_att_g:
    s_cmp_eq_u32 s34, 63
    s_cbranch_scc1 ch_end
    s_cmp_lg_u32 s34, 0
    s_cbranch_scc1 ch_kv0_g
    s_add_u32 s98, s34, 0
    s_and_b32 s99, s98, 7
    s_cmp_lg_u32 s99, 0
    s_cbranch_scc1 kvok_7_g
    s_lshl_b32 s98, s98, 9
    s_lshr_b32 s99, s46, 1
    s_lshl_b32 s99, s99, 7
    s_add_u32 s98, s98, s99
    s_add_u32 s98, s98, 167772160
    v_mov_b32 v30, 0
kvp_8_g:
    buffer_load_dword v16, v30, s[4:7], s98 offen sc1
    buffer_load_dword v17, v30, s[4:7], s98 offen offset:2048 sc1
    s_waitcnt vmcnt(0)
    v_min_u32 v16, v16, v17
    v_cmp_gt_u32 vcc, 4, v16
    s_cbranch_vccz kvok_7_g
    s_sleep 2
    s_sub_u32 s35, s35, 1
    s_cbranch_scc0 kvp_8_g
    s_mov_b32 s35, 0
kvok_7_g:
    s_add_u32 s21, s38, 4096
    buffer_load_dwordx4 v[64:67], v8, s[4:7], s38 offen offset:0 sc1
    buffer_load_dwordx4 v[80:83], v8, s[4:7], s38 offen offset:256 sc1
    buffer_load_dwordx4 v[68:71], v8, s[4:7], s38 offen offset:2048 sc1
    buffer_load_dwordx4 v[84:87], v8, s[4:7], s38 offen offset:2304 sc1
    buffer_load_dwordx4 v[72:75], v8, s[4:7], s21 offen offset:0 sc1
    buffer_load_dwordx4 v[88:91], v8, s[4:7], s21 offen offset:256 sc1
    buffer_load_dwordx4 v[76:79], v8, s[4:7], s21 offen offset:2048 sc1
    buffer_load_dwordx4 v[92:95], v8, s[4:7], s21 offen offset:2304 sc1
    buffer_load_dwordx4 v[96:99], v8, s[4:7], s39 offen offset:0 sc1
    buffer_load_dwordx4 v[100:103], v8, s[4:7], s39 offen offset:256 sc1
    s_add_u32 s38, s38, 262144
    s_add_u32 s39, s39, 262144
ch_kv0_g:
    s_add_u32 s21, s33, s36
    s_branch ch_att2_g
ch_end:
    s_endpgm
mk_worker:
    s_load_dwordx2 s[82:83], s[0:1], 104
    s_load_dwordx2 s[84:85], s[0:1], 88
    s_load_dwordx2 s[86:87], s[0:1], 16
    s_load_dwordx2 s[88:89], s[0:1], 24
    s_load_dwordx2 s[90:91], s[0:1], 32
    s_load_dwordx2 s[92:93], s[0:1], 40
    s_load_dwordx2 s[94:95], s[0:1], 64
    s_load_dwordx2 s[96:97], s[0:1], 72
    s_load_dwordx2 s[98:99], s[0:1], 80
    s_load_dwordx2 s[100:101], s[0:1], 0
    s_and_b32 s80, s2, 7
    s_lshr_b32 s81, s2, 3
    s_sub_u32 s81, s81, 16
    s_mov_b32 s78, 400000
    s_load_dwordx2 s[48:49], s[0:1], 96
    v_and_b32 v1, 7, v0
    v_bfe_u32 v2, v0, 3, 5
    v_lshrrev_b32 v4, 6, v0
    s_nop 0
    v_readfirstlane_b32 s20, v4
    s_sub_u32 s18, s2, 128
    s_lshl_b32 s18, s18, 1
    s_lshr_b32 s19, s20, 2
    s_add_u32 s18, s18, s19
    s_lshl_b32 s16, s18, 14
    v_lshlrev_b32 v3, 11, v1
    v_lshl_add_u32 v3, v2, 6, v3
    s_waitcnt lgkmcnt(0)
    s_mov_b32 s4, s82
    s_and_b32 s5, s83, 0xffff
    s_mov_b32 s6, 268435456
    s_mov_b32 s7, 0x00020000
    s_mov_b32 s12, s100
    s_and_b32 s13, s101, 0xffff
    s_mov_b32 s14, 4194304
    s_mov_b32 s15, 0x00020000
    s_mov_b32 s52, s48
    s_and_b32 s53, s49, 0xffff
    s_mov_b32 s54, 256
    s_mov_b32 s55, 0x00020000
    buffer_load_dwordx4 v[8:11], v3, s[12:15], s16 offen offset:0
    buffer_load_dwordx4 v[12:15], v3, s[12:15], s16 offen offset:16
    buffer_load_dwordx4 v[16:19], v3, s[12:15], s16 offen offset:32
    buffer_load_dwordx4 v[20:23], v3, s[12:15], s16 offen offset:48
    s_lshl_b32 s19, s19, 11
    s_waitcnt vmcnt(0)
mk_nw2:
mk_ln1:
    v_lshlrev_b32 v24, 16, v8
    v_and_b32 v25, 0xffff0000, v8
    v_lshlrev_b32 v26, 16, v9
    v_and_b32 v27, 0xffff0000, v9
    v_lshlrev_b32 v28, 16, v10
    v_and_b32 v29, 0xffff0000, v10
    v_lshlrev_b32 v30, 16, v11
    v_and_b32 v31, 0xffff0000, v11
    v_lshlrev_b32 v32, 16, v12
    v_and_b32 v33, 0xffff0000, v12
    v_lshlrev_b32 v34, 16, v13
    v_and_b32 v35, 0xffff0000, v13
    v_lshlrev_b32 v36, 16, v14
    v_and_b32 v37, 0xffff0000, v14
    v_lshlrev_b32 v38, 16, v15
    v_and_b32 v39, 0xffff0000, v15
    v_lshlrev_b32 v40, 16, v16
    v_and_b32 v41, 0xffff0000, v16
    v_lshlrev_b32 v42, 16, v17
    v_and_b32 v43, 0xffff0000, v17
    v_lshlrev_b32 v44, 16, v18
    v_and_b32 v45, 0xffff0000, v18
    v_lshlrev_b32 v46, 16, v19
    v_and_b32 v47, 0xffff0000, v19
    v_lshlrev_b32 v48, 16, v20
    v_and_b32 v49, 0xffff0000, v20
    v_lshlrev_b32 v50, 16, v21
    v_and_b32 v51, 0xffff0000, v21
    v_lshlrev_b32 v52, 16, v22
    v_and_b32 v53, 0xffff0000, v22
    v_lshlrev_b32 v54, 16, v23
    v_and_b32 v55, 0xffff0000, v23
    v_pk_add_f32 v[64:65], v[24:25], v[40:41]
    v_pk_add_f32 v[66:67], v[26:27], v[42:43]
    v_pk_add_f32 v[68:69], v[28:29], v[44:45]
    v_pk_add_f32 v[70:71], v[30:31], v[46:47]
    v_pk_add_f32 v[72:73], v[32:33], v[48:49]
    v_pk_add_f32 v[74:75], v[34:35], v[50:51]
    v_pk_add_f32 v[76:77], v[36:37], v[52:53]
    v_pk_add_f32 v[78:79], v[38:39], v[54:55]
    v_pk_add_f32 v[64:65], v[64:65], v[72:73]
    v_pk_add_f32 v[66:67], v[66:67], v[74:75]
    v_pk_add_f32 v[68:69], v[68:69], v[76:77]
    v_pk_add_f32 v[70:71], v[70:71], v[78:79]
    v_pk_add_f32 v[64:65], v[64:65], v[68:69]
    v_pk_add_f32 v[66:67], v[66:67], v[70:71]
    v_pk_add_f32 v[64:65], v[64:65], v[66:67]
    v_add_f32 v56, v64, v65
    v_mul_f32 v58, 0xbd000000, v56
    v_pk_add_f32 v[64:65], v[24:25], v[58:59] op_sel_hi:[1,0]
    v_pk_add_f32 v[66:67], v[26:27], v[58:59] op_sel_hi:[1,0]
    v_pk_add_f32 v[68:69], v[28:29], v[58:59] op_sel_hi:[1,0]
    v_pk_add_f32 v[70:71], v[30:31], v[58:59] op_sel_hi:[1,0]
    v_pk_add_f32 v[72:73], v[32:33], v[58:59] op_sel_hi:[1,0]
    v_pk_add_f32 v[74:75], v[34:35], v[58:59] op_sel_hi:[1,0]
    v_pk_add_f32 v[76:77], v[36:37], v[58:59] op_sel_hi:[1,0]
    v_pk_add_f32 v[78:79], v[38:39], v[58:59] op_sel_hi:[1,0]
    v_pk_add_f32 v[80:81], v[40:41], v[58:59] op_sel_hi:[1,0]
    v_pk_add_f32 v[82:83], v[42:43], v[58:59] op_sel_hi:[1,0]
    v_pk_add_f32 v[84:85], v[44:45], v[58:59] op_sel_hi:[1,0]
    v_pk_add_f32 v[86:87], v[46:47], v[58:59] op_sel_hi:[1,0]
    v_pk_add_f32 v[88:89], v[48:49], v[58:59] op_sel_hi:[1,0]
    v_pk_add_f32 v[90:91], v[50:51], v[58:59] op_sel_hi:[1,0]
    v_pk_add_f32 v[92:93], v[52:53], v[58:59] op_sel_hi:[1,0]
    v_pk_add_f32 v[94:95], v[54:55], v[58:59] op_sel_hi:[1,0]
    v_pk_mul_f32 v[96:97], v[64:65], v[64:65]
    v_pk_mul_f32 v[98:99], v[66:67], v[66:67]
    v_pk_fma_f32 v[96:97], v[68:69], v[68:69], v[96:97]
    v_pk_fma_f32 v[98:99], v[70:71], v[70:71], v[98:99]
    v_pk_fma_f32 v[96:97], v[72:73], v[72:73], v[96:97]
    v_pk_fma_f32 v[98:99], v[74:75], v[74:75], v[98:99]
    v_pk_fma_f32 v[96:97], v[76:77], v[76:77], v[96:97]
    v_pk_fma_f32 v[98:99], v[78:79], v[78:79], v[98:99]
    v_pk_fma_f32 v[96:97], v[80:81], v[80:81], v[96:97]
    v_pk_fma_f32 v[98:99], v[82:83], v[82:83], v[98:99]
    v_pk_fma_f32 v[96:97], v[84:85], v[84:85], v[96:97]
    v_pk_fma_f32 v[98:99], v[86:87], v[86:87], v[98:99]
    v_pk_fma_f32 v[96:97], v[88:89], v[88:89], v[96:97]
    v_pk_fma_f32 v[98:99], v[90:91], v[90:91], v[98:99]
    v_pk_fma_f32 v[96:97], v[92:93], v[92:93], v[96:97]
    v_pk_fma_f32 v[98:99], v[94:95], v[94:95], v[98:99]
    v_pk_add_f32 v[96:97], v[96:97], v[98:99]
    v_add_f32 v57, v96, v97
    v_mov_b32_dpp v58, v56 row_ror:8 row_mask:0xf bank_mask:0xf
    s_nop 0
    v_mov_b32_dpp v59, v57 row_ror:8 row_mask:0xf bank_mask:0xf
    v_sub_f32 v60, v56, v58
    v_pk_add_f32 v[56:57], v[56:57], v[58:59]
    v_mul_f32 v61, 0x3c800000, v60
    v_fmac_f32 v57, v60, v61
    v_mov_b32 v58, v56
    v_mov_b32 v59, v57
    s_nop 0
    v_permlane16_swap_b32 v56, v58
    v_permlane16_swap_b32 v57, v59
    v_sub_f32 v60, v56, v58
    v_pk_add_f32 v[56:57], v[56:57], v[58:59]
    v_mul_f32 v61, 0x3c000000, v60
    v_fmac_f32 v57, v60, v61
    v_mov_b32 v58, v56
    v_mov_b32 v59, v57
    s_nop 0
    v_permlane32_swap_b32 v56, v58
    v_permlane32_swap_b32 v57, v59
    v_sub_f32 v60, v56, v58
    v_pk_add_f32 v[56:57], v[56:57], v[58:59]
    v_mul_f32 v61, 0x3b800000, v60
    v_fmac_f32 v57, v60, v61
    v_lshlrev_b32 v62, 5, v1
    v_add_u32 v62, s19, v62
    v_and_b32 v63, 24, v2
    v_add_u32 v63, v62, v63
    ds_write_b64 v63, v[56:57]
    s_waitcnt lgkmcnt(0)
    s_barrier
    ds_read_b128 v[56:59], v62
    ds_read_b128 v[96:99], v62 offset:16
    s_waitcnt lgkmcnt(0)
    v_sub_f32 v60, v56, v58
    v_pk_add_f32 v[56:57], v[56:57], v[58:59]
    v_mul_f32 v61, 0x3b000000, v60
    v_fmac_f32 v57, v60, v61
    v_sub_f32 v60, v96, v98
    v_pk_add_f32 v[96:97], v[96:97], v[98:99]
    v_mul_f32 v61, 0x3b000000, v60
    v_fmac_f32 v97, v60, v61
    v_sub_f32 v60, v56, v96
    v_pk_add_f32 v[56:57], v[56:57], v[96:97]
    v_mul_f32 v61, 0x3a800000, v60
    v_fmac_f32 v57, v60, v61
    v_mul_f32 v56, 0x3a800000, v56
    v_mul_f32 v100, 0x3a800000, v57
    v_cvt_pk_bf16_f32 v101, v56, v100
    v_lshlrev_b32 v56, 16, v101
    v_and_b32 v100, 0xffff0000, v101
    v_add_f32 v100, 0x3727c5ac, v100
    v_cvt_pk_bf16_f32 v100, v100, v100
    v_and_b32 v100, 0xffff0000, v100
    v_sqrt_f32 v100, v100
    s_nop 0
    v_cvt_pk_bf16_f32 v100, v100, v100
    v_and_b32 v100, 0xffff0000, v100
    v_rcp_f32 v102, v100
    s_nop 0
    v_fma_f32 v103, -v100, v102, 2.0
    v_mul_f32 v102, v102, v103
    v_pk_add_f32 v[24:25], v[24:25], v[56:57] op_sel_hi:[1,0] neg_lo:[0,1] neg_hi:[0,1]
    v_cvt_pk_bf16_f32 v59, v24, v25
    v_lshlrev_b32 v24, 16, v59
    v_and_b32 v25, 0xffff0000, v59
    v_pk_mul_f32 v[24:25], v[24:25], v[102:103] op_sel_hi:[1,0]
    v_cvt_pk_bf16_f32 v64, v24, v25
    v_pk_add_f32 v[26:27], v[26:27], v[56:57] op_sel_hi:[1,0] neg_lo:[0,1] neg_hi:[0,1]
    v_cvt_pk_bf16_f32 v59, v26, v27
    v_lshlrev_b32 v26, 16, v59
    v_and_b32 v27, 0xffff0000, v59
    v_pk_mul_f32 v[26:27], v[26:27], v[102:103] op_sel_hi:[1,0]
    v_cvt_pk_bf16_f32 v65, v26, v27
    v_pk_add_f32 v[28:29], v[28:29], v[56:57] op_sel_hi:[1,0] neg_lo:[0,1] neg_hi:[0,1]
    v_cvt_pk_bf16_f32 v59, v28, v29
    v_lshlrev_b32 v28, 16, v59
    v_and_b32 v29, 0xffff0000, v59
    v_pk_mul_f32 v[28:29], v[28:29], v[102:103] op_sel_hi:[1,0]
    v_cvt_pk_bf16_f32 v68, v28, v29
    v_pk_add_f32 v[30:31], v[30:31], v[56:57] op_sel_hi:[1,0] neg_lo:[0,1] neg_hi:[0,1]
    v_cvt_pk_bf16_f32 v59, v30, v31
    v_lshlrev_b32 v30, 16, v59
    v_and_b32 v31, 0xffff0000, v59
    v_pk_mul_f32 v[30:31], v[30:31], v[102:103] op_sel_hi:[1,0]
    v_cvt_pk_bf16_f32 v69, v30, v31
    v_pk_add_f32 v[32:33], v[32:33], v[56:57] op_sel_hi:[1,0] neg_lo:[0,1] neg_hi:[0,1]
    v_cvt_pk_bf16_f32 v59, v32, v33
    v_lshlrev_b32 v32, 16, v59
    v_and_b32 v33, 0xffff0000, v59
    v_pk_mul_f32 v[32:33], v[32:33], v[102:103] op_sel_hi:[1,0]
    v_cvt_pk_bf16_f32 v72, v32, v33
    v_pk_add_f32 v[34:35], v[34:35], v[56:57] op_sel_hi:[1,0] neg_lo:[0,1] neg_hi:[0,1]
    v_cvt_pk_bf16_f32 v59, v34, v35
    v_lshlrev_b32 v34, 16, v59
    v_and_b32 v35, 0xffff0000, v59
    v_pk_mul_f32 v[34:35], v[34:35], v[102:103] op_sel_hi:[1,0]
    v_cvt_pk_bf16_f32 v73, v34, v35
    v_pk_add_f32 v[36:37], v[36:37], v[56:57] op_sel_hi:[1,0] neg_lo:[0,1] neg_hi:[0,1]
    v_cvt_pk_bf16_f32 v59, v36, v37
    v_lshlrev_b32 v36, 16, v59
    v_and_b32 v37, 0xffff0000, v59
    v_pk_mul_f32 v[36:37], v[36:37], v[102:103] op_sel_hi:[1,0]
    v_cvt_pk_bf16_f32 v76, v36, v37
    v_pk_add_f32 v[38:39], v[38:39], v[56:57] op_sel_hi:[1,0] neg_lo:[0,1] neg_hi:[0,1]
    v_cvt_pk_bf16_f32 v59, v38, v39
    v_lshlrev_b32 v38, 16, v59
    v_and_b32 v39, 0xffff0000, v59
    v_pk_mul_f32 v[38:39], v[38:39], v[102:103] op_sel_hi:[1,0]
    v_cvt_pk_bf16_f32 v77, v38, v39
    v_pk_add_f32 v[40:41], v[40:41], v[56:57] op_sel_hi:[1,0] neg_lo:[0,1] neg_hi:[0,1]
    v_cvt_pk_bf16_f32 v59, v40, v41
    v_lshlrev_b32 v40, 16, v59
    v_and_b32 v41, 0xffff0000, v59
    v_pk_mul_f32 v[40:41], v[40:41], v[102:103] op_sel_hi:[1,0]
    v_cvt_pk_bf16_f32 v66, v40, v41
    v_pk_add_f32 v[42:43], v[42:43], v[56:57] op_sel_hi:[1,0] neg_lo:[0,1] neg_hi:[0,1]
    v_cvt_pk_bf16_f32 v59, v42, v43
    v_lshlrev_b32 v42, 16, v59
    v_and_b32 v43, 0xffff0000, v59
    v_pk_mul_f32 v[42:43], v[42:43], v[102:103] op_sel_hi:[1,0]
    v_cvt_pk_bf16_f32 v67, v42, v43
    v_pk_add_f32 v[44:45], v[44:45], v[56:57] op_sel_hi:[1,0] neg_lo:[0,1] neg_hi:[0,1]
    v_cvt_pk_bf16_f32 v59, v44, v45
    v_lshlrev_b32 v44, 16, v59
    v_and_b32 v45, 0xffff0000, v59
    v_pk_mul_f32 v[44:45], v[44:45], v[102:103] op_sel_hi:[1,0]
    v_cvt_pk_bf16_f32 v70, v44, v45
    v_pk_add_f32 v[46:47], v[46:47], v[56:57] op_sel_hi:[1,0] neg_lo:[0,1] neg_hi:[0,1]
    v_cvt_pk_bf16_f32 v59, v46, v47
    v_lshlrev_b32 v46, 16, v59
    v_and_b32 v47, 0xffff0000, v59
    v_pk_mul_f32 v[46:47], v[46:47], v[102:103] op_sel_hi:[1,0]
    v_cvt_pk_bf16_f32 v71, v46, v47
    v_pk_add_f32 v[48:49], v[48:49], v[56:57] op_sel_hi:[1,0] neg_lo:[0,1] neg_hi:[0,1]
    v_cvt_pk_bf16_f32 v59, v48, v49
    v_lshlrev_b32 v48, 16, v59
    v_and_b32 v49, 0xffff0000, v59
    v_pk_mul_f32 v[48:49], v[48:49], v[102:103] op_sel_hi:[1,0]
    v_cvt_pk_bf16_f32 v74, v48, v49
    v_pk_add_f32 v[50:51], v[50:51], v[56:57] op_sel_hi:[1,0] neg_lo:[0,1] neg_hi:[0,1]
    v_cvt_pk_bf16_f32 v59, v50, v51
    v_lshlrev_b32 v50, 16, v59
    v_and_b32 v51, 0xffff0000, v59
    v_pk_mul_f32 v[50:51], v[50:51], v[102:103] op_sel_hi:[1,0]
    v_cvt_pk_bf16_f32 v75, v50, v51
    v_pk_add_f32 v[52:53], v[52:53], v[56:57] op_sel_hi:[1,0] neg_lo:[0,1] neg_hi:[0,1]
    v_cvt_pk_bf16_f32 v59, v52, v53
    v_lshlrev_b32 v52, 16, v59
    v_and_b32 v53, 0xffff0000, v59
    v_pk_mul_f32 v[52:53], v[52:53], v[102:103] op_sel_hi:[1,0]
    v_cvt_pk_bf16_f32 v78, v52, v53
    v_pk_add_f32 v[54:55], v[54:55], v[56:57] op_sel_hi:[1,0] neg_lo:[0,1] neg_hi:[0,1]
    v_cvt_pk_bf16_f32 v59, v54, v55
    v_lshlrev_b32 v54, 16, v59
    v_and_b32 v55, 0xffff0000, v59
    v_pk_mul_f32 v[54:55], v[54:55], v[102:103] op_sel_hi:[1,0]
    v_cvt_pk_bf16_f32 v79, v54, v55
    s_lshr_b32 s19, s18, 2
    s_lshl_b32 s19, s19, 16
    s_and_b32 s21, s18, 3
    s_lshl_b32 s21, s21, 7
    s_add_u32 s19, s19, s21
    v_lshlrev_b32 v3, 11, v2
    v_lshl_add_u32 v3, v1, 4, v3
    buffer_store_dwordx4 v[64:67], v3, s[4:7], s19 offen offset:0 sc1
    buffer_store_dwordx4 v[68:71], v3, s[4:7], s19 offen offset:512 sc1
    buffer_store_dwordx4 v[72:75], v3, s[4:7], s19 offen offset:1024 sc1
    buffer_store_dwordx4 v[76:79], v3, s[4:7], s19 offen offset:1536 sc1
    s_cmp_lg_u32 s20, 0
    s_cbranch_scc1 mk_ini
    v_and_b32 v4, 7, v0
    v_lshlrev_b32 v4, 2, v4
mk_inip:
    buffer_load_dword v5, v4, s[52:55], 0 offen sc1
    s_waitcnt vmcnt(0)
    v_and_b32 v5, 0xff, v5
    v_cmp_gt_u32 vcc, 16, v5
    s_cbranch_vccz mk_ini
    s_sleep 4
    s_sub_u32 s78, s78, 1
    s_cbranch_scc0 mk_inip
    s_mov_b32 s78, 0
mk_ini:
    v_and_b32 v47, 63, v0
    s_lshr_b32 s40, s18, 4
    s_lshl_b32 s40, s40, 7
    s_add_u32 s40, s40, 167874560
    v_mov_b32 v24, v8
    v_mov_b32 v25, v9
    v_mov_b32 v26, v16
    v_mov_b32 v27, v17
    v_mov_b32 v28, v10
    v_mov_b32 v29, v11
    v_mov_b32 v30, v18
    v_mov_b32 v31, v19
    v_mov_b32 v32, v12
    v_mov_b32 v33, v13
    v_mov_b32 v34, v20
    v_mov_b32 v35, v21
    v_mov_b32 v36, v14
    v_mov_b32 v37, v15
    v_mov_b32 v38, v22
    v_mov_b32 v39, v23
    v_mov_b32 v40, v3
    s_add_u32 s44, s19, 171966464
    s_waitcnt vmcnt(0)
    s_barrier
    s_cmp_lg_u32 s20, 0
    s_cbranch_scc1 sg_31
    v_min_u32 v1, 1, v47
    v_lshlrev_b32 v1, 30, v1
    v_mov_b32 v2, 1
    buffer_atomic_add v2, v1, s[4:7], s40 offen sc1
sg_31:
    v_and_b32 v47, 63, v0
    v_lshrrev_b32 v1, 6, v0
    s_nop 0
    v_readfirstlane_b32 s20, v1
    s_lshr_b32 s23, s20, 1
    s_mul_i32 s23, s23, 65536
    s_and_b32 s24, s20, 1
    s_lshl_b32 s24, s24, 11
    s_add_u32 s23, s23, s24
    v_lshlrev_b32 v48, 4, v47
    v_add_u32 v48, s23, v48
    s_mul_i32 s21, s20, 2048
    s_mul_i32 s22, s20, 2048
    s_add_u32 s22, s22, 16384
    s_mul_i32 s23, s20, 65536
    s_mov_b32 s24, 8192
    v_lshrrev_b32 v1, 4, v47
    v_and_b32 v2, 15, v47
    v_lshlrev_b32 v3, 2, v1
    v_xor_b32 v2, v2, v3
    v_mul_lo_u32 v1, v1, s24
    v_add_u32 v1, s23, v1
    v_lshl_add_u32 v49, v2, 4, v1
    v_add_u32 v50, 31744, v49
    s_lshr_b32 s23, s20, 2
    s_and_b32 s24, s20, 3
    s_mul_i32 s23, s23, 8192
    v_lshlrev_b32 v52, 4, v47
    v_add_u32 v52, s23, v52
    v_add_u32 v53, 65536, v52
    v_bfe_u32 v1, v47, 2, 2
    v_lshrrev_b32 v2, 5, v47
    v_lshl_add_u32 v2, v2, 2, v1
    v_mul_u32_u24 v2, 256, v2
    v_bfe_u32 v3, v47, 4, 1
    v_lshl_add_u32 v2, v3, 5, v2
    v_and_b32 v3, 3, v47
    v_lshl_add_u32 v2, v3, 3, v2
    s_mul_i32 s24, s24, 1
    s_add_u32 s25, s24, 0
    v_xor_b32 v3, s25, v1
    v_lshl_add_u32 v54, v3, 6, v2
    v_add_u32 v54, 16384, v54
    v_add_u32 v55, 65536, v54
    s_lshr_b32 s35, s81, 3
    s_and_b32 s36, s80, 3
    s_lshl_b32 s36, s36, 3
    s_and_b32 s34, s81, 7
    s_add_u32 s36, s36, s34
mk_kv0:
    s_cmp_ge_u32 s80, 4
    s_cselect_b32 s8, s90, s88
    s_cselect_b32 s9, s91, s89
    s_and_b32 s9, s9, 0xffff
    s_mov_b32 s10, 8388608
    s_mov_b32 s11, 0x00020000
    s_lshl_b32 s17, s36, 8
    s_add_u32 m0, s22, 0
    s_nop 0
    buffer_load_dwordx4 v49, s[8:11], s17 offen offset:0 lds
    buffer_load_dwordx4 v50, s[8:11], s17 offen offset:1024 lds
    s_add_u32 s17, s17, 524288
    s_add_u32 m0, s22, 32768
    s_nop 0
    buffer_load_dwordx4 v49, s[8:11], s17 offen offset:0 lds
    buffer_load_dwordx4 v50, s[8:11], s17 offen offset:1024 lds
    s_add_u32 s17, s17, 524288
    s_add_u32 m0, s22, 65536
    s_nop 0
    buffer_load_dwordx4 v49, s[8:11], s17 offen offset:0 lds
    buffer_load_dwordx4 v50, s[8:11], s17 offen offset:1024 lds
    s_add_u32 s17, s17, 524288
    s_add_u32 m0, s22, 98304
    s_nop 0
    buffer_load_dwordx4 v49, s[8:11], s17 offen offset:0 lds
    buffer_load_dwordx4 v50, s[8:11], s17 offen offset:1024 lds
    s_add_u32 s17, s17, 524288
    v_lshrrev_b32 v1, 3, v47
    v_and_b32 v2, 7, v47
    v_lshlrev_b32 v2, 4, v2
    v_lshl_add_u32 v2, v1, 13, v2
    s_lshl_b32 s23, s81, 19
    s_lshl_b32 s24, s20, 16
    s_add_u32 s23, s23, s24
    s_and_b32 s24, s80, 3
    s_lshl_b32 s24, s24, 11
    s_add_u32 s23, s23, s24
    buffer_load_dwordx4 v[160:163], v2, s[8:11], s23 offen offset:384
    buffer_load_dwordx4 v[160:163], v2, s[8:11], s23 offen offset:1408
    s_lshl_b32 s40, s35, 7
    s_add_u32 s40, s40, 167874560
    v_mov_b32 v3, 0
    s_cmp_lg_u32 s20, 0
    s_cbranch_scc1 mk_kvw
wf_32:
    buffer_load_dword v2, v3, s[4:7], s40 offen sc1
    s_waitcnt vmcnt(0)
    v_cmp_gt_u32 vcc, 8, v2
    s_cbranch_vccz wfo_33
    s_sleep 2
    s_sub_u32 s78, s78, 1
    s_cbranch_scc0 wf_32
    s_mov_b32 s78, 0
wfo_33:
mk_kvw:
    s_barrier
    s_mul_i32 s16, s35, 262144
    s_lshr_b32 s37, s20, 2
    s_mul_i32 s37, s37, 2
    s_mul_i32 s38, s35, 4
    s_add_u32 s37, s37, s38
    s_lshl_b32 s37, s37, 18
    s_and_b32 s38, s20, 3
    s_mul_i32 s38, s38, 1
    s_mul_i32 s39, s36, 4
    s_add_u32 s38, s38, s39
    s_lshl_b32 s38, s38, 11
    s_add_u32 s37, s37, s38
    s_cmp_ge_u32 s80, 4
    s_cbranch_scc1 mk_v0
    s_add_u32 s37, s37, 20971520
    s_add_u32 m0, s21, 0
    s_nop 0
    buffer_load_dwordx4 v48, s[4:7], s16 offen offset:0 sc1 lds
    buffer_load_dwordx4 v48, s[4:7], s16 offen offset:1024 sc1 lds
    s_add_u32 s16, s16, 4096
    s_add_u32 m0, s21, 32768
    s_nop 0
    buffer_load_dwordx4 v48, s[4:7], s16 offen offset:0 sc1 lds
    buffer_load_dwordx4 v48, s[4:7], s16 offen offset:1024 sc1 lds
    s_add_u32 s16, s16, 4096
    s_add_u32 m0, s21, 65536
    s_nop 0
    buffer_load_dwordx4 v48, s[4:7], s16 offen offset:0 sc1 lds
    buffer_load_dwordx4 v48, s[4:7], s16 offen offset:1024 sc1 lds
    s_add_u32 s16, s16, 4096
    s_add_u32 m0, s21, 98304
    s_nop 0
    buffer_load_dwordx4 v48, s[4:7], s16 offen offset:0 sc1 lds
    buffer_load_dwordx4 v48, s[4:7], s16 offen offset:1024 sc1 lds
    s_add_u32 s16, s16, 4096
    v_mov_b32 v128, 0
    v_mov_b32 v129, 0
    v_mov_b32 v130, 0
    v_mov_b32 v131, 0
    v_mov_b32 v132, 0
    v_mov_b32 v133, 0
    v_mov_b32 v134, 0
    v_mov_b32 v135, 0
    v_mov_b32 v136, 0
    v_mov_b32 v137, 0
    v_mov_b32 v138, 0
    v_mov_b32 v139, 0
    v_mov_b32 v140, 0
    v_mov_b32 v141, 0
    v_mov_b32 v142, 0
    v_mov_b32 v143, 0
    v_mov_b32 v144, 0
    v_mov_b32 v145, 0
    v_mov_b32 v146, 0
    v_mov_b32 v147, 0
    v_mov_b32 v148, 0
    v_mov_b32 v149, 0
    v_mov_b32 v150, 0
    v_mov_b32 v151, 0
    v_mov_b32 v152, 0
    v_mov_b32 v153, 0
    v_mov_b32 v154, 0
    v_mov_b32 v155, 0
    v_mov_b32 v156, 0
    v_mov_b32 v157, 0
    v_mov_b32 v158, 0
    v_mov_b32 v159, 0
    s_waitcnt vmcnt(0)
    s_barrier
    ds_read_b64_tr_b16 v[72:73], v54 offset:0
    ds_read_b64_tr_b16 v[74:75], v54 offset:4096
    ds_read_b128 v[64:67], v52 offset:0
    ds_read_b128 v[68:71], v52 offset:4096
    ds_read_b64_tr_b16 v[84:85], v54 offset:2048
    ds_read_b64_tr_b16 v[86:87], v54 offset:6144
    ds_read_b128 v[76:79], v52 offset:1024
    ds_read_b128 v[80:83], v52 offset:5120
    s_mov_b32 s19, 4
gl_34:
    s_waitcnt lgkmcnt(0)
    v_mfma_f32_32x32x16_bf16 v[128:143], v[72:75], v[64:67], v[128:143]
    ds_read_b64_tr_b16 v[96:97], v54 offset:8192
    ds_read_b64_tr_b16 v[98:99], v54 offset:12288
    ds_read_b128 v[88:91], v52 offset:2048
    ds_read_b128 v[92:95], v52 offset:6144
    v_mfma_f32_32x32x16_bf16 v[144:159], v[72:75], v[68:71], v[144:159]
    ds_read_b64_tr_b16 v[108:109], v54 offset:10240
    ds_read_b64_tr_b16 v[110:111], v54 offset:14336
    ds_read_b128 v[100:103], v52 offset:3072
    ds_read_b128 v[104:107], v52 offset:7168
    v_mfma_f32_32x32x16_bf16 v[128:143], v[84:87], v[76:79], v[128:143]
    s_cmp_eq_u32 s19, 1
    s_cselect_b32 s6, 0, s6
    s_cselect_b32 s10, 0, s10
    v_mfma_f32_32x32x16_bf16 v[144:159], v[84:87], v[80:83], v[144:159]
    s_waitcnt vmcnt(8) lgkmcnt(0)
    s_barrier
    v_mfma_f32_32x32x16_bf16 v[128:143], v[96:99], v[88:91], v[128:143]
    ds_read_b64_tr_b16 v[72:73], v54 offset:32768
    ds_read_b64_tr_b16 v[74:75], v54 offset:36864
    ds_read_b128 v[64:67], v52 offset:32768
    ds_read_b128 v[68:71], v52 offset:36864
    v_mfma_f32_32x32x16_bf16 v[144:159], v[96:99], v[92:95], v[144:159]
    ds_read_b64_tr_b16 v[84:85], v54 offset:34816
    ds_read_b64_tr_b16 v[86:87], v54 offset:38912
    ds_read_b128 v[76:79], v52 offset:33792
    ds_read_b128 v[80:83], v52 offset:37888
    v_mfma_f32_32x32x16_bf16 v[128:143], v[108:111], v[100:103], v[128:143]
    s_add_u32 m0, s21, 0
    s_nop 0
    buffer_load_dwordx4 v48, s[4:7], s16 offen offset:0 sc1 lds
    buffer_load_dwordx4 v48, s[4:7], s16 offen offset:1024 sc1 lds
    s_add_u32 m0, s22, 0
    v_mfma_f32_32x32x16_bf16 v[144:159], v[108:111], v[104:107], v[144:159]
    buffer_load_dwordx4 v49, s[8:11], s17 offen offset:0 lds
    buffer_load_dwordx4 v50, s[8:11], s17 offen offset:1024 lds
    s_add_u32 s16, s16, 4096
    s_add_u32 s17, s17, 524288
    s_waitcnt lgkmcnt(0)
    v_mfma_f32_32x32x16_bf16 v[128:143], v[72:75], v[64:67], v[128:143]
    ds_read_b64_tr_b16 v[96:97], v54 offset:40960
    ds_read_b64_tr_b16 v[98:99], v54 offset:45056
    ds_read_b128 v[88:91], v52 offset:34816
    ds_read_b128 v[92:95], v52 offset:38912
    v_mfma_f32_32x32x16_bf16 v[144:159], v[72:75], v[68:71], v[144:159]
    ds_read_b64_tr_b16 v[108:109], v54 offset:43008
    ds_read_b64_tr_b16 v[110:111], v54 offset:47104
    ds_read_b128 v[100:103], v52 offset:35840
    ds_read_b128 v[104:107], v52 offset:39936
    v_mfma_f32_32x32x16_bf16 v[128:143], v[84:87], v[76:79], v[128:143]
    v_mfma_f32_32x32x16_bf16 v[144:159], v[84:87], v[80:83], v[144:159]
    s_waitcnt vmcnt(8) lgkmcnt(0)
    s_barrier
    v_mfma_f32_32x32x16_bf16 v[128:143], v[96:99], v[88:91], v[128:143]
    ds_read_b64_tr_b16 v[72:73], v55 offset:0
    ds_read_b64_tr_b16 v[74:75], v55 offset:4096
    ds_read_b128 v[64:67], v53 offset:0
    ds_read_b128 v[68:71], v53 offset:4096
    v_mfma_f32_32x32x16_bf16 v[144:159], v[96:99], v[92:95], v[144:159]
    ds_read_b64_tr_b16 v[84:85], v55 offset:2048
    ds_read_b64_tr_b16 v[86:87], v55 offset:6144
    ds_read_b128 v[76:79], v53 offset:1024
    ds_read_b128 v[80:83], v53 offset:5120
    v_mfma_f32_32x32x16_bf16 v[128:143], v[108:111], v[100:103], v[128:143]
    s_add_u32 m0, s21, 32768
    s_nop 0
    buffer_load_dwordx4 v48, s[4:7], s16 offen offset:0 sc1 lds
    buffer_load_dwordx4 v48, s[4:7], s16 offen offset:1024 sc1 lds
    s_add_u32 m0, s22, 32768
    v_mfma_f32_32x32x16_bf16 v[144:159], v[108:111], v[104:107], v[144:159]
    buffer_load_dwordx4 v49, s[8:11], s17 offen offset:0 lds
    buffer_load_dwordx4 v50, s[8:11], s17 offen offset:1024 lds
    s_add_u32 s16, s16, 4096
    s_add_u32 s17, s17, 524288
    s_waitcnt lgkmcnt(0)
    v_mfma_f32_32x32x16_bf16 v[128:143], v[72:75], v[64:67], v[128:143]
    ds_read_b64_tr_b16 v[96:97], v55 offset:8192
    ds_read_b64_tr_b16 v[98:99], v55 offset:12288
    ds_read_b128 v[88:91], v53 offset:2048
    ds_read_b128 v[92:95], v53 offset:6144
    v_mfma_f32_32x32x16_bf16 v[144:159], v[72:75], v[68:71], v[144:159]
    ds_read_b64_tr_b16 v[108:109], v55 offset:10240
    ds_read_b64_tr_b16 v[110:111], v55 offset:14336
    ds_read_b128 v[100:103], v53 offset:3072
    ds_read_b128 v[104:107], v53 offset:7168
    v_mfma_f32_32x32x16_bf16 v[128:143], v[84:87], v[76:79], v[128:143]
    v_mfma_f32_32x32x16_bf16 v[144:159], v[84:87], v[80:83], v[144:159]
    s_waitcnt vmcnt(8) lgkmcnt(0)
    s_barrier
    v_mfma_f32_32x32x16_bf16 v[128:143], v[96:99], v[88:91], v[128:143]
    ds_read_b64_tr_b16 v[72:73], v55 offset:32768
    ds_read_b64_tr_b16 v[74:75], v55 offset:36864
    ds_read_b128 v[64:67], v53 offset:32768
    ds_read_b128 v[68:71], v53 offset:36864
    v_mfma_f32_32x32x16_bf16 v[144:159], v[96:99], v[92:95], v[144:159]
    ds_read_b64_tr_b16 v[84:85], v55 offset:34816
    ds_read_b64_tr_b16 v[86:87], v55 offset:38912
    ds_read_b128 v[76:79], v53 offset:33792
    ds_read_b128 v[80:83], v53 offset:37888
    v_mfma_f32_32x32x16_bf16 v[128:143], v[108:111], v[100:103], v[128:143]
    s_add_u32 m0, s21, 65536
    s_nop 0
    buffer_load_dwordx4 v48, s[4:7], s16 offen offset:0 sc1 lds
    buffer_load_dwordx4 v48, s[4:7], s16 offen offset:1024 sc1 lds
    s_add_u32 m0, s22, 65536
    v_mfma_f32_32x32x16_bf16 v[144:159], v[108:111], v[104:107], v[144:159]
    buffer_load_dwordx4 v49, s[8:11], s17 offen offset:0 lds
    buffer_load_dwordx4 v50, s[8:11], s17 offen offset:1024 lds
    s_add_u32 s16, s16, 4096
    s_add_u32 s17, s17, 524288
    s_waitcnt lgkmcnt(0)
    v_mfma_f32_32x32x16_bf16 v[128:143], v[72:75], v[64:67], v[128:143]
    ds_read_b64_tr_b16 v[96:97], v55 offset:40960
    ds_read_b64_tr_b16 v[98:99], v55 offset:45056
    ds_read_b128 v[88:91], v53 offset:34816
    ds_read_b128 v[92:95], v53 offset:38912
    v_mfma_f32_32x32x16_bf16 v[144:159], v[72:75], v[68:71], v[144:159]
    ds_read_b64_tr_b16 v[108:109], v55 offset:43008
    ds_read_b64_tr_b16 v[110:111], v55 offset:47104
    ds_read_b128 v[100:103], v53 offset:35840
    ds_read_b128 v[104:107], v53 offset:39936
    v_mfma_f32_32x32x16_bf16 v[128:143], v[84:87], v[76:79], v[128:143]
    v_mfma_f32_32x32x16_bf16 v[144:159], v[84:87], v[80:83], v[144:159]
    s_waitcnt vmcnt(8) lgkmcnt(0)
    s_barrier
    v_mfma_f32_32x32x16_bf16 v[128:143], v[96:99], v[88:91], v[128:143]
    ds_read_b64_tr_b16 v[72:73], v54 offset:0
    ds_read_b64_tr_b16 v[74:75], v54 offset:4096
    ds_read_b128 v[64:67], v52 offset:0
    ds_read_b128 v[68:71], v52 offset:4096
    ds_read_b64_tr_b16 v[84:85], v54 offset:2048
    v_mfma_f32_32x32x16_bf16 v[144:159], v[96:99], v[92:95], v[144:159]
    ds_read_b64_tr_b16 v[86:87], v54 offset:6144
    ds_read_b128 v[76:79], v52 offset:1024
    ds_read_b128 v[80:83], v52 offset:5120
    s_add_u32 m0, s21, 98304
    s_nop 0
    buffer_load_dwordx4 v48, s[4:7], s16 offen offset:0 sc1 lds
    v_mfma_f32_32x32x16_bf16 v[128:143], v[108:111], v[100:103], v[128:143]
    buffer_load_dwordx4 v48, s[4:7], s16 offen offset:1024 sc1 lds
    s_add_u32 m0, s22, 98304
    s_nop 0
    buffer_load_dwordx4 v49, s[8:11], s17 offen offset:0 lds
    buffer_load_dwordx4 v50, s[8:11], s17 offen offset:1024 lds
    v_mfma_f32_32x32x16_bf16 v[144:159], v[108:111], v[104:107], v[144:159]
    s_add_u32 s16, s16, 4096
    s_add_u32 s17, s17, 524288
    s_sub_u32 s19, s19, 1
    s_cmp_lg_u32 s19, 0
    s_cbranch_scc1 gl_34
    s_waitcnt vmcnt(0) lgkmcnt(0)
    s_mov_b32 s6, 268435456
    v_lshlrev_b32 v1, 4, v47
    v_cvt_pk_bf16_f32 v64, v128, v136
    v_cvt_pk_bf16_f32 v65, v129, v137
    v_cvt_pk_bf16_f32 v66, v130, v138
    v_cvt_pk_bf16_f32 v67, v131, v139
    v_cvt_pk_bf16_f32 v68, v132, v140
    v_cvt_pk_bf16_f32 v69, v133, v141
    v_cvt_pk_bf16_f32 v70, v134, v142
    v_cvt_pk_bf16_f32 v71, v135, v143
    s_add_u32 s25, s37, 0
    buffer_store_dwordx4 v[64:67], v1, s[4:7], s25 offen offset:0 sc1
    buffer_store_dwordx4 v[68:71], v1, s[4:7], s25 offen offset:1024 sc1
    v_cvt_pk_bf16_f32 v72, v144, v152
    v_cvt_pk_bf16_f32 v73, v145, v153
    v_cvt_pk_bf16_f32 v74, v146, v154
    v_cvt_pk_bf16_f32 v75, v147, v155
    v_cvt_pk_bf16_f32 v76, v148, v156
    v_cvt_pk_bf16_f32 v77, v149, v157
    v_cvt_pk_bf16_f32 v78, v150, v158
    v_cvt_pk_bf16_f32 v79, v151, v159
    s_add_u32 s25, s37, 262144
    buffer_store_dwordx4 v[72:75], v1, s[4:7], s25 offen offset:0 sc1
    buffer_store_dwordx4 v[76:79], v1, s[4:7], s25 offen offset:1024 sc1
    s_branch mk_kv0s
mk_v0:
    s_add_u32 s37, s37, 37748736
    s_add_u32 m0, s21, 0
    s_nop 0
    buffer_load_dwordx4 v48, s[4:7], s16 offen offset:0 sc1 lds
    buffer_load_dwordx4 v48, s[4:7], s16 offen offset:1024 sc1 lds
    s_add_u32 s16, s16, 4096
    s_add_u32 m0, s21, 32768
    s_nop 0
    buffer_load_dwordx4 v48, s[4:7], s16 offen offset:0 sc1 lds
    buffer_load_dwordx4 v48, s[4:7], s16 offen offset:1024 sc1 lds
    s_add_u32 s16, s16, 4096
    s_add_u32 m0, s21, 65536
    s_nop 0
    buffer_load_dwordx4 v48, s[4:7], s16 offen offset:0 sc1 lds
    buffer_load_dwordx4 v48, s[4:7], s16 offen offset:1024 sc1 lds
    s_add_u32 s16, s16, 4096
    s_add_u32 m0, s21, 98304
    s_nop 0
    buffer_load_dwordx4 v48, s[4:7], s16 offen offset:0 sc1 lds
    buffer_load_dwordx4 v48, s[4:7], s16 offen offset:1024 sc1 lds
    s_add_u32 s16, s16, 4096
    v_mov_b32 v128, 0
    v_mov_b32 v129, 0
    v_mov_b32 v130, 0
    v_mov_b32 v131, 0
    v_mov_b32 v132, 0
    v_mov_b32 v133, 0
    v_mov_b32 v134, 0
    v_mov_b32 v135, 0
    v_mov_b32 v136, 0
    v_mov_b32 v137, 0
    v_mov_b32 v138, 0
    v_mov_b32 v139, 0
    v_mov_b32 v140, 0
    v_mov_b32 v141, 0
    v_mov_b32 v142, 0
    v_mov_b32 v143, 0
    v_mov_b32 v144, 0
    v_mov_b32 v145, 0
    v_mov_b32 v146, 0
    v_mov_b32 v147, 0
    v_mov_b32 v148, 0
    v_mov_b32 v149, 0
    v_mov_b32 v150, 0
    v_mov_b32 v151, 0
    v_mov_b32 v152, 0
    v_mov_b32 v153, 0
    v_mov_b32 v154, 0
    v_mov_b32 v155, 0
    v_mov_b32 v156, 0
    v_mov_b32 v157, 0
    v_mov_b32 v158, 0
    v_mov_b32 v159, 0
    s_waitcnt vmcnt(0)
    s_barrier
    ds_read_b64_tr_b16 v[72:73], v54 offset:0
    ds_read_b64_tr_b16 v[74:75], v54 offset:4096
    ds_read_b128 v[64:67], v52 offset:0
    ds_read_b128 v[68:71], v52 offset:4096
    ds_read_b64_tr_b16 v[84:85], v54 offset:2048
    ds_read_b64_tr_b16 v[86:87], v54 offset:6144
    ds_read_b128 v[76:79], v52 offset:1024
    ds_read_b128 v[80:83], v52 offset:5120
    s_mov_b32 s19, 4
gl_35:
    s_waitcnt lgkmcnt(0)
    v_mfma_f32_32x32x16_bf16 v[128:143], v[64:67], v[72:75], v[128:143]
    ds_read_b64_tr_b16 v[96:97], v54 offset:8192
    ds_read_b64_tr_b16 v[98:99], v54 offset:12288
    ds_read_b128 v[88:91], v52 offset:2048
    ds_read_b128 v[92:95], v52 offset:6144
    v_mfma_f32_32x32x16_bf16 v[144:159], v[68:71], v[72:75], v[144:159]
    ds_read_b64_tr_b16 v[108:109], v54 offset:10240
    ds_read_b64_tr_b16 v[110:111], v54 offset:14336
    ds_read_b128 v[100:103], v52 offset:3072
    ds_read_b128 v[104:107], v52 offset:7168
    v_mfma_f32_32x32x16_bf16 v[128:143], v[76:79], v[84:87], v[128:143]
    s_cmp_eq_u32 s19, 1
    s_cselect_b32 s6, 0, s6
    s_cselect_b32 s10, 0, s10
    v_mfma_f32_32x32x16_bf16 v[144:159], v[80:83], v[84:87], v[144:159]
    s_waitcnt vmcnt(8) lgkmcnt(0)
    s_barrier
    v_mfma_f32_32x32x16_bf16 v[128:143], v[88:91], v[96:99], v[128:143]
    ds_read_b64_tr_b16 v[72:73], v54 offset:32768
    ds_read_b64_tr_b16 v[74:75], v54 offset:36864
    ds_read_b128 v[64:67], v52 offset:32768
    ds_read_b128 v[68:71], v52 offset:36864
    v_mfma_f32_32x32x16_bf16 v[144:159], v[92:95], v[96:99], v[144:159]
    ds_read_b64_tr_b16 v[84:85], v54 offset:34816
    ds_read_b64_tr_b16 v[86:87], v54 offset:38912
    ds_read_b128 v[76:79], v52 offset:33792
    ds_read_b128 v[80:83], v52 offset:37888
    v_mfma_f32_32x32x16_bf16 v[128:143], v[100:103], v[108:111], v[128:143]
    s_add_u32 m0, s21, 0
    s_nop 0
    buffer_load_dwordx4 v48, s[4:7], s16 offen offset:0 sc1 lds
    buffer_load_dwordx4 v48, s[4:7], s16 offen offset:1024 sc1 lds
    s_add_u32 m0, s22, 0
    v_mfma_f32_32x32x16_bf16 v[144:159], v[104:107], v[108:111], v[144:159]
    buffer_load_dwordx4 v49, s[8:11], s17 offen offset:0 lds
    buffer_load_dwordx4 v50, s[8:11], s17 offen offset:1024 lds
    s_add_u32 s16, s16, 4096
    s_add_u32 s17, s17, 524288
    s_waitcnt lgkmcnt(0)
    v_mfma_f32_32x32x16_bf16 v[128:143], v[64:67], v[72:75], v[128:143]
    ds_read_b64_tr_b16 v[96:97], v54 offset:40960
    ds_read_b64_tr_b16 v[98:99], v54 offset:45056
    ds_read_b128 v[88:91], v52 offset:34816
    ds_read_b128 v[92:95], v52 offset:38912
    v_mfma_f32_32x32x16_bf16 v[144:159], v[68:71], v[72:75], v[144:159]
    ds_read_b64_tr_b16 v[108:109], v54 offset:43008
    ds_read_b64_tr_b16 v[110:111], v54 offset:47104
    ds_read_b128 v[100:103], v52 offset:35840
    ds_read_b128 v[104:107], v52 offset:39936
    v_mfma_f32_32x32x16_bf16 v[128:143], v[76:79], v[84:87], v[128:143]
    v_mfma_f32_32x32x16_bf16 v[144:159], v[80:83], v[84:87], v[144:159]
    s_waitcnt vmcnt(8) lgkmcnt(0)
    s_barrier
    v_mfma_f32_32x32x16_bf16 v[128:143], v[88:91], v[96:99], v[128:143]
    ds_read_b64_tr_b16 v[72:73], v55 offset:0
    ds_read_b64_tr_b16 v[74:75], v55 offset:4096
    ds_read_b128 v[64:67], v53 offset:0
    ds_read_b128 v[68:71], v53 offset:4096
    v_mfma_f32_32x32x16_bf16 v[144:159], v[92:95], v[96:99], v[144:159]
    ds_read_b64_tr_b16 v[84:85], v55 offset:2048
    ds_read_b64_tr_b16 v[86:87], v55 offset:6144
    ds_read_b128 v[76:79], v53 offset:1024
    ds_read_b128 v[80:83], v53 offset:5120
    v_mfma_f32_32x32x16_bf16 v[128:143], v[100:103], v[108:111], v[128:143]
    s_add_u32 m0, s21, 32768
    s_nop 0
    buffer_load_dwordx4 v48, s[4:7], s16 offen offset:0 sc1 lds
    buffer_load_dwordx4 v48, s[4:7], s16 offen offset:1024 sc1 lds
    s_add_u32 m0, s22, 32768
    v_mfma_f32_32x32x16_bf16 v[144:159], v[104:107], v[108:111], v[144:159]
    buffer_load_dwordx4 v49, s[8:11], s17 offen offset:0 lds
    buffer_load_dwordx4 v50, s[8:11], s17 offen offset:1024 lds
    s_add_u32 s16, s16, 4096
    s_add_u32 s17, s17, 524288
    s_waitcnt lgkmcnt(0)
    v_mfma_f32_32x32x16_bf16 v[128:143], v[64:67], v[72:75], v[128:143]
    ds_read_b64_tr_b16 v[96:97], v55 offset:8192
    ds_read_b64_tr_b16 v[98:99], v55 offset:12288
    ds_read_b128 v[88:91], v53 offset:2048
    ds_read_b128 v[92:95], v53 offset:6144
    v_mfma_f32_32x32x16_bf16 v[144:159], v[68:71], v[72:75], v[144:159]
    ds_read_b64_tr_b16 v[108:109], v55 offset:10240
    ds_read_b64_tr_b16 v[110:111], v55 offset:14336
    ds_read_b128 v[100:103], v53 offset:3072
    ds_read_b128 v[104:107], v53 offset:7168
    v_mfma_f32_32x32x16_bf16 v[128:143], v[76:79], v[84:87], v[128:143]
    v_mfma_f32_32x32x16_bf16 v[144:159], v[80:83], v[84:87], v[144:159]
    s_waitcnt vmcnt(8) lgkmcnt(0)
    s_barrier
    v_mfma_f32_32x32x16_bf16 v[128:143], v[88:91], v[96:99], v[128:143]
    ds_read_b64_tr_b16 v[72:73], v55 offset:32768
    ds_read_b64_tr_b16 v[74:75], v55 offset:36864
    ds_read_b128 v[64:67], v53 offset:32768
    ds_read_b128 v[68:71], v53 offset:36864
    v_mfma_f32_32x32x16_bf16 v[144:159], v[92:95], v[96:99], v[144:159]
    ds_read_b64_tr_b16 v[84:85], v55 offset:34816
    ds_read_b64_tr_b16 v[86:87], v55 offset:38912
    ds_read_b128 v[76:79], v53 offset:33792
    ds_read_b128 v[80:83], v53 offset:37888
    v_mfma_f32_32x32x16_bf16 v[128:143], v[100:103], v[108:111], v[128:143]
    s_add_u32 m0, s21, 65536
    s_nop 0
    buffer_load_dwordx4 v48, s[4:7], s16 offen offset:0 sc1 lds
    buffer_load_dwordx4 v48, s[4:7], s16 offen offset:1024 sc1 lds
    s_add_u32 m0, s22, 65536
    v_mfma_f32_32x32x16_bf16 v[144:159], v[104:107], v[108:111], v[144:159]
    buffer_load_dwordx4 v49, s[8:11], s17 offen offset:0 lds
    buffer_load_dwordx4 v50, s[8:11], s17 offen offset:1024 lds
    s_add_u32 s16, s16, 4096
    s_add_u32 s17, s17, 524288
    s_waitcnt lgkmcnt(0)
    v_mfma_f32_32x32x16_bf16 v[128:143], v[64:67], v[72:75], v[128:143]
    ds_read_b64_tr_b16 v[96:97], v55 offset:40960
    ds_read_b64_tr_b16 v[98:99], v55 offset:45056
    ds_read_b128 v[88:91], v53 offset:34816
    ds_read_b128 v[92:95], v53 offset:38912
    v_mfma_f32_32x32x16_bf16 v[144:159], v[68:71], v[72:75], v[144:159]
    ds_read_b64_tr_b16 v[108:109], v55 offset:43008
    ds_read_b64_tr_b16 v[110:111], v55 offset:47104
    ds_read_b128 v[100:103], v53 offset:35840
    ds_read_b128 v[104:107], v53 offset:39936
    v_mfma_f32_32x32x16_bf16 v[128:143], v[76:79], v[84:87], v[128:143]
    v_mfma_f32_32x32x16_bf16 v[144:159], v[80:83], v[84:87], v[144:159]
    s_waitcnt vmcnt(8) lgkmcnt(0)
    s_barrier
    v_mfma_f32_32x32x16_bf16 v[128:143], v[88:91], v[96:99], v[128:143]
    ds_read_b64_tr_b16 v[72:73], v54 offset:0
    ds_read_b64_tr_b16 v[74:75], v54 offset:4096
    ds_read_b128 v[64:67], v52 offset:0
    ds_read_b128 v[68:71], v52 offset:4096
    ds_read_b64_tr_b16 v[84:85], v54 offset:2048
    v_mfma_f32_32x32x16_bf16 v[144:159], v[92:95], v[96:99], v[144:159]
    ds_read_b64_tr_b16 v[86:87], v54 offset:6144
    ds_read_b128 v[76:79], v52 offset:1024
    ds_read_b128 v[80:83], v52 offset:5120
    s_add_u32 m0, s21, 98304
    s_nop 0
    buffer_load_dwordx4 v48, s[4:7], s16 offen offset:0 sc1 lds
    v_mfma_f32_32x32x16_bf16 v[128:143], v[100:103], v[108:111], v[128:143]
    buffer_load_dwordx4 v48, s[4:7], s16 offen offset:1024 sc1 lds
    s_add_u32 m0, s22, 98304
    s_nop 0
    buffer_load_dwordx4 v49, s[8:11], s17 offen offset:0 lds
    buffer_load_dwordx4 v50, s[8:11], s17 offen offset:1024 lds
    v_mfma_f32_32x32x16_bf16 v[144:159], v[104:107], v[108:111], v[144:159]
    s_add_u32 s16, s16, 4096
    s_add_u32 s17, s17, 524288
    s_sub_u32 s19, s19, 1
    s_cmp_lg_u32 s19, 0
    s_cbranch_scc1 gl_35
    s_waitcnt vmcnt(0) lgkmcnt(0)
    s_mov_b32 s6, 268435456
    v_lshlrev_b32 v1, 4, v47
    v_cvt_pk_bf16_f32 v64, v128, v129
    v_cvt_pk_bf16_f32 v65, v130, v131
    v_cvt_pk_bf16_f32 v66, v136, v137
    v_cvt_pk_bf16_f32 v67, v138, v139
    v_cvt_pk_bf16_f32 v68, v132, v133
    v_cvt_pk_bf16_f32 v69, v134, v135
    v_cvt_pk_bf16_f32 v70, v140, v141
    v_cvt_pk_bf16_f32 v71, v142, v143
    s_add_u32 s25, s37, 0
    buffer_store_dwordx4 v[64:67], v1, s[4:7], s25 offen offset:0 sc1
    buffer_store_dwordx4 v[68:71], v1, s[4:7], s25 offen offset:1024 sc1
    v_cvt_pk_bf16_f32 v72, v144, v145
    v_cvt_pk_bf16_f32 v73, v146, v147
    v_cvt_pk_bf16_f32 v74, v152, v153
    v_cvt_pk_bf16_f32 v75, v154, v155
    v_cvt_pk_bf16_f32 v76, v148, v149
    v_cvt_pk_bf16_f32 v77, v150, v151
    v_cvt_pk_bf16_f32 v78, v156, v157
    v_cvt_pk_bf16_f32 v79, v158, v159
    s_add_u32 s25, s37, 262144
    buffer_store_dwordx4 v[72:75], v1, s[4:7], s25 offen offset:0 sc1
    buffer_store_dwordx4 v[76:79], v1, s[4:7], s25 offen offset:1024 sc1
mk_kv0s:
    s_lshr_b32 s40, s36, 1
    s_lshr_b32 s41, s80, 2
    s_lshl_b32 s41, s41, 4
    s_add_u32 s40, s40, s41
    s_lshr_b32 s41, s35, 1
    s_lshl_b32 s41, s41, 5
    s_add_u32 s40, s40, s41
    s_lshl_b32 s40, s40, 7
    s_add_u32 s40, s40, 167772160
    s_waitcnt vmcnt(0)
    s_barrier
    s_cmp_lg_u32 s20, 0
    s_cbranch_scc1 sg_36
    v_min_u32 v1, 1, v47
    v_lshlrev_b32 v1, 30, v1
    v_mov_b32 v2, 1
    buffer_atomic_add v2, v1, s[4:7], s40 offen sc1
sg_36:
    s_cmp_ge_u32 s35, 2
    s_cbranch_scc1 mk_noxf
    s_cmp_ge_u32 s81, 10
    s_cbranch_scc1 mk_noxf
    buffer_store_dwordx4 v[24:27], v40, s[4:7], s44 offen offset:0 sc1
    buffer_store_dwordx4 v[28:31], v40, s[4:7], s44 offen offset:512 sc1
    buffer_store_dwordx4 v[32:35], v40, s[4:7], s44 offen offset:1024 sc1
    buffer_store_dwordx4 v[36:39], v40, s[4:7], s44 offen offset:1536 sc1
mk_noxf:
    s_add_u32 s35, s35, 2
    s_cmp_lt_u32 s35, 4
    s_cbranch_scc1 mk_kv0
    v_and_b32 v3, 15, v47
    v_lshlrev_b32 v3, 7, v3
    s_mov_b32 s40, 167874560
wf_37:
    buffer_load_dword v2, v3, s[4:7], s40 offen sc1
    s_waitcnt vmcnt(0)
    v_cmp_gt_u32 vcc, 8, v2
    s_cbranch_vccz wfo_38
    s_sleep 4
    s_sub_u32 s78, s78, 1
    s_cbranch_scc0 wf_37
    s_mov_b32 s78, 0
wfo_38:
    v_mov_b32 v2, 0
    s_mov_b32 s23, 0x03020100
    v_writelane_b32 v2, s23, 0
    s_mov_b32 s23, 0x07060504
    v_writelane_b32 v2, s23, 1
    s_mov_b32 s23, 0x0b0a0908
    v_writelane_b32 v2, s23, 2
    s_mov_b32 s23, 0x41402120
    v_writelane_b32 v2, s23, 3
    s_mov_b32 s23, 0x45444342
    v_writelane_b32 v2, s23, 4
    s_mov_b32 s23, 0x49484746
    v_writelane_b32 v2, s23, 5
    s_mov_b32 s23, 0x4d4c4b4a
    v_writelane_b32 v2, s23, 6
    s_mov_b32 s23, 0x25242322
    v_writelane_b32 v2, s23, 7
    s_mov_b32 s23, 0xc1c06b6a
    v_writelane_b32 v2, s23, 8
    s_mov_b32 s23, 0x0d0c2726
    v_writelane_b32 v2, s23, 9
    s_mov_b32 s23, 0x29280f0e
    v_writelane_b32 v2, s23, 10
    s_mov_b32 s23, 0x13121110
    v_writelane_b32 v2, s23, 11
    s_mov_b32 s23, 0x63626160
    v_writelane_b32 v2, s23, 12
    s_mov_b32 s23, 0x2b2a6564
    v_writelane_b32 v2, s23, 13
    s_mov_b32 s23, 0x17161514
    v_writelane_b32 v2, s23, 14
    s_mov_b32 s23, 0x67666d6c
    v_writelane_b32 v2, s23, 15
    s_mov_b32 s23, 0x2d2c6968
    v_writelane_b32 v2, s23, 16
    s_mov_b32 s23, 0x6f6e2f2e
    v_writelane_b32 v2, s23, 17
    s_mov_b32 s23, 0xe3e2e1e0
    v_writelane_b32 v2, s23, 18
    s_mov_b32 s23, 0xe3e2e1e0
    v_writelane_b32 v2, s23, 19
    s_mov_b32 s23, 0xe2e1e0a0
    v_writelane_b32 v2, s23, 20
    s_mov_b32 s23, 0xe0a2a1e3
    v_writelane_b32 v2, s23, 21
    s_mov_b32 s23, 0xe0e0e0e1
    v_writelane_b32 v2, s23, 22
    s_mov_b32 s23, 0xe0e0e0e0
    v_writelane_b32 v2, s23, 23
    s_mov_b32 s23, 0xe0e0e0e0
    v_writelane_b32 v2, s23, 24
    s_mov_b32 s23, 0xe0e0e0e0
    v_writelane_b32 v2, s23, 25
    s_mov_b32 s23, 0xe0e0e0e0
    v_writelane_b32 v2, s23, 26
    s_mov_b32 s23, 0xe0e0e0e0
    v_writelane_b32 v2, s23, 27
    s_mov_b32 s23, 0xe0e0e0e0
    v_writelane_b32 v2, s23, 28
    s_mov_b32 s23, 0xe0e0e0e0
    v_writelane_b32 v2, s23, 29
    s_mov_b32 s23, 0xe0e0e0e0
    v_writelane_b32 v2, s23, 30
    s_mov_b32 s23, 0xe0e0e0e0
    v_writelane_b32 v2, s23, 31
    v_and_b32 v3, 31, v47
    v_lshlrev_b32 v3, 2, v3
    v_add_u32 v3, 131072, v3
    s_mov_b64 s[24:25], exec
    s_mov_b64 exec, 0xffffffff
    ds_write_b32 v3, v2
    s_mov_b64 exec, s[24:25]
    s_waitcnt lgkmcnt(0)
    s_barrier
    s_lshl_b32 s59, s80, 7
    s_add_u32 s59, s59, 167878656
    s_mov_b32 s56, 0
mk_fetch:
    s_cmp_lg_u32 s20, 0
    s_cbranch_scc1 mk_fet2
    v_and_b32 v1, 63, v0
    v_min_u32 v1, 1, v1
    v_lshlrev_b32 v1, 30, v1
    v_mov_b32 v2, 1
    buffer_atomic_add v2, v1, s[4:7], s59 offen sc0 sc1
    s_waitcnt vmcnt(0)
    v_readfirstlane_b32 s23, v2
    s_min_u32 s23, s23, 127
    s_add_u32 s23, s23, 131072
    v_mov_b32 v2, s23
    ds_read_u8 v2, v2
    v_mov_b32 v3, 131200
    s_waitcnt lgkmcnt(0)
    ds_write_b32 v3, v2
    s_waitcnt lgkmcnt(0)
mk_fet2:
    s_barrier
    v_mov_b32 v3, 131200
    ds_read_b32 v2, v3
    s_waitcnt lgkmcnt(0)
    v_readfirstlane_b32 s72, v2
    s_barrier
mk_start:
    s_and_b32 s72, s72, 0xff
    s_cmp_ge_u32 s72, 160
    s_cbranch_scc1 mk_other
    s_bfe_u32 s23, s72, 0x40001
    s_lshl_b32 s23, s23, 7
    s_lshr_b32 s25, s72, 5
    s_cmp_eq_u32 s25, 3
    s_cselect_b32 s24, 14, 0
    s_cmp_eq_u32 s25, 4
    s_cselect_b32 s24, 1, s24
    s_cselect_b32 s25, 3072, 0
    s_add_u32 s23, s23, s25
    s_add_u32 s23, s23, 167858176
    s_mov_b32 s40, s23
    s_mov_b32 s41, s24
    v_mov_b32 v3, 0
wf_39:
    buffer_load_dword v2, v3, s[4:7], s40 offen sc1
    s_waitcnt vmcnt(0)
    v_cmp_gt_u32 vcc, s41, v2
    s_cbranch_vccz wfo_40
    s_sleep 16
    s_sub_u32 s78, s78, 1
    s_cbranch_scc0 wf_39
    s_mov_b32 s78, 0
wfo_40:
    s_barrier
    v_and_b32 v47, 63, v0
    s_mul_i32 s21, s20, 2048
    s_add_u32 s22, s21, 16384
    s_lshr_b32 s23, s20, 2
    s_lshl_b32 s23, s23, 13
    v_lshrrev_b32 v1, 4, v47
    v_and_b32 v2, 15, v47
    v_lshlrev_b32 v2, 4, v2
    v_lshl_add_u32 v46, v1, 9, v2
    v_add_u32 v52, s23, v46
    v_add_u32 v53, 65536, v52
    v_lshrrev_b32 v2, 2, v47
    v_lshlrev_b32 v2, 9, v2
    v_and_b32 v3, 3, v47
    v_lshl_add_u32 v2, v3, 3, v2
    v_add_u32 v2, 16384, v2
    v_bfe_u32 v3, v47, 2, 2
    v_lshlrev_b32 v3, 6, v3
    v_and_b32 v1, 1, v1
    v_lshl_add_u32 v3, v1, 5, v3
    s_and_b32 s24, s20, 3
    s_lshl_b32 s24, s24, 7
    s_add_u32 s25, s24, 0
    v_xor_b32 v1, s25, v3
    v_add_u32 v54, v1, v2
    v_add_u32 v55, 65536, v54
    s_add_u32 s25, s24, 32
    v_xor_b32 v1, s25, v3
    v_add_u32 v56, v1, v2
    v_add_u32 v57, 65536, v56
    s_add_u32 s25, s24, 64
    v_xor_b32 v1, s25, v3
    v_add_u32 v58, v1, v2
    v_add_u32 v59, 65536, v58
    s_add_u32 s25, s24, 96
    v_xor_b32 v1, s25, v3
    v_add_u32 v60, v1, v2
    v_add_u32 v61, 65536, v60
    s_call_b64 s[26:27], mk_prep
    s_add_u32 m0, s21, 0
    s_nop 0
    buffer_load_dwordx4 v48, s[4:7], s16 offen offset:0 sc1 lds
    buffer_load_dwordx4 v48, s[4:7], s16 offen offset:1024 sc1 lds
    s_add_u32 m0, s22, 0
    s_nop 0
    buffer_load_dwordx4 v49, s[8:11], s17 offen offset:0 lds
    buffer_load_dwordx4 v50, s[8:11], s17 offen offset:1024 lds
    s_add_u32 s16, s16, 2048
    s_add_u32 s17, s17, s18
    s_add_u32 m0, s21, 32768
    s_nop 0
    buffer_load_dwordx4 v48, s[4:7], s16 offen offset:0 sc1 lds
    buffer_load_dwordx4 v48, s[4:7], s16 offen offset:1024 sc1 lds
    s_add_u32 m0, s22, 32768
    s_nop 0
    buffer_load_dwordx4 v49, s[8:11], s17 offen offset:0 lds
    buffer_load_dwordx4 v50, s[8:11], s17 offen offset:1024 lds
    s_add_u32 s16, s16, 2048
    s_add_u32 s17, s17, s18
    s_add_u32 m0, s21, 65536
    s_nop 0
    buffer_load_dwordx4 v48, s[4:7], s16 offen offset:0 sc1 lds
    buffer_load_dwordx4 v48, s[4:7], s16 offen offset:1024 sc1 lds
    s_add_u32 m0, s22, 65536
    s_nop 0
    buffer_load_dwordx4 v49, s[8:11], s17 offen offset:0 lds
    buffer_load_dwordx4 v50, s[8:11], s17 offen offset:1024 lds
    s_add_u32 s16, s16, 2048
    s_add_u32 s17, s17, s18
    s_add_u32 m0, s21, 98304
    s_nop 0
    buffer_load_dwordx4 v48, s[4:7], s16 offen offset:0 sc1 lds
    buffer_load_dwordx4 v48, s[4:7], s16 offen offset:1024 sc1 lds
    s_add_u32 m0, s22, 98304
    s_nop 0
    buffer_load_dwordx4 v49, s[8:11], s17 offen offset:0 lds
    buffer_load_dwordx4 v50, s[8:11], s17 offen offset:1024 lds
    s_add_u32 s16, s16, 2048
    s_add_u32 s17, s17, s18
    s_waitcnt vmcnt(12)
    s_barrier
mk_run:
    s_mov_b32 s79, s72
    s_mov_b32 s19, s30
    s_mov_b32 s58, s30
    s_mov_b32 s37, s31
    s_mov_b32 s40, s32
    s_mov_b32 s41, s33
    ds_read_b64_tr_b16 v[96:97], v54 offset:0
    ds_read_b64_tr_b16 v[98:99], v54 offset:8192
    ds_read_b64_tr_b16 v[100:101], v56 offset:0
    ds_read_b64_tr_b16 v[102:103], v56 offset:8192
    ds_read_b64_tr_b16 v[104:105], v58 offset:0
    ds_read_b64_tr_b16 v[106:107], v58 offset:8192
    ds_read_b64_tr_b16 v[108:109], v60 offset:0
    ds_read_b64_tr_b16 v[110:111], v60 offset:8192
    ds_read_b128 v[64:67], v52 offset:0
    ds_read_b128 v[68:71], v52 offset:256
    ds_read_b128 v[72:75], v52 offset:2048
    ds_read_b128 v[76:79], v52 offset:2304
    s_lshr_b32 s23, s79, 5
    s_cmp_eq_u32 s23, 4
    s_cbranch_scc1 mk_l1
    v_mov_b32 v128, 0
    v_mov_b32 v129, 0
    v_mov_b32 v130, 0
    v_mov_b32 v131, 0
    v_mov_b32 v132, 0
    v_mov_b32 v133, 0
    v_mov_b32 v134, 0
    v_mov_b32 v135, 0
    v_mov_b32 v136, 0
    v_mov_b32 v137, 0
    v_mov_b32 v138, 0
    v_mov_b32 v139, 0
    v_mov_b32 v140, 0
    v_mov_b32 v141, 0
    v_mov_b32 v142, 0
    v_mov_b32 v143, 0
    v_mov_b32 v144, 0
    v_mov_b32 v145, 0
    v_mov_b32 v146, 0
    v_mov_b32 v147, 0
    v_mov_b32 v148, 0
    v_mov_b32 v149, 0
    v_mov_b32 v150, 0
    v_mov_b32 v151, 0
    v_mov_b32 v152, 0
    v_mov_b32 v153, 0
    v_mov_b32 v154, 0
    v_mov_b32 v155, 0
    v_mov_b32 v156, 0
    v_mov_b32 v157, 0
    v_mov_b32 v158, 0
    v_mov_b32 v159, 0
    v_mov_b32 v160, 0
    v_mov_b32 v161, 0
    v_mov_b32 v162, 0
    v_mov_b32 v163, 0
    v_mov_b32 v164, 0
    v_mov_b32 v165, 0
    v_mov_b32 v166, 0
    v_mov_b32 v167, 0
    v_mov_b32 v168, 0
    v_mov_b32 v169, 0
    v_mov_b32 v170, 0
    v_mov_b32 v171, 0
    v_mov_b32 v172, 0
    v_mov_b32 v173, 0
    v_mov_b32 v174, 0
    v_mov_b32 v175, 0
    v_mov_b32 v176, 0
    v_mov_b32 v177, 0
    v_mov_b32 v178, 0
    v_mov_b32 v179, 0
    v_mov_b32 v180, 0
    v_mov_b32 v181, 0
    v_mov_b32 v182, 0
    v_mov_b32 v183, 0
    v_mov_b32 v184, 0
    v_mov_b32 v185, 0
    v_mov_b32 v186, 0
    v_mov_b32 v187, 0
    v_mov_b32 v188, 0
    v_mov_b32 v189, 0
    v_mov_b32 v190, 0
    v_mov_b32 v191, 0
    v_mov_b32 v192, 0
    v_mov_b32 v193, 0
    v_mov_b32 v194, 0
    v_mov_b32 v195, 0
    v_mov_b32 v196, 0
    v_mov_b32 v197, 0
    v_mov_b32 v198, 0
    v_mov_b32 v199, 0
    v_mov_b32 v200, 0
    v_mov_b32 v201, 0
    v_mov_b32 v202, 0
    v_mov_b32 v203, 0
    v_mov_b32 v204, 0
    v_mov_b32 v205, 0
    v_mov_b32 v206, 0
    v_mov_b32 v207, 0
    v_mov_b32 v208, 0
    v_mov_b32 v209, 0
    v_mov_b32 v210, 0
    v_mov_b32 v211, 0
    v_mov_b32 v212, 0
    v_mov_b32 v213, 0
    v_mov_b32 v214, 0
    v_mov_b32 v215, 0
    v_mov_b32 v216, 0
    v_mov_b32 v217, 0
    v_mov_b32 v218, 0
    v_mov_b32 v219, 0
    v_mov_b32 v220, 0
    v_mov_b32 v221, 0
    v_mov_b32 v222, 0
    v_mov_b32 v223, 0
    v_mov_b32 v224, 0
    v_mov_b32 v225, 0
    v_mov_b32 v226, 0
    v_mov_b32 v227, 0
    v_mov_b32 v228, 0
    v_mov_b32 v229, 0
    v_mov_b32 v230, 0
    v_mov_b32 v231, 0
    v_mov_b32 v232, 0
    v_mov_b32 v233, 0
    v_mov_b32 v234, 0
    v_mov_b32 v235, 0
    v_mov_b32 v236, 0
    v_mov_b32 v237, 0
    v_mov_b32 v238, 0
    v_mov_b32 v239, 0
    v_mov_b32 v240, 0
    v_mov_b32 v241, 0
    v_mov_b32 v242, 0
    v_mov_b32 v243, 0
    v_mov_b32 v244, 0
    v_mov_b32 v245, 0
    v_mov_b32 v246, 0
    v_mov_b32 v247, 0
    v_mov_b32 v248, 0
    v_mov_b32 v249, 0
    v_mov_b32 v250, 0
    v_mov_b32 v251, 0
    v_mov_b32 v252, 0
    v_mov_b32 v253, 0
    v_mov_b32 v254, 0
    v_mov_b32 v255, 0
    s_cmp_lg_u32 s23, 2
    s_cbranch_scc1 mk_nob
    s_mov_b32 s12, s96
    s_and_b32 s13, s97, 0xffff
    s_mov_b32 s14, 7168
    s_mov_b32 s15, 0x00020000
    v_lshrrev_b32 v1, 4, v47
    v_lshlrev_b32 v1, 3, v1
    buffer_load_dwordx2 v[24:25], v1, s[12:15], s41 offen offset:0
    buffer_load_dwordx2 v[26:27], v1, s[12:15], s41 offen offset:32
    buffer_load_dwordx2 v[28:29], v1, s[12:15], s41 offen offset:64
    buffer_load_dwordx2 v[30:31], v1, s[12:15], s41 offen offset:96
mk_nob:
    s_cmp_lg_u32 s23, 0
    s_cbranch_scc1 mk_l1
    s_cmp_ge_u32 s80, 4
    s_cbranch_scc1 mk_l0
mk_l1:
    s_cmp_lg_u32 s20, 0
    s_cbranch_scc1 mk_l1a
    s_call_b64 s[26:27], mk_serv
mk_l1a:
    s_cmp_lg_u32 s19, 1
    s_cbranch_scc1 mk_l1b
    s_call_b64 s[26:27], mk_switch
mk_l1b:
    s_waitcnt lgkmcnt(0)
    v_mfma_f32_16x16x32_bf16 v[128:131], v[96:99], v[64:67], v[128:131]
    ds_read_b128 v[80:83], v52 offset:4096
    v_mfma_f32_16x16x32_bf16 v[132:135], v[100:103], v[64:67], v[132:135]
    ds_read_b128 v[84:87], v52 offset:4352
    v_mfma_f32_16x16x32_bf16 v[136:139], v[104:107], v[64:67], v[136:139]
    ds_read_b128 v[88:91], v52 offset:6144
    v_mfma_f32_16x16x32_bf16 v[140:143], v[108:111], v[64:67], v[140:143]
    ds_read_b128 v[92:95], v52 offset:6400
    v_mfma_f32_16x16x32_bf16 v[144:147], v[96:99], v[68:71], v[144:147]
    v_mfma_f32_16x16x32_bf16 v[148:151], v[100:103], v[68:71], v[148:151]
    v_mfma_f32_16x16x32_bf16 v[152:155], v[104:107], v[68:71], v[152:155]
    v_mfma_f32_16x16x32_bf16 v[156:159], v[108:111], v[68:71], v[156:159]
    v_mfma_f32_16x16x32_bf16 v[160:163], v[96:99], v[72:75], v[160:163]
    v_mfma_f32_16x16x32_bf16 v[164:167], v[100:103], v[72:75], v[164:167]
    v_mfma_f32_16x16x32_bf16 v[168:171], v[104:107], v[72:75], v[168:171]
    v_mfma_f32_16x16x32_bf16 v[172:175], v[108:111], v[72:75], v[172:175]
    v_mfma_f32_16x16x32_bf16 v[176:179], v[96:99], v[76:79], v[176:179]
    v_mfma_f32_16x16x32_bf16 v[180:183], v[100:103], v[76:79], v[180:183]
    v_mfma_f32_16x16x32_bf16 v[184:187], v[104:107], v[76:79], v[184:187]
    v_mfma_f32_16x16x32_bf16 v[188:191], v[108:111], v[76:79], v[188:191]
    s_waitcnt vmcnt(8) lgkmcnt(0)
    s_barrier
    v_mfma_f32_16x16x32_bf16 v[192:195], v[96:99], v[80:83], v[192:195]
    ds_read_b64_tr_b16 v[112:113], v54 offset:32768
    ds_read_b64_tr_b16 v[114:115], v54 offset:40960
    v_mfma_f32_16x16x32_bf16 v[196:199], v[100:103], v[80:83], v[196:199]
    ds_read_b64_tr_b16 v[116:117], v56 offset:32768
    ds_read_b64_tr_b16 v[118:119], v56 offset:40960
    v_mfma_f32_16x16x32_bf16 v[200:203], v[104:107], v[80:83], v[200:203]
    ds_read_b64_tr_b16 v[120:121], v58 offset:32768
    ds_read_b64_tr_b16 v[122:123], v58 offset:40960
    v_mfma_f32_16x16x32_bf16 v[204:207], v[108:111], v[80:83], v[204:207]
    ds_read_b64_tr_b16 v[124:125], v60 offset:32768
    ds_read_b64_tr_b16 v[126:127], v60 offset:40960
    v_mfma_f32_16x16x32_bf16 v[208:211], v[96:99], v[84:87], v[208:211]
    ds_read_b128 v[64:67], v52 offset:32768
    v_mfma_f32_16x16x32_bf16 v[212:215], v[100:103], v[84:87], v[212:215]
    ds_read_b128 v[68:71], v52 offset:33024
    v_mfma_f32_16x16x32_bf16 v[216:219], v[104:107], v[84:87], v[216:219]
    ds_read_b128 v[72:75], v52 offset:34816
    v_mfma_f32_16x16x32_bf16 v[220:223], v[108:111], v[84:87], v[220:223]
    ds_read_b128 v[76:79], v52 offset:35072
    v_mfma_f32_16x16x32_bf16 v[224:227], v[96:99], v[88:91], v[224:227]
    s_add_u32 m0, s21, 0
    v_mfma_f32_16x16x32_bf16 v[228:231], v[100:103], v[88:91], v[228:231]
    buffer_load_dwordx4 v48, s[4:7], s16 offen offset:0 sc1 lds
    v_mfma_f32_16x16x32_bf16 v[232:235], v[104:107], v[88:91], v[232:235]
    buffer_load_dwordx4 v48, s[4:7], s16 offen offset:1024 sc1 lds
    v_mfma_f32_16x16x32_bf16 v[236:239], v[108:111], v[88:91], v[236:239]
    s_add_u32 m0, s22, 0
    v_mfma_f32_16x16x32_bf16 v[240:243], v[96:99], v[92:95], v[240:243]
    buffer_load_dwordx4 v49, s[8:11], s17 offen offset:0 lds
    v_mfma_f32_16x16x32_bf16 v[244:247], v[100:103], v[92:95], v[244:247]
    buffer_load_dwordx4 v50, s[8:11], s17 offen offset:1024 lds
    v_mfma_f32_16x16x32_bf16 v[248:251], v[104:107], v[92:95], v[248:251]
    s_add_u32 s16, s16, 2048
    v_mfma_f32_16x16x32_bf16 v[252:255], v[108:111], v[92:95], v[252:255]
    s_add_u32 s17, s17, s18
    s_waitcnt lgkmcnt(0)
    v_mfma_f32_16x16x32_bf16 v[128:131], v[112:115], v[64:67], v[128:131]
    ds_read_b128 v[80:83], v52 offset:36864
    v_mfma_f32_16x16x32_bf16 v[132:135], v[116:119], v[64:67], v[132:135]
    ds_read_b128 v[84:87], v52 offset:37120
    v_mfma_f32_16x16x32_bf16 v[136:139], v[120:123], v[64:67], v[136:139]
    ds_read_b128 v[88:91], v52 offset:38912
    v_mfma_f32_16x16x32_bf16 v[140:143], v[124:127], v[64:67], v[140:143]
    ds_read_b128 v[92:95], v52 offset:39168
    v_mfma_f32_16x16x32_bf16 v[144:147], v[112:115], v[68:71], v[144:147]
    v_mfma_f32_16x16x32_bf16 v[148:151], v[116:119], v[68:71], v[148:151]
    v_mfma_f32_16x16x32_bf16 v[152:155], v[120:123], v[68:71], v[152:155]
    v_mfma_f32_16x16x32_bf16 v[156:159], v[124:127], v[68:71], v[156:159]
    v_mfma_f32_16x16x32_bf16 v[160:163], v[112:115], v[72:75], v[160:163]
    v_mfma_f32_16x16x32_bf16 v[164:167], v[116:119], v[72:75], v[164:167]
    v_mfma_f32_16x16x32_bf16 v[168:171], v[120:123], v[72:75], v[168:171]
    v_mfma_f32_16x16x32_bf16 v[172:175], v[124:127], v[72:75], v[172:175]
    v_mfma_f32_16x16x32_bf16 v[176:179], v[112:115], v[76:79], v[176:179]
    v_mfma_f32_16x16x32_bf16 v[180:183], v[116:119], v[76:79], v[180:183]
    v_mfma_f32_16x16x32_bf16 v[184:187], v[120:123], v[76:79], v[184:187]
    v_mfma_f32_16x16x32_bf16 v[188:191], v[124:127], v[76:79], v[188:191]
    s_waitcnt vmcnt(8) lgkmcnt(0)
    s_barrier
    v_mfma_f32_16x16x32_bf16 v[192:195], v[112:115], v[80:83], v[192:195]
    ds_read_b64_tr_b16 v[96:97], v55 offset:0
    ds_read_b64_tr_b16 v[98:99], v55 offset:8192
    v_mfma_f32_16x16x32_bf16 v[196:199], v[116:119], v[80:83], v[196:199]
    ds_read_b64_tr_b16 v[100:101], v57 offset:0
    ds_read_b64_tr_b16 v[102:103], v57 offset:8192
    v_mfma_f32_16x16x32_bf16 v[200:203], v[120:123], v[80:83], v[200:203]
    ds_read_b64_tr_b16 v[104:105], v59 offset:0
    ds_read_b64_tr_b16 v[106:107], v59 offset:8192
    v_mfma_f32_16x16x32_bf16 v[204:207], v[124:127], v[80:83], v[204:207]
    ds_read_b64_tr_b16 v[108:109], v61 offset:0
    ds_read_b64_tr_b16 v[110:111], v61 offset:8192
    v_mfma_f32_16x16x32_bf16 v[208:211], v[112:115], v[84:87], v[208:211]
    ds_read_b128 v[64:67], v53 offset:0
    v_mfma_f32_16x16x32_bf16 v[212:215], v[116:119], v[84:87], v[212:215]
    ds_read_b128 v[68:71], v53 offset:256
    v_mfma_f32_16x16x32_bf16 v[216:219], v[120:123], v[84:87], v[216:219]
    ds_read_b128 v[72:75], v53 offset:2048
    v_mfma_f32_16x16x32_bf16 v[220:223], v[124:127], v[84:87], v[220:223]
    ds_read_b128 v[76:79], v53 offset:2304
    v_mfma_f32_16x16x32_bf16 v[224:227], v[112:115], v[88:91], v[224:227]
    s_add_u32 m0, s21, 32768
    v_mfma_f32_16x16x32_bf16 v[228:231], v[116:119], v[88:91], v[228:231]
    buffer_load_dwordx4 v48, s[4:7], s16 offen offset:0 sc1 lds
    v_mfma_f32_16x16x32_bf16 v[232:235], v[120:123], v[88:91], v[232:235]
    buffer_load_dwordx4 v48, s[4:7], s16 offen offset:1024 sc1 lds
    v_mfma_f32_16x16x32_bf16 v[236:239], v[124:127], v[88:91], v[236:239]
    s_add_u32 m0, s22, 32768
    v_mfma_f32_16x16x32_bf16 v[240:243], v[112:115], v[92:95], v[240:243]
    buffer_load_dwordx4 v49, s[8:11], s17 offen offset:0 lds
    v_mfma_f32_16x16x32_bf16 v[244:247], v[116:119], v[92:95], v[244:247]
    buffer_load_dwordx4 v50, s[8:11], s17 offen offset:1024 lds
    v_mfma_f32_16x16x32_bf16 v[248:251], v[120:123], v[92:95], v[248:251]
    s_add_u32 s16, s16, 2048
    v_mfma_f32_16x16x32_bf16 v[252:255], v[124:127], v[92:95], v[252:255]
    s_add_u32 s17, s17, s18
    s_waitcnt lgkmcnt(0)
    v_mfma_f32_16x16x32_bf16 v[128:131], v[96:99], v[64:67], v[128:131]
    ds_read_b128 v[80:83], v53 offset:4096
    v_mfma_f32_16x16x32_bf16 v[132:135], v[100:103], v[64:67], v[132:135]
    ds_read_b128 v[84:87], v53 offset:4352
    v_mfma_f32_16x16x32_bf16 v[136:139], v[104:107], v[64:67], v[136:139]
    ds_read_b128 v[88:91], v53 offset:6144
    v_mfma_f32_16x16x32_bf16 v[140:143], v[108:111], v[64:67], v[140:143]
    ds_read_b128 v[92:95], v53 offset:6400
    v_mfma_f32_16x16x32_bf16 v[144:147], v[96:99], v[68:71], v[144:147]
    v_mfma_f32_16x16x32_bf16 v[148:151], v[100:103], v[68:71], v[148:151]
    v_mfma_f32_16x16x32_bf16 v[152:155], v[104:107], v[68:71], v[152:155]
    v_mfma_f32_16x16x32_bf16 v[156:159], v[108:111], v[68:71], v[156:159]
    v_mfma_f32_16x16x32_bf16 v[160:163], v[96:99], v[72:75], v[160:163]
    v_mfma_f32_16x16x32_bf16 v[164:167], v[100:103], v[72:75], v[164:167]
    v_mfma_f32_16x16x32_bf16 v[168:171], v[104:107], v[72:75], v[168:171]
    v_mfma_f32_16x16x32_bf16 v[172:175], v[108:111], v[72:75], v[172:175]
    v_mfma_f32_16x16x32_bf16 v[176:179], v[96:99], v[76:79], v[176:179]
    v_mfma_f32_16x16x32_bf16 v[180:183], v[100:103], v[76:79], v[180:183]
    v_mfma_f32_16x16x32_bf16 v[184:187], v[104:107], v[76:79], v[184:187]
    v_mfma_f32_16x16x32_bf16 v[188:191], v[108:111], v[76:79], v[188:191]
    s_waitcnt vmcnt(8) lgkmcnt(0)
    s_barrier
    v_mfma_f32_16x16x32_bf16 v[192:195], v[96:99], v[80:83], v[192:195]
    ds_read_b64_tr_b16 v[112:113], v55 offset:32768
    ds_read_b64_tr_b16 v[114:115], v55 offset:40960
    v_mfma_f32_16x16x32_bf16 v[196:199], v[100:103], v[80:83], v[196:199]
    ds_read_b64_tr_b16 v[116:117], v57 offset:32768
    ds_read_b64_tr_b16 v[118:119], v57 offset:40960
    v_mfma_f32_16x16x32_bf16 v[200:203], v[104:107], v[80:83], v[200:203]
    ds_read_b64_tr_b16 v[120:121], v59 offset:32768
    ds_read_b64_tr_b16 v[122:123], v59 offset:40960
    v_mfma_f32_16x16x32_bf16 v[204:207], v[108:111], v[80:83], v[204:207]
    ds_read_b64_tr_b16 v[124:125], v61 offset:32768
    ds_read_b64_tr_b16 v[126:127], v61 offset:40960
    v_mfma_f32_16x16x32_bf16 v[208:211], v[96:99], v[84:87], v[208:211]
    ds_read_b128 v[64:67], v53 offset:32768
    v_mfma_f32_16x16x32_bf16 v[212:215], v[100:103], v[84:87], v[212:215]
    ds_read_b128 v[68:71], v53 offset:33024
    v_mfma_f32_16x16x32_bf16 v[216:219], v[104:107], v[84:87], v[216:219]
    ds_read_b128 v[72:75], v53 offset:34816
    v_mfma_f32_16x16x32_bf16 v[220:223], v[108:111], v[84:87], v[220:223]
    ds_read_b128 v[76:79], v53 offset:35072
    v_mfma_f32_16x16x32_bf16 v[224:227], v[96:99], v[88:91], v[224:227]
    s_add_u32 m0, s21, 65536
    v_mfma_f32_16x16x32_bf16 v[228:231], v[100:103], v[88:91], v[228:231]
    buffer_load_dwordx4 v48, s[4:7], s16 offen offset:0 sc1 lds
    v_mfma_f32_16x16x32_bf16 v[232:235], v[104:107], v[88:91], v[232:235]
    buffer_load_dwordx4 v48, s[4:7], s16 offen offset:1024 sc1 lds
    v_mfma_f32_16x16x32_bf16 v[236:239], v[108:111], v[88:91], v[236:239]
    s_add_u32 m0, s22, 65536
    v_mfma_f32_16x16x32_bf16 v[240:243], v[96:99], v[92:95], v[240:243]
    buffer_load_dwordx4 v49, s[8:11], s17 offen offset:0 lds
    v_mfma_f32_16x16x32_bf16 v[244:247], v[100:103], v[92:95], v[244:247]
    buffer_load_dwordx4 v50, s[8:11], s17 offen offset:1024 lds
    v_mfma_f32_16x16x32_bf16 v[248:251], v[104:107], v[92:95], v[248:251]
    s_add_u32 s16, s16, 2048
    v_mfma_f32_16x16x32_bf16 v[252:255], v[108:111], v[92:95], v[252:255]
    s_add_u32 s17, s17, s18
    s_waitcnt lgkmcnt(0)
    v_mfma_f32_16x16x32_bf16 v[128:131], v[112:115], v[64:67], v[128:131]
    ds_read_b128 v[80:83], v53 offset:36864
    v_mfma_f32_16x16x32_bf16 v[132:135], v[116:119], v[64:67], v[132:135]
    ds_read_b128 v[84:87], v53 offset:37120
    v_mfma_f32_16x16x32_bf16 v[136:139], v[120:123], v[64:67], v[136:139]
    ds_read_b128 v[88:91], v53 offset:38912
    v_mfma_f32_16x16x32_bf16 v[140:143], v[124:127], v[64:67], v[140:143]
    ds_read_b128 v[92:95], v53 offset:39168
    v_mfma_f32_16x16x32_bf16 v[144:147], v[112:115], v[68:71], v[144:147]
    v_mfma_f32_16x16x32_bf16 v[148:151], v[116:119], v[68:71], v[148:151]
    v_mfma_f32_16x16x32_bf16 v[152:155], v[120:123], v[68:71], v[152:155]
    v_mfma_f32_16x16x32_bf16 v[156:159], v[124:127], v[68:71], v[156:159]
    v_mfma_f32_16x16x32_bf16 v[160:163], v[112:115], v[72:75], v[160:163]
    v_mfma_f32_16x16x32_bf16 v[164:167], v[116:119], v[72:75], v[164:167]
    v_mfma_f32_16x16x32_bf16 v[168:171], v[120:123], v[72:75], v[168:171]
    v_mfma_f32_16x16x32_bf16 v[172:175], v[124:127], v[72:75], v[172:175]
    v_mfma_f32_16x16x32_bf16 v[176:179], v[112:115], v[76:79], v[176:179]
    v_mfma_f32_16x16x32_bf16 v[180:183], v[116:119], v[76:79], v[180:183]
    v_mfma_f32_16x16x32_bf16 v[184:187], v[120:123], v[76:79], v[184:187]
    v_mfma_f32_16x16x32_bf16 v[188:191], v[124:127], v[76:79], v[188:191]
    s_waitcnt vmcnt(8) lgkmcnt(0)
    s_barrier
    v_mfma_f32_16x16x32_bf16 v[192:195], v[112:115], v[80:83], v[192:195]
    ds_read_b64_tr_b16 v[96:97], v54 offset:0
    ds_read_b64_tr_b16 v[98:99], v54 offset:8192
    v_mfma_f32_16x16x32_bf16 v[196:199], v[116:119], v[80:83], v[196:199]
    ds_read_b64_tr_b16 v[100:101], v56 offset:0
    ds_read_b64_tr_b16 v[102:103], v56 offset:8192
    v_mfma_f32_16x16x32_bf16 v[200:203], v[120:123], v[80:83], v[200:203]
    ds_read_b64_tr_b16 v[104:105], v58 offset:0
    ds_read_b64_tr_b16 v[106:107], v58 offset:8192
    v_mfma_f32_16x16x32_bf16 v[204:207], v[124:127], v[80:83], v[204:207]
    ds_read_b64_tr_b16 v[108:109], v60 offset:0
    ds_read_b64_tr_b16 v[110:111], v60 offset:8192
    v_mfma_f32_16x16x32_bf16 v[208:211], v[112:115], v[84:87], v[208:211]
    ds_read_b128 v[64:67], v52 offset:0
    ds_read_b128 v[68:71], v52 offset:256
    v_mfma_f32_16x16x32_bf16 v[212:215], v[116:119], v[84:87], v[212:215]
    ds_read_b128 v[72:75], v52 offset:2048
    ds_read_b128 v[76:79], v52 offset:2304
    v_mfma_f32_16x16x32_bf16 v[216:219], v[120:123], v[84:87], v[216:219]
    s_add_u32 m0, s21, 98304
    v_mfma_f32_16x16x32_bf16 v[220:223], v[124:127], v[84:87], v[220:223]
    buffer_load_dwordx4 v48, s[4:7], s16 offen offset:0 sc1 lds
    v_mfma_f32_16x16x32_bf16 v[224:227], v[112:115], v[88:91], v[224:227]
    buffer_load_dwordx4 v48, s[4:7], s16 offen offset:1024 sc1 lds
    v_mfma_f32_16x16x32_bf16 v[228:231], v[116:119], v[88:91], v[228:231]
    s_add_u32 m0, s22, 98304
    v_mfma_f32_16x16x32_bf16 v[232:235], v[120:123], v[88:91], v[232:235]
    buffer_load_dwordx4 v49, s[8:11], s17 offen offset:0 lds
    v_mfma_f32_16x16x32_bf16 v[236:239], v[124:127], v[88:91], v[236:239]
    buffer_load_dwordx4 v50, s[8:11], s17 offen offset:1024 lds
    v_mfma_f32_16x16x32_bf16 v[240:243], v[112:115], v[92:95], v[240:243]
    s_add_u32 s16, s16, 2048
    v_mfma_f32_16x16x32_bf16 v[244:247], v[116:119], v[92:95], v[244:247]
    s_add_u32 s17, s17, s18
    v_mfma_f32_16x16x32_bf16 v[248:251], v[120:123], v[92:95], v[248:251]
    s_sub_u32 s19, s19, 1
    v_mfma_f32_16x16x32_bf16 v[252:255], v[124:127], v[92:95], v[252:255]
    s_cmp_lg_u32 s19, 0
    s_cbranch_scc1 mk_l1
    s_waitcnt lgkmcnt(0)
    s_mov_b32 s6, 268435456
    s_branch mk_epi
mk_l0:
    s_cmp_lg_u32 s20, 0
    s_cbranch_scc1 mk_l0a
    s_call_b64 s[26:27], mk_serv
mk_l0a:
    s_cmp_lg_u32 s19, 1
    s_cbranch_scc1 mk_l0b
    s_call_b64 s[26:27], mk_switch
mk_l0b:
    s_waitcnt lgkmcnt(0)
    v_mfma_f32_16x16x32_bf16 v[128:131], v[64:67], v[96:99], v[128:131]
    ds_read_b128 v[80:83], v52 offset:4096
    v_mfma_f32_16x16x32_bf16 v[132:135], v[64:67], v[100:103], v[132:135]
    ds_read_b128 v[84:87], v52 offset:4352
    v_mfma_f32_16x16x32_bf16 v[136:139], v[64:67], v[104:107], v[136:139]
    ds_read_b128 v[88:91], v52 offset:6144
    v_mfma_f32_16x16x32_bf16 v[140:143], v[64:67], v[108:111], v[140:143]
    ds_read_b128 v[92:95], v52 offset:6400
    v_mfma_f32_16x16x32_bf16 v[144:147], v[68:71], v[96:99], v[144:147]
    v_mfma_f32_16x16x32_bf16 v[148:151], v[68:71], v[100:103], v[148:151]
    v_mfma_f32_16x16x32_bf16 v[152:155], v[68:71], v[104:107], v[152:155]
    v_mfma_f32_16x16x32_bf16 v[156:159], v[68:71], v[108:111], v[156:159]
    v_mfma_f32_16x16x32_bf16 v[160:163], v[72:75], v[96:99], v[160:163]
    v_mfma_f32_16x16x32_bf16 v[164:167], v[72:75], v[100:103], v[164:167]
    v_mfma_f32_16x16x32_bf16 v[168:171], v[72:75], v[104:107], v[168:171]
    v_mfma_f32_16x16x32_bf16 v[172:175], v[72:75], v[108:111], v[172:175]
    v_mfma_f32_16x16x32_bf16 v[176:179], v[76:79], v[96:99], v[176:179]
    v_mfma_f32_16x16x32_bf16 v[180:183], v[76:79], v[100:103], v[180:183]
    v_mfma_f32_16x16x32_bf16 v[184:187], v[76:79], v[104:107], v[184:187]
    v_mfma_f32_16x16x32_bf16 v[188:191], v[76:79], v[108:111], v[188:191]
    s_waitcnt vmcnt(8) lgkmcnt(0)
    s_barrier
    v_mfma_f32_16x16x32_bf16 v[192:195], v[80:83], v[96:99], v[192:195]
    ds_read_b64_tr_b16 v[112:113], v54 offset:32768
    ds_read_b64_tr_b16 v[114:115], v54 offset:40960
    v_mfma_f32_16x16x32_bf16 v[196:199], v[80:83], v[100:103], v[196:199]
    ds_read_b64_tr_b16 v[116:117], v56 offset:32768
    ds_read_b64_tr_b16 v[118:119], v56 offset:40960
    v_mfma_f32_16x16x32_bf16 v[200:203], v[80:83], v[104:107], v[200:203]
    ds_read_b64_tr_b16 v[120:121], v58 offset:32768
    ds_read_b64_tr_b16 v[122:123], v58 offset:40960
    v_mfma_f32_16x16x32_bf16 v[204:207], v[80:83], v[108:111], v[204:207]
    ds_read_b64_tr_b16 v[124:125], v60 offset:32768
    ds_read_b64_tr_b16 v[126:127], v60 offset:40960
    v_mfma_f32_16x16x32_bf16 v[208:211], v[84:87], v[96:99], v[208:211]
    ds_read_b128 v[64:67], v52 offset:32768
    v_mfma_f32_16x16x32_bf16 v[212:215], v[84:87], v[100:103], v[212:215]
    ds_read_b128 v[68:71], v52 offset:33024
    v_mfma_f32_16x16x32_bf16 v[216:219], v[84:87], v[104:107], v[216:219]
    ds_read_b128 v[72:75], v52 offset:34816
    v_mfma_f32_16x16x32_bf16 v[220:223], v[84:87], v[108:111], v[220:223]
    ds_read_b128 v[76:79], v52 offset:35072
    v_mfma_f32_16x16x32_bf16 v[224:227], v[88:91], v[96:99], v[224:227]
    s_add_u32 m0, s21, 0
    v_mfma_f32_16x16x32_bf16 v[228:231], v[88:91], v[100:103], v[228:231]
    buffer_load_dwordx4 v48, s[4:7], s16 offen offset:0 sc1 lds
    v_mfma_f32_16x16x32_bf16 v[232:235], v[88:91], v[104:107], v[232:235]
    buffer_load_dwordx4 v48, s[4:7], s16 offen offset:1024 sc1 lds
    v_mfma_f32_16x16x32_bf16 v[236:239], v[88:91], v[108:111], v[236:239]
    s_add_u32 m0, s22, 0
    v_mfma_f32_16x16x32_bf16 v[240:243], v[92:95], v[96:99], v[240:243]
    buffer_load_dwordx4 v49, s[8:11], s17 offen offset:0 lds
    v_mfma_f32_16x16x32_bf16 v[244:247], v[92:95], v[100:103], v[244:247]
    buffer_load_dwordx4 v50, s[8:11], s17 offen offset:1024 lds
    v_mfma_f32_16x16x32_bf16 v[248:251], v[92:95], v[104:107], v[248:251]
    s_add_u32 s16, s16, 2048
    v_mfma_f32_16x16x32_bf16 v[252:255], v[92:95], v[108:111], v[252:255]
    s_add_u32 s17, s17, s18
    s_waitcnt lgkmcnt(0)
    v_mfma_f32_16x16x32_bf16 v[128:131], v[64:67], v[112:115], v[128:131]
    ds_read_b128 v[80:83], v52 offset:36864
    v_mfma_f32_16x16x32_bf16 v[132:135], v[64:67], v[116:119], v[132:135]
    ds_read_b128 v[84:87], v52 offset:37120
    v_mfma_f32_16x16x32_bf16 v[136:139], v[64:67], v[120:123], v[136:139]
    ds_read_b128 v[88:91], v52 offset:38912
    v_mfma_f32_16x16x32_bf16 v[140:143], v[64:67], v[124:127], v[140:143]
    ds_read_b128 v[92:95], v52 offset:39168
    v_mfma_f32_16x16x32_bf16 v[144:147], v[68:71], v[112:115], v[144:147]
    v_mfma_f32_16x16x32_bf16 v[148:151], v[68:71], v[116:119], v[148:151]
    v_mfma_f32_16x16x32_bf16 v[152:155], v[68:71], v[120:123], v[152:155]
    v_mfma_f32_16x16x32_bf16 v[156:159], v[68:71], v[124:127], v[156:159]
    v_mfma_f32_16x16x32_bf16 v[160:163], v[72:75], v[112:115], v[160:163]
    v_mfma_f32_16x16x32_bf16 v[164:167], v[72:75], v[116:119], v[164:167]
    v_mfma_f32_16x16x32_bf16 v[168:171], v[72:75], v[120:123], v[168:171]
    v_mfma_f32_16x16x32_bf16 v[172:175], v[72:75], v[124:127], v[172:175]
    v_mfma_f32_16x16x32_bf16 v[176:179], v[76:79], v[112:115], v[176:179]
    v_mfma_f32_16x16x32_bf16 v[180:183], v[76:79], v[116:119], v[180:183]
    v_mfma_f32_16x16x32_bf16 v[184:187], v[76:79], v[120:123], v[184:187]
    v_mfma_f32_16x16x32_bf16 v[188:191], v[76:79], v[124:127], v[188:191]
    s_waitcnt vmcnt(8) lgkmcnt(0)
    s_barrier
    v_mfma_f32_16x16x32_bf16 v[192:195], v[80:83], v[112:115], v[192:195]
    ds_read_b64_tr_b16 v[96:97], v55 offset:0
    ds_read_b64_tr_b16 v[98:99], v55 offset:8192
    v_mfma_f32_16x16x32_bf16 v[196:199], v[80:83], v[116:119], v[196:199]
    ds_read_b64_tr_b16 v[100:101], v57 offset:0
    ds_read_b64_tr_b16 v[102:103], v57 offset:8192
    v_mfma_f32_16x16x32_bf16 v[200:203], v[80:83], v[120:123], v[200:203]
    ds_read_b64_tr_b16 v[104:105], v59 offset:0
    ds_read_b64_tr_b16 v[106:107], v59 offset:8192
    v_mfma_f32_16x16x32_bf16 v[204:207], v[80:83], v[124:127], v[204:207]
    ds_read_b64_tr_b16 v[108:109], v61 offset:0
    ds_read_b64_tr_b16 v[110:111], v61 offset:8192
    v_mfma_f32_16x16x32_bf16 v[208:211], v[84:87], v[112:115], v[208:211]
    ds_read_b128 v[64:67], v53 offset:0
    v_mfma_f32_16x16x32_bf16 v[212:215], v[84:87], v[116:119], v[212:215]
    ds_read_b128 v[68:71], v53 offset:256
    v_mfma_f32_16x16x32_bf16 v[216:219], v[84:87], v[120:123], v[216:219]
    ds_read_b128 v[72:75], v53 offset:2048
    v_mfma_f32_16x16x32_bf16 v[220:223], v[84:87], v[124:127], v[220:223]
    ds_read_b128 v[76:79], v53 offset:2304
    v_mfma_f32_16x16x32_bf16 v[224:227], v[88:91], v[112:115], v[224:227]
    s_add_u32 m0, s21, 32768
    v_mfma_f32_16x16x32_bf16 v[228:231], v[88:91], v[116:119], v[228:231]
    buffer_load_dwordx4 v48, s[4:7], s16 offen offset:0 sc1 lds
    v_mfma_f32_16x16x32_bf16 v[232:235], v[88:91], v[120:123], v[232:235]
    buffer_load_dwordx4 v48, s[4:7], s16 offen offset:1024 sc1 lds
    v_mfma_f32_16x16x32_bf16 v[236:239], v[88:91], v[124:127], v[236:239]
    s_add_u32 m0, s22, 32768
    v_mfma_f32_16x16x32_bf16 v[240:243], v[92:95], v[112:115], v[240:243]
    buffer_load_dwordx4 v49, s[8:11], s17 offen offset:0 lds
    v_mfma_f32_16x16x32_bf16 v[244:247], v[92:95], v[116:119], v[244:247]
    buffer_load_dwordx4 v50, s[8:11], s17 offen offset:1024 lds
    v_mfma_f32_16x16x32_bf16 v[248:251], v[92:95], v[120:123], v[248:251]
    s_add_u32 s16, s16, 2048
    v_mfma_f32_16x16x32_bf16 v[252:255], v[92:95], v[124:127], v[252:255]
    s_add_u32 s17, s17, s18
    s_waitcnt lgkmcnt(0)
    v_mfma_f32_16x16x32_bf16 v[128:131], v[64:67], v[96:99], v[128:131]
    ds_read_b128 v[80:83], v53 offset:4096
    v_mfma_f32_16x16x32_bf16 v[132:135], v[64:67], v[100:103], v[132:135]
    ds_read_b128 v[84:87], v53 offset:4352
    v_mfma_f32_16x16x32_bf16 v[136:139], v[64:67], v[104:107], v[136:139]
    ds_read_b128 v[88:91], v53 offset:6144
    v_mfma_f32_16x16x32_bf16 v[140:143], v[64:67], v[108:111], v[140:143]
    ds_read_b128 v[92:95], v53 offset:6400
    v_mfma_f32_16x16x32_bf16 v[144:147], v[68:71], v[96:99], v[144:147]
    v_mfma_f32_16x16x32_bf16 v[148:151], v[68:71], v[100:103], v[148:151]
    v_mfma_f32_16x16x32_bf16 v[152:155], v[68:71], v[104:107], v[152:155]
    v_mfma_f32_16x16x32_bf16 v[156:159], v[68:71], v[108:111], v[156:159]
    v_mfma_f32_16x16x32_bf16 v[160:163], v[72:75], v[96:99], v[160:163]
    v_mfma_f32_16x16x32_bf16 v[164:167], v[72:75], v[100:103], v[164:167]
    v_mfma_f32_16x16x32_bf16 v[168:171], v[72:75], v[104:107], v[168:171]
    v_mfma_f32_16x16x32_bf16 v[172:175], v[72:75], v[108:111], v[172:175]
    v_mfma_f32_16x16x32_bf16 v[176:179], v[76:79], v[96:99], v[176:179]
    v_mfma_f32_16x16x32_bf16 v[180:183], v[76:79], v[100:103], v[180:183]
    v_mfma_f32_16x16x32_bf16 v[184:187], v[76:79], v[104:107], v[184:187]
    v_mfma_f32_16x16x32_bf16 v[188:191], v[76:79], v[108:111], v[188:191]
    s_waitcnt vmcnt(8) lgkmcnt(0)
    s_barrier
    v_mfma_f32_16x16x32_bf16 v[192:195], v[80:83], v[96:99], v[192:195]
    ds_read_b64_tr_b16 v[112:113], v55 offset:32768
    ds_read_b64_tr_b16 v[114:115], v55 offset:40960
    v_mfma_f32_16x16x32_bf16 v[196:199], v[80:83], v[100:103], v[196:199]
    ds_read_b64_tr_b16 v[116:117], v57 offset:32768
    ds_read_b64_tr_b16 v[118:119], v57 offset:40960
    v_mfma_f32_16x16x32_bf16 v[200:203], v[80:83], v[104:107], v[200:203]
    ds_read_b64_tr_b16 v[120:121], v59 offset:32768
    ds_read_b64_tr_b16 v[122:123], v59 offset:40960
    v_mfma_f32_16x16x32_bf16 v[204:207], v[80:83], v[108:111], v[204:207]
    ds_read_b64_tr_b16 v[124:125], v61 offset:32768
    ds_read_b64_tr_b16 v[126:127], v61 offset:40960
    v_mfma_f32_16x16x32_bf16 v[208:211], v[84:87], v[96:99], v[208:211]
    ds_read_b128 v[64:67], v53 offset:32768
    v_mfma_f32_16x16x32_bf16 v[212:215], v[84:87], v[100:103], v[212:215]
    ds_read_b128 v[68:71], v53 offset:33024
    v_mfma_f32_16x16x32_bf16 v[216:219], v[84:87], v[104:107], v[216:219]
    ds_read_b128 v[72:75], v53 offset:34816
    v_mfma_f32_16x16x32_bf16 v[220:223], v[84:87], v[108:111], v[220:223]
    ds_read_b128 v[76:79], v53 offset:35072
    v_mfma_f32_16x16x32_bf16 v[224:227], v[88:91], v[96:99], v[224:227]
    s_add_u32 m0, s21, 65536
    v_mfma_f32_16x16x32_bf16 v[228:231], v[88:91], v[100:103], v[228:231]
    buffer_load_dwordx4 v48, s[4:7], s16 offen offset:0 sc1 lds
    v_mfma_f32_16x16x32_bf16 v[232:235], v[88:91], v[104:107], v[232:235]
    buffer_load_dwordx4 v48, s[4:7], s16 offen offset:1024 sc1 lds
    v_mfma_f32_16x16x32_bf16 v[236:239], v[88:91], v[108:111], v[236:239]
    s_add_u32 m0, s22, 65536
    v_mfma_f32_16x16x32_bf16 v[240:243], v[92:95], v[96:99], v[240:243]
    buffer_load_dwordx4 v49, s[8:11], s17 offen offset:0 lds
    v_mfma_f32_16x16x32_bf16 v[244:247], v[92:95], v[100:103], v[244:247]
    buffer_load_dwordx4 v50, s[8:11], s17 offen offset:1024 lds
    v_mfma_f32_16x16x32_bf16 v[248:251], v[92:95], v[104:107], v[248:251]
    s_add_u32 s16, s16, 2048
    v_mfma_f32_16x16x32_bf16 v[252:255], v[92:95], v[108:111], v[252:255]
    s_add_u32 s17, s17, s18
    s_waitcnt lgkmcnt(0)
    v_mfma_f32_16x16x32_bf16 v[128:131], v[64:67], v[112:115], v[128:131]
    ds_read_b128 v[80:83], v53 offset:36864
    v_mfma_f32_16x16x32_bf16 v[132:135], v[64:67], v[116:119], v[132:135]
    ds_read_b128 v[84:87], v53 offset:37120
    v_mfma_f32_16x16x32_bf16 v[136:139], v[64:67], v[120:123], v[136:139]
    ds_read_b128 v[88:91], v53 offset:38912
    v_mfma_f32_16x16x32_bf16 v[140:143], v[64:67], v[124:127], v[140:143]
    ds_read_b128 v[92:95], v53 offset:39168
    v_mfma_f32_16x16x32_bf16 v[144:147], v[68:71], v[112:115], v[144:147]
    v_mfma_f32_16x16x32_bf16 v[148:151], v[68:71], v[116:119], v[148:151]
    v_mfma_f32_16x16x32_bf16 v[152:155], v[68:71], v[120:123], v[152:155]
    v_mfma_f32_16x16x32_bf16 v[156:159], v[68:71], v[124:127], v[156:159]
    v_mfma_f32_16x16x32_bf16 v[160:163], v[72:75], v[112:115], v[160:163]
    v_mfma_f32_16x16x32_bf16 v[164:167], v[72:75], v[116:119], v[164:167]
    v_mfma_f32_16x16x32_bf16 v[168:171], v[72:75], v[120:123], v[168:171]
    v_mfma_f32_16x16x32_bf16 v[172:175], v[72:75], v[124:127], v[172:175]
    v_mfma_f32_16x16x32_bf16 v[176:179], v[76:79], v[112:115], v[176:179]
    v_mfma_f32_16x16x32_bf16 v[180:183], v[76:79], v[116:119], v[180:183]
    v_mfma_f32_16x16x32_bf16 v[184:187], v[76:79], v[120:123], v[184:187]
    v_mfma_f32_16x16x32_bf16 v[188:191], v[76:79], v[124:127], v[188:191]
    s_waitcnt vmcnt(8) lgkmcnt(0)
    s_barrier
    v_mfma_f32_16x16x32_bf16 v[192:195], v[80:83], v[112:115], v[192:195]
    ds_read_b64_tr_b16 v[96:97], v54 offset:0
    ds_read_b64_tr_b16 v[98:99], v54 offset:8192
    v_mfma_f32_16x16x32_bf16 v[196:199], v[80:83], v[116:119], v[196:199]
    ds_read_b64_tr_b16 v[100:101], v56 offset:0
    ds_read_b64_tr_b16 v[102:103], v56 offset:8192
    v_mfma_f32_16x16x32_bf16 v[200:203], v[80:83], v[120:123], v[200:203]
    ds_read_b64_tr_b16 v[104:105], v58 offset:0
    ds_read_b64_tr_b16 v[106:107], v58 offset:8192
    v_mfma_f32_16x16x32_bf16 v[204:207], v[80:83], v[124:127], v[204:207]
    ds_read_b64_tr_b16 v[108:109], v60 offset:0
    ds_read_b64_tr_b16 v[110:111], v60 offset:8192
    v_mfma_f32_16x16x32_bf16 v[208:211], v[84:87], v[112:115], v[208:211]
    ds_read_b128 v[64:67], v52 offset:0
    ds_read_b128 v[68:71], v52 offset:256
    v_mfma_f32_16x16x32_bf16 v[212:215], v[84:87], v[116:119], v[212:215]
    ds_read_b128 v[72:75], v52 offset:2048
    ds_read_b128 v[76:79], v52 offset:2304
    v_mfma_f32_16x16x32_bf16 v[216:219], v[84:87], v[120:123], v[216:219]
    s_add_u32 m0, s21, 98304
    v_mfma_f32_16x16x32_bf16 v[220:223], v[84:87], v[124:127], v[220:223]
    buffer_load_dwordx4 v48, s[4:7], s16 offen offset:0 sc1 lds
    v_mfma_f32_16x16x32_bf16 v[224:227], v[88:91], v[112:115], v[224:227]
    buffer_load_dwordx4 v48, s[4:7], s16 offen offset:1024 sc1 lds
    v_mfma_f32_16x16x32_bf16 v[228:231], v[88:91], v[116:119], v[228:231]
    s_add_u32 m0, s22, 98304
    v_mfma_f32_16x16x32_bf16 v[232:235], v[88:91], v[120:123], v[232:235]
    buffer_load_dwordx4 v49, s[8:11], s17 offen offset:0 lds
    v_mfma_f32_16x16x32_bf16 v[236:239], v[88:91], v[124:127], v[236:239]
    buffer_load_dwordx4 v50, s[8:11], s17 offen offset:1024 lds
    v_mfma_f32_16x16x32_bf16 v[240:243], v[92:95], v[112:115], v[240:243]
    s_add_u32 s16, s16, 2048
    v_mfma_f32_16x16x32_bf16 v[244:247], v[92:95], v[116:119], v[244:247]
    s_add_u32 s17, s17, s18
    v_mfma_f32_16x16x32_bf16 v[248:251], v[92:95], v[120:123], v[248:251]
    s_sub_u32 s19, s19, 1
    v_mfma_f32_16x16x32_bf16 v[252:255], v[92:95], v[124:127], v[252:255]
    s_cmp_lg_u32 s19, 0
    s_cbranch_scc1 mk_l0
    s_waitcnt lgkmcnt(0)
    s_mov_b32 s6, 268435456
    s_nop 15
    s_add_u32 s25, s37, 0
    v_cvt_pk_bf16_f32 v64, v128, v129
    v_cvt_pk_bf16_f32 v65, v130, v131
    v_cvt_pk_bf16_f32 v66, v144, v145
    v_cvt_pk_bf16_f32 v67, v146, v147
    buffer_store_dwordx4 v[64:67], v46, s[4:7], s25 offen offset:0 sc1
    v_cvt_pk_bf16_f32 v68, v132, v133
    v_cvt_pk_bf16_f32 v69, v134, v135
    v_cvt_pk_bf16_f32 v70, v148, v149
    v_cvt_pk_bf16_f32 v71, v150, v151
    buffer_store_dwordx4 v[68:71], v46, s[4:7], s25 offen offset:256 sc1
    v_cvt_pk_bf16_f32 v72, v136, v137
    v_cvt_pk_bf16_f32 v73, v138, v139
    v_cvt_pk_bf16_f32 v74, v152, v153
    v_cvt_pk_bf16_f32 v75, v154, v155
    buffer_store_dwordx4 v[72:75], v46, s[4:7], s25 offen offset:2048 sc1
    v_cvt_pk_bf16_f32 v76, v140, v141
    v_cvt_pk_bf16_f32 v77, v142, v143
    v_cvt_pk_bf16_f32 v78, v156, v157
    v_cvt_pk_bf16_f32 v79, v158, v159
    buffer_store_dwordx4 v[76:79], v46, s[4:7], s25 offen offset:2304 sc1
    s_add_u32 s25, s37, 262144
    v_cvt_pk_bf16_f32 v80, v160, v161
    v_cvt_pk_bf16_f32 v81, v162, v163
    v_cvt_pk_bf16_f32 v82, v176, v177
    v_cvt_pk_bf16_f32 v83, v178, v179
    buffer_store_dwordx4 v[80:83], v46, s[4:7], s25 offen offset:0 sc1
    v_cvt_pk_bf16_f32 v84, v164, v165
    v_cvt_pk_bf16_f32 v85, v166, v167
    v_cvt_pk_bf16_f32 v86, v180, v181
    v_cvt_pk_bf16_f32 v87, v182, v183
    buffer_store_dwordx4 v[84:87], v46, s[4:7], s25 offen offset:256 sc1
    v_cvt_pk_bf16_f32 v88, v168, v169
    v_cvt_pk_bf16_f32 v89, v170, v171
    v_cvt_pk_bf16_f32 v90, v184, v185
    v_cvt_pk_bf16_f32 v91, v186, v187
    buffer_store_dwordx4 v[88:91], v46, s[4:7], s25 offen offset:2048 sc1
    v_cvt_pk_bf16_f32 v92, v172, v173
    v_cvt_pk_bf16_f32 v93, v174, v175
    v_cvt_pk_bf16_f32 v94, v188, v189
    v_cvt_pk_bf16_f32 v95, v190, v191
    buffer_store_dwordx4 v[92:95], v46, s[4:7], s25 offen offset:2304 sc1
    s_add_u32 s25, s37, 524288
    v_cvt_pk_bf16_f32 v64, v192, v193
    v_cvt_pk_bf16_f32 v65, v194, v195
    v_cvt_pk_bf16_f32 v66, v208, v209
    v_cvt_pk_bf16_f32 v67, v210, v211
    buffer_store_dwordx4 v[64:67], v46, s[4:7], s25 offen offset:0 sc1
    v_cvt_pk_bf16_f32 v68, v196, v197
    v_cvt_pk_bf16_f32 v69, v198, v199
    v_cvt_pk_bf16_f32 v70, v212, v213
    v_cvt_pk_bf16_f32 v71, v214, v215
    buffer_store_dwordx4 v[68:71], v46, s[4:7], s25 offen offset:256 sc1
    v_cvt_pk_bf16_f32 v72, v200, v201
    v_cvt_pk_bf16_f32 v73, v202, v203
    v_cvt_pk_bf16_f32 v74, v216, v217
    v_cvt_pk_bf16_f32 v75, v218, v219
    buffer_store_dwordx4 v[72:75], v46, s[4:7], s25 offen offset:2048 sc1
    v_cvt_pk_bf16_f32 v76, v204, v205
    v_cvt_pk_bf16_f32 v77, v206, v207
    v_cvt_pk_bf16_f32 v78, v220, v221
    v_cvt_pk_bf16_f32 v79, v222, v223
    buffer_store_dwordx4 v[76:79], v46, s[4:7], s25 offen offset:2304 sc1
    s_add_u32 s25, s37, 786432
    v_cvt_pk_bf16_f32 v80, v224, v225
    v_cvt_pk_bf16_f32 v81, v226, v227
    v_cvt_pk_bf16_f32 v82, v240, v241
    v_cvt_pk_bf16_f32 v83, v242, v243
    buffer_store_dwordx4 v[80:83], v46, s[4:7], s25 offen offset:0 sc1
    v_cvt_pk_bf16_f32 v84, v228, v229
    v_cvt_pk_bf16_f32 v85, v230, v231
    v_cvt_pk_bf16_f32 v86, v244, v245
    v_cvt_pk_bf16_f32 v87, v246, v247
    buffer_store_dwordx4 v[84:87], v46, s[4:7], s25 offen offset:256 sc1
    v_cvt_pk_bf16_f32 v88, v232, v233
    v_cvt_pk_bf16_f32 v89, v234, v235
    v_cvt_pk_bf16_f32 v90, v248, v249
    v_cvt_pk_bf16_f32 v91, v250, v251
    buffer_store_dwordx4 v[88:91], v46, s[4:7], s25 offen offset:2048 sc1
    v_cvt_pk_bf16_f32 v92, v236, v237
    v_cvt_pk_bf16_f32 v93, v238, v239
    v_cvt_pk_bf16_f32 v94, v252, v253
    v_cvt_pk_bf16_f32 v95, v254, v255
    buffer_store_dwordx4 v[92:95], v46, s[4:7], s25 offen offset:2304 sc1
    s_mov_b32 s57, 4
    s_branch mk_done
mk_epi:
    s_nop 15
    s_lshr_b32 s23, s79, 5
    s_cmp_eq_u32 s23, 2
    s_cbranch_scc1 mk_eh
    s_cmp_eq_u32 s23, 3
    s_cbranch_scc1 mk_ef
    s_cmp_eq_u32 s23, 4
    s_cbranch_scc1 mk_efs
    s_add_u32 s25, s37, 0
    v_cvt_pk_bf16_f32 v64, v128, v132
    v_cvt_pk_bf16_f32 v65, v129, v133
    v_cvt_pk_bf16_f32 v66, v130, v134
    v_cvt_pk_bf16_f32 v67, v131, v135
    buffer_store_dwordx4 v[64:67], v46, s[4:7], s25 offen offset:0 sc1
    v_cvt_pk_bf16_f32 v68, v144, v148
    v_cvt_pk_bf16_f32 v69, v145, v149
    v_cvt_pk_bf16_f32 v70, v146, v150
    v_cvt_pk_bf16_f32 v71, v147, v151
    buffer_store_dwordx4 v[68:71], v46, s[4:7], s25 offen offset:256 sc1
    v_cvt_pk_bf16_f32 v72, v136, v140
    v_cvt_pk_bf16_f32 v73, v137, v141
    v_cvt_pk_bf16_f32 v74, v138, v142
    v_cvt_pk_bf16_f32 v75, v139, v143
    buffer_store_dwordx4 v[72:75], v46, s[4:7], s25 offen offset:2048 sc1
    v_cvt_pk_bf16_f32 v76, v152, v156
    v_cvt_pk_bf16_f32 v77, v153, v157
    v_cvt_pk_bf16_f32 v78, v154, v158
    v_cvt_pk_bf16_f32 v79, v155, v159
    buffer_store_dwordx4 v[76:79], v46, s[4:7], s25 offen offset:2304 sc1
    s_add_u32 s25, s37, 262144
    v_cvt_pk_bf16_f32 v80, v160, v164
    v_cvt_pk_bf16_f32 v81, v161, v165
    v_cvt_pk_bf16_f32 v82, v162, v166
    v_cvt_pk_bf16_f32 v83, v163, v167
    buffer_store_dwordx4 v[80:83], v46, s[4:7], s25 offen offset:0 sc1
    v_cvt_pk_bf16_f32 v84, v176, v180
    v_cvt_pk_bf16_f32 v85, v177, v181
    v_cvt_pk_bf16_f32 v86, v178, v182
    v_cvt_pk_bf16_f32 v87, v179, v183
    buffer_store_dwordx4 v[84:87], v46, s[4:7], s25 offen offset:256 sc1
    v_cvt_pk_bf16_f32 v88, v168, v172
    v_cvt_pk_bf16_f32 v89, v169, v173
    v_cvt_pk_bf16_f32 v90, v170, v174
    v_cvt_pk_bf16_f32 v91, v171, v175
    buffer_store_dwordx4 v[88:91], v46, s[4:7], s25 offen offset:2048 sc1
    v_cvt_pk_bf16_f32 v92, v184, v188
    v_cvt_pk_bf16_f32 v93, v185, v189
    v_cvt_pk_bf16_f32 v94, v186, v190
    v_cvt_pk_bf16_f32 v95, v187, v191
    buffer_store_dwordx4 v[92:95], v46, s[4:7], s25 offen offset:2304 sc1
    s_add_u32 s25, s37, 524288
    v_cvt_pk_bf16_f32 v64, v192, v196
    v_cvt_pk_bf16_f32 v65, v193, v197
    v_cvt_pk_bf16_f32 v66, v194, v198
    v_cvt_pk_bf16_f32 v67, v195, v199
    buffer_store_dwordx4 v[64:67], v46, s[4:7], s25 offen offset:0 sc1
    v_cvt_pk_bf16_f32 v68, v208, v212
    v_cvt_pk_bf16_f32 v69, v209, v213
    v_cvt_pk_bf16_f32 v70, v210, v214
    v_cvt_pk_bf16_f32 v71, v211, v215
    buffer_store_dwordx4 v[68:71], v46, s[4:7], s25 offen offset:256 sc1
    v_cvt_pk_bf16_f32 v72, v200, v204
    v_cvt_pk_bf16_f32 v73, v201, v205
    v_cvt_pk_bf16_f32 v74, v202, v206
    v_cvt_pk_bf16_f32 v75, v203, v207
    buffer_store_dwordx4 v[72:75], v46, s[4:7], s25 offen offset:2048 sc1
    v_cvt_pk_bf16_f32 v76, v216, v220
    v_cvt_pk_bf16_f32 v77, v217, v221
    v_cvt_pk_bf16_f32 v78, v218, v222
    v_cvt_pk_bf16_f32 v79, v219, v223
    buffer_store_dwordx4 v[76:79], v46, s[4:7], s25 offen offset:2304 sc1
    s_add_u32 s25, s37, 786432
    v_cvt_pk_bf16_f32 v80, v224, v228
    v_cvt_pk_bf16_f32 v81, v225, v229
    v_cvt_pk_bf16_f32 v82, v226, v230
    v_cvt_pk_bf16_f32 v83, v227, v231
    buffer_store_dwordx4 v[80:83], v46, s[4:7], s25 offen offset:0 sc1
    v_cvt_pk_bf16_f32 v84, v240, v244
    v_cvt_pk_bf16_f32 v85, v241, v245
    v_cvt_pk_bf16_f32 v86, v242, v246
    v_cvt_pk_bf16_f32 v87, v243, v247
    buffer_store_dwordx4 v[84:87], v46, s[4:7], s25 offen offset:256 sc1
    v_cvt_pk_bf16_f32 v88, v232, v236
    v_cvt_pk_bf16_f32 v89, v233, v237
    v_cvt_pk_bf16_f32 v90, v234, v238
    v_cvt_pk_bf16_f32 v91, v235, v239
    buffer_store_dwordx4 v[88:91], v46, s[4:7], s25 offen offset:2048 sc1
    v_cvt_pk_bf16_f32 v92, v248, v252
    v_cvt_pk_bf16_f32 v93, v249, v253
    v_cvt_pk_bf16_f32 v94, v250, v254
    v_cvt_pk_bf16_f32 v95, v251, v255
    buffer_store_dwordx4 v[92:95], v46, s[4:7], s25 offen offset:2304 sc1
    s_mov_b32 s57, 4
    s_branch mk_done
mk_eh:
    v_lshlrev_b32 v8, 16, v24
    v_and_b32 v9, 0xffff0000, v24
    v_lshlrev_b32 v10, 16, v25
    v_and_b32 v11, 0xffff0000, v25
    v_lshlrev_b32 v12, 16, v26
    v_and_b32 v13, 0xffff0000, v26
    v_lshlrev_b32 v14, 16, v27
    v_and_b32 v15, 0xffff0000, v27
    v_lshlrev_b32 v16, 16, v28
    v_and_b32 v17, 0xffff0000, v28
    v_lshlrev_b32 v18, 16, v29
    v_and_b32 v19, 0xffff0000, v29
    v_lshlrev_b32 v20, 16, v30
    v_and_b32 v21, 0xffff0000, v30
    v_lshlrev_b32 v22, 16, v31
    v_and_b32 v23, 0xffff0000, v31
    s_mov_b32 s60, 0x3fb8aa3b
    s_mov_b32 s61, s60
    s_mov_b32 s62, 2.0
    s_mov_b32 s63, 2.0
    s_mov_b32 s64, 0x422c0000
    s_add_u32 s25, s37, 0
    v_pk_add_f32 v[128:129], v[128:129], v[8:9]
    v_pk_add_f32 v[130:131], v[130:131], v[10:11]
    v_pk_add_f32 v[132:133], v[132:133], v[12:13]
    v_pk_add_f32 v[134:135], v[134:135], v[14:15]
    v_pk_mul_f32 v[96:97], v[128:129], s[60:61]
    v_pk_mul_f32 v[98:99], v[130:131], s[60:61]
    v_pk_mul_f32 v[100:101], v[132:133], s[60:61]
    v_pk_mul_f32 v[102:103], v[134:135], s[60:61]
    v_min_f32 v96, s64, v96
    v_min_f32 v97, s64, v97
    v_min_f32 v98, s64, v98
    v_min_f32 v99, s64, v99
    v_min_f32 v100, s64, v100
    v_min_f32 v101, s64, v101
    v_min_f32 v102, s64, v102
    v_min_f32 v103, s64, v103
    v_exp_f32 v96, v96
    v_exp_f32 v97, v97
    v_exp_f32 v98, v98
    v_exp_f32 v99, v99
    v_exp_f32 v100, v100
    v_exp_f32 v101, v101
    v_exp_f32 v102, v102
    v_exp_f32 v103, v103
    v_pk_add_f32 v[104:105], v[96:97], s[62:63]
    v_pk_add_f32 v[106:107], v[98:99], s[62:63]
    v_pk_add_f32 v[108:109], v[100:101], s[62:63]
    v_pk_add_f32 v[110:111], v[102:103], s[62:63]
    v_pk_mul_f32 v[96:97], v[96:97], v[104:105]
    v_pk_mul_f32 v[98:99], v[98:99], v[106:107]
    v_pk_mul_f32 v[100:101], v[100:101], v[108:109]
    v_pk_mul_f32 v[102:103], v[102:103], v[110:111]
    v_pk_add_f32 v[104:105], v[96:97], s[62:63]
    v_pk_add_f32 v[106:107], v[98:99], s[62:63]
    v_pk_add_f32 v[108:109], v[100:101], s[62:63]
    v_pk_add_f32 v[110:111], v[102:103], s[62:63]
    v_rcp_f32 v104, v104
    v_rcp_f32 v105, v105
    v_rcp_f32 v106, v106
    v_rcp_f32 v107, v107
    v_rcp_f32 v108, v108
    v_rcp_f32 v109, v109
    v_rcp_f32 v110, v110
    v_rcp_f32 v111, v111
    v_pk_mul_f32 v[96:97], v[96:97], v[104:105]
    v_pk_mul_f32 v[98:99], v[98:99], v[106:107]
    v_pk_mul_f32 v[100:101], v[100:101], v[108:109]
    v_pk_mul_f32 v[102:103], v[102:103], v[110:111]
    v_pk_mul_f32 v[128:129], v[128:129], v[96:97]
    v_pk_mul_f32 v[130:131], v[130:131], v[98:99]
    v_pk_mul_f32 v[132:133], v[132:133], v[100:101]
    v_pk_mul_f32 v[134:135], v[134:135], v[102:103]
    v_cvt_pk_bf16_f32 v64, v128, v129
    v_cvt_pk_bf16_f32 v65, v130, v131
    v_cvt_pk_bf16_f32 v66, v132, v133
    v_cvt_pk_bf16_f32 v67, v134, v135
    buffer_store_dwordx4 v[64:67], v46, s[4:7], s25 offen offset:0 sc1
    v_pk_add_f32 v[144:145], v[144:145], v[8:9]
    v_pk_add_f32 v[146:147], v[146:147], v[10:11]
    v_pk_add_f32 v[148:149], v[148:149], v[12:13]
    v_pk_add_f32 v[150:151], v[150:151], v[14:15]
    v_pk_mul_f32 v[96:97], v[144:145], s[60:61]
    v_pk_mul_f32 v[98:99], v[146:147], s[60:61]
    v_pk_mul_f32 v[100:101], v[148:149], s[60:61]
    v_pk_mul_f32 v[102:103], v[150:151], s[60:61]
    v_min_f32 v96, s64, v96
    v_min_f32 v97, s64, v97
    v_min_f32 v98, s64, v98
    v_min_f32 v99, s64, v99
    v_min_f32 v100, s64, v100
    v_min_f32 v101, s64, v101
    v_min_f32 v102, s64, v102
    v_min_f32 v103, s64, v103
    v_exp_f32 v96, v96
    v_exp_f32 v97, v97
    v_exp_f32 v98, v98
    v_exp_f32 v99, v99
    v_exp_f32 v100, v100
    v_exp_f32 v101, v101
    v_exp_f32 v102, v102
    v_exp_f32 v103, v103
    v_pk_add_f32 v[104:105], v[96:97], s[62:63]
    v_pk_add_f32 v[106:107], v[98:99], s[62:63]
    v_pk_add_f32 v[108:109], v[100:101], s[62:63]
    v_pk_add_f32 v[110:111], v[102:103], s[62:63]
    v_pk_mul_f32 v[96:97], v[96:97], v[104:105]
    v_pk_mul_f32 v[98:99], v[98:99], v[106:107]
    v_pk_mul_f32 v[100:101], v[100:101], v[108:109]
    v_pk_mul_f32 v[102:103], v[102:103], v[110:111]
    v_pk_add_f32 v[104:105], v[96:97], s[62:63]
    v_pk_add_f32 v[106:107], v[98:99], s[62:63]
    v_pk_add_f32 v[108:109], v[100:101], s[62:63]
    v_pk_add_f32 v[110:111], v[102:103], s[62:63]
    v_rcp_f32 v104, v104
    v_rcp_f32 v105, v105
    v_rcp_f32 v106, v106
    v_rcp_f32 v107, v107
    v_rcp_f32 v108, v108
    v_rcp_f32 v109, v109
    v_rcp_f32 v110, v110
    v_rcp_f32 v111, v111
    v_pk_mul_f32 v[96:97], v[96:97], v[104:105]
    v_pk_mul_f32 v[98:99], v[98:99], v[106:107]
    v_pk_mul_f32 v[100:101], v[100:101], v[108:109]
    v_pk_mul_f32 v[102:103], v[102:103], v[110:111]
    v_pk_mul_f32 v[144:145], v[144:145], v[96:97]
    v_pk_mul_f32 v[146:147], v[146:147], v[98:99]
    v_pk_mul_f32 v[148:149], v[148:149], v[100:101]
    v_pk_mul_f32 v[150:151], v[150:151], v[102:103]
    v_cvt_pk_bf16_f32 v68, v144, v145
    v_cvt_pk_bf16_f32 v69, v146, v147
    v_cvt_pk_bf16_f32 v70, v148, v149
    v_cvt_pk_bf16_f32 v71, v150, v151
    buffer_store_dwordx4 v[68:71], v46, s[4:7], s25 offen offset:256 sc1
    v_pk_add_f32 v[136:137], v[136:137], v[16:17]
    v_pk_add_f32 v[138:139], v[138:139], v[18:19]
    v_pk_add_f32 v[140:141], v[140:141], v[20:21]
    v_pk_add_f32 v[142:143], v[142:143], v[22:23]
    v_pk_mul_f32 v[96:97], v[136:137], s[60:61]
    v_pk_mul_f32 v[98:99], v[138:139], s[60:61]
    v_pk_mul_f32 v[100:101], v[140:141], s[60:61]
    v_pk_mul_f32 v[102:103], v[142:143], s[60:61]
    v_min_f32 v96, s64, v96
    v_min_f32 v97, s64, v97
    v_min_f32 v98, s64, v98
    v_min_f32 v99, s64, v99
    v_min_f32 v100, s64, v100
    v_min_f32 v101, s64, v101
    v_min_f32 v102, s64, v102
    v_min_f32 v103, s64, v103
    v_exp_f32 v96, v96
    v_exp_f32 v97, v97
    v_exp_f32 v98, v98
    v_exp_f32 v99, v99
    v_exp_f32 v100, v100
    v_exp_f32 v101, v101
    v_exp_f32 v102, v102
    v_exp_f32 v103, v103
    v_pk_add_f32 v[104:105], v[96:97], s[62:63]
    v_pk_add_f32 v[106:107], v[98:99], s[62:63]
    v_pk_add_f32 v[108:109], v[100:101], s[62:63]
    v_pk_add_f32 v[110:111], v[102:103], s[62:63]
    v_pk_mul_f32 v[96:97], v[96:97], v[104:105]
    v_pk_mul_f32 v[98:99], v[98:99], v[106:107]
    v_pk_mul_f32 v[100:101], v[100:101], v[108:109]
    v_pk_mul_f32 v[102:103], v[102:103], v[110:111]
    v_pk_add_f32 v[104:105], v[96:97], s[62:63]
    v_pk_add_f32 v[106:107], v[98:99], s[62:63]
    v_pk_add_f32 v[108:109], v[100:101], s[62:63]
    v_pk_add_f32 v[110:111], v[102:103], s[62:63]
    v_rcp_f32 v104, v104
    v_rcp_f32 v105, v105
    v_rcp_f32 v106, v106
    v_rcp_f32 v107, v107
    v_rcp_f32 v108, v108
    v_rcp_f32 v109, v109
    v_rcp_f32 v110, v110
    v_rcp_f32 v111, v111
    v_pk_mul_f32 v[96:97], v[96:97], v[104:105]
    v_pk_mul_f32 v[98:99], v[98:99], v[106:107]
    v_pk_mul_f32 v[100:101], v[100:101], v[108:109]
    v_pk_mul_f32 v[102:103], v[102:103], v[110:111]
    v_pk_mul_f32 v[136:137], v[136:137], v[96:97]
    v_pk_mul_f32 v[138:139], v[138:139], v[98:99]
    v_pk_mul_f32 v[140:141], v[140:141], v[100:101]
    v_pk_mul_f32 v[142:143], v[142:143], v[102:103]
    v_cvt_pk_bf16_f32 v72, v136, v137
    v_cvt_pk_bf16_f32 v73, v138, v139
    v_cvt_pk_bf16_f32 v74, v140, v141
    v_cvt_pk_bf16_f32 v75, v142, v143
    buffer_store_dwordx4 v[72:75], v46, s[4:7], s25 offen offset:2048 sc1
    v_pk_add_f32 v[152:153], v[152:153], v[16:17]
    v_pk_add_f32 v[154:155], v[154:155], v[18:19]
    v_pk_add_f32 v[156:157], v[156:157], v[20:21]
    v_pk_add_f32 v[158:159], v[158:159], v[22:23]
    v_pk_mul_f32 v[96:97], v[152:153], s[60:61]
    v_pk_mul_f32 v[98:99], v[154:155], s[60:61]
    v_pk_mul_f32 v[100:101], v[156:157], s[60:61]
    v_pk_mul_f32 v[102:103], v[158:159], s[60:61]
    v_min_f32 v96, s64, v96
    v_min_f32 v97, s64, v97
    v_min_f32 v98, s64, v98
    v_min_f32 v99, s64, v99
    v_min_f32 v100, s64, v100
    v_min_f32 v101, s64, v101
    v_min_f32 v102, s64, v102
    v_min_f32 v103, s64, v103
    v_exp_f32 v96, v96
    v_exp_f32 v97, v97
    v_exp_f32 v98, v98
    v_exp_f32 v99, v99
    v_exp_f32 v100, v100
    v_exp_f32 v101, v101
    v_exp_f32 v102, v102
    v_exp_f32 v103, v103
    v_pk_add_f32 v[104:105], v[96:97], s[62:63]
    v_pk_add_f32 v[106:107], v[98:99], s[62:63]
    v_pk_add_f32 v[108:109], v[100:101], s[62:63]
    v_pk_add_f32 v[110:111], v[102:103], s[62:63]
    v_pk_mul_f32 v[96:97], v[96:97], v[104:105]
    v_pk_mul_f32 v[98:99], v[98:99], v[106:107]
    v_pk_mul_f32 v[100:101], v[100:101], v[108:109]
    v_pk_mul_f32 v[102:103], v[102:103], v[110:111]
    v_pk_add_f32 v[104:105], v[96:97], s[62:63]
    v_pk_add_f32 v[106:107], v[98:99], s[62:63]
    v_pk_add_f32 v[108:109], v[100:101], s[62:63]
    v_pk_add_f32 v[110:111], v[102:103], s[62:63]
    v_rcp_f32 v104, v104
    v_rcp_f32 v105, v105
    v_rcp_f32 v106, v106
    v_rcp_f32 v107, v107
    v_rcp_f32 v108, v108
    v_rcp_f32 v109, v109
    v_rcp_f32 v110, v110
    v_rcp_f32 v111, v111
    v_pk_mul_f32 v[96:97], v[96:97], v[104:105]
    v_pk_mul_f32 v[98:99], v[98:99], v[106:107]
    v_pk_mul_f32 v[100:101], v[100:101], v[108:109]
    v_pk_mul_f32 v[102:103], v[102:103], v[110:111]
    v_pk_mul_f32 v[152:153], v[152:153], v[96:97]
    v_pk_mul_f32 v[154:155], v[154:155], v[98:99]
    v_pk_mul_f32 v[156:157], v[156:157], v[100:101]
    v_pk_mul_f32 v[158:159], v[158:159], v[102:103]
    v_cvt_pk_bf16_f32 v76, v152, v153
    v_cvt_pk_bf16_f32 v77, v154, v155
    v_cvt_pk_bf16_f32 v78, v156, v157
    v_cvt_pk_bf16_f32 v79, v158, v159
    buffer_store_dwordx4 v[76:79], v46, s[4:7], s25 offen offset:2304 sc1
    s_add_u32 s25, s37, 491520
    v_pk_add_f32 v[160:161], v[160:161], v[8:9]
    v_pk_add_f32 v[162:163], v[162:163], v[10:11]
    v_pk_add_f32 v[164:165], v[164:165], v[12:13]
    v_pk_add_f32 v[166:167], v[166:167], v[14:15]
    v_pk_mul_f32 v[96:97], v[160:161], s[60:61]
    v_pk_mul_f32 v[98:99], v[162:163], s[60:61]
    v_pk_mul_f32 v[100:101], v[164:165], s[60:61]
    v_pk_mul_f32 v[102:103], v[166:167], s[60:61]
    v_min_f32 v96, s64, v96
    v_min_f32 v97, s64, v97
    v_min_f32 v98, s64, v98
    v_min_f32 v99, s64, v99
    v_min_f32 v100, s64, v100
    v_min_f32 v101, s64, v101
    v_min_f32 v102, s64, v102
    v_min_f32 v103, s64, v103
    v_exp_f32 v96, v96
    v_exp_f32 v97, v97
    v_exp_f32 v98, v98
    v_exp_f32 v99, v99
    v_exp_f32 v100, v100
    v_exp_f32 v101, v101
    v_exp_f32 v102, v102
    v_exp_f32 v103, v103
    v_pk_add_f32 v[104:105], v[96:97], s[62:63]
    v_pk_add_f32 v[106:107], v[98:99], s[62:63]
    v_pk_add_f32 v[108:109], v[100:101], s[62:63]
    v_pk_add_f32 v[110:111], v[102:103], s[62:63]
    v_pk_mul_f32 v[96:97], v[96:97], v[104:105]
    v_pk_mul_f32 v[98:99], v[98:99], v[106:107]
    v_pk_mul_f32 v[100:101], v[100:101], v[108:109]
    v_pk_mul_f32 v[102:103], v[102:103], v[110:111]
    v_pk_add_f32 v[104:105], v[96:97], s[62:63]
    v_pk_add_f32 v[106:107], v[98:99], s[62:63]
    v_pk_add_f32 v[108:109], v[100:101], s[62:63]
    v_pk_add_f32 v[110:111], v[102:103], s[62:63]
    v_rcp_f32 v104, v104
    v_rcp_f32 v105, v105
    v_rcp_f32 v106, v106
    v_rcp_f32 v107, v107
    v_rcp_f32 v108, v108
    v_rcp_f32 v109, v109
    v_rcp_f32 v110, v110
    v_rcp_f32 v111, v111
    v_pk_mul_f32 v[96:97], v[96:97], v[104:105]
    v_pk_mul_f32 v[98:99], v[98:99], v[106:107]
    v_pk_mul_f32 v[100:101], v[100:101], v[108:109]
    v_pk_mul_f32 v[102:103], v[102:103], v[110:111]
    v_pk_mul_f32 v[160:161], v[160:161], v[96:97]
    v_pk_mul_f32 v[162:163], v[162:163], v[98:99]
    v_pk_mul_f32 v[164:165], v[164:165], v[100:101]
    v_pk_mul_f32 v[166:167], v[166:167], v[102:103]
    v_cvt_pk_bf16_f32 v80, v160, v161
    v_cvt_pk_bf16_f32 v81, v162, v163
    v_cvt_pk_bf16_f32 v82, v164, v165
    v_cvt_pk_bf16_f32 v83, v166, v167
    buffer_store_dwordx4 v[80:83], v46, s[4:7], s25 offen offset:0 sc1
    v_pk_add_f32 v[176:177], v[176:177], v[8:9]
    v_pk_add_f32 v[178:179], v[178:179], v[10:11]
    v_pk_add_f32 v[180:181], v[180:181], v[12:13]
    v_pk_add_f32 v[182:183], v[182:183], v[14:15]
    v_pk_mul_f32 v[96:97], v[176:177], s[60:61]
    v_pk_mul_f32 v[98:99], v[178:179], s[60:61]
    v_pk_mul_f32 v[100:101], v[180:181], s[60:61]
    v_pk_mul_f32 v[102:103], v[182:183], s[60:61]
    v_min_f32 v96, s64, v96
    v_min_f32 v97, s64, v97
    v_min_f32 v98, s64, v98
    v_min_f32 v99, s64, v99
    v_min_f32 v100, s64, v100
    v_min_f32 v101, s64, v101
    v_min_f32 v102, s64, v102
    v_min_f32 v103, s64, v103
    v_exp_f32 v96, v96
    v_exp_f32 v97, v97
    v_exp_f32 v98, v98
    v_exp_f32 v99, v99
    v_exp_f32 v100, v100
    v_exp_f32 v101, v101
    v_exp_f32 v102, v102
    v_exp_f32 v103, v103
    v_pk_add_f32 v[104:105], v[96:97], s[62:63]
    v_pk_add_f32 v[106:107], v[98:99], s[62:63]
    v_pk_add_f32 v[108:109], v[100:101], s[62:63]
    v_pk_add_f32 v[110:111], v[102:103], s[62:63]
    v_pk_mul_f32 v[96:97], v[96:97], v[104:105]
    v_pk_mul_f32 v[98:99], v[98:99], v[106:107]
    v_pk_mul_f32 v[100:101], v[100:101], v[108:109]
    v_pk_mul_f32 v[102:103], v[102:103], v[110:111]
    v_pk_add_f32 v[104:105], v[96:97], s[62:63]
    v_pk_add_f32 v[106:107], v[98:99], s[62:63]
    v_pk_add_f32 v[108:109], v[100:101], s[62:63]
    v_pk_add_f32 v[110:111], v[102:103], s[62:63]
    v_rcp_f32 v104, v104
    v_rcp_f32 v105, v105
    v_rcp_f32 v106, v106
    v_rcp_f32 v107, v107
    v_rcp_f32 v108, v108
    v_rcp_f32 v109, v109
    v_rcp_f32 v110, v110
    v_rcp_f32 v111, v111
    v_pk_mul_f32 v[96:97], v[96:97], v[104:105]
    v_pk_mul_f32 v[98:99], v[98:99], v[106:107]
    v_pk_mul_f32 v[100:101], v[100:101], v[108:109]
    v_pk_mul_f32 v[102:103], v[102:103], v[110:111]
    v_pk_mul_f32 v[176:177], v[176:177], v[96:97]
    v_pk_mul_f32 v[178:179], v[178:179], v[98:99]
    v_pk_mul_f32 v[180:181], v[180:181], v[100:101]
    v_pk_mul_f32 v[182:183], v[182:183], v[102:103]
    v_cvt_pk_bf16_f32 v84, v176, v177
    v_cvt_pk_bf16_f32 v85, v178, v179
    v_cvt_pk_bf16_f32 v86, v180, v181
    v_cvt_pk_bf16_f32 v87, v182, v183
    buffer_store_dwordx4 v[84:87], v46, s[4:7], s25 offen offset:256 sc1
    v_pk_add_f32 v[168:169], v[168:169], v[16:17]
    v_pk_add_f32 v[170:171], v[170:171], v[18:19]
    v_pk_add_f32 v[172:173], v[172:173], v[20:21]
    v_pk_add_f32 v[174:175], v[174:175], v[22:23]
    v_pk_mul_f32 v[96:97], v[168:169], s[60:61]
    v_pk_mul_f32 v[98:99], v[170:171], s[60:61]
    v_pk_mul_f32 v[100:101], v[172:173], s[60:61]
    v_pk_mul_f32 v[102:103], v[174:175], s[60:61]
    v_min_f32 v96, s64, v96
    v_min_f32 v97, s64, v97
    v_min_f32 v98, s64, v98
    v_min_f32 v99, s64, v99
    v_min_f32 v100, s64, v100
    v_min_f32 v101, s64, v101
    v_min_f32 v102, s64, v102
    v_min_f32 v103, s64, v103
    v_exp_f32 v96, v96
    v_exp_f32 v97, v97
    v_exp_f32 v98, v98
    v_exp_f32 v99, v99
    v_exp_f32 v100, v100
    v_exp_f32 v101, v101
    v_exp_f32 v102, v102
    v_exp_f32 v103, v103
    v_pk_add_f32 v[104:105], v[96:97], s[62:63]
    v_pk_add_f32 v[106:107], v[98:99], s[62:63]
    v_pk_add_f32 v[108:109], v[100:101], s[62:63]
    v_pk_add_f32 v[110:111], v[102:103], s[62:63]
    v_pk_mul_f32 v[96:97], v[96:97], v[104:105]
    v_pk_mul_f32 v[98:99], v[98:99], v[106:107]
    v_pk_mul_f32 v[100:101], v[100:101], v[108:109]
    v_pk_mul_f32 v[102:103], v[102:103], v[110:111]
    v_pk_add_f32 v[104:105], v[96:97], s[62:63]
    v_pk_add_f32 v[106:107], v[98:99], s[62:63]
    v_pk_add_f32 v[108:109], v[100:101], s[62:63]
    v_pk_add_f32 v[110:111], v[102:103], s[62:63]
    v_rcp_f32 v104, v104
    v_rcp_f32 v105, v105
    v_rcp_f32 v106, v106
    v_rcp_f32 v107, v107
    v_rcp_f32 v108, v108
    v_rcp_f32 v109, v109
    v_rcp_f32 v110, v110
    v_rcp_f32 v111, v111
    v_pk_mul_f32 v[96:97], v[96:97], v[104:105]
    v_pk_mul_f32 v[98:99], v[98:99], v[106:107]
    v_pk_mul_f32 v[100:101], v[100:101], v[108:109]
    v_pk_mul_f32 v[102:103], v[102:103], v[110:111]
    v_pk_mul_f32 v[168:169], v[168:169], v[96:97]
    v_pk_mul_f32 v[170:171], v[170:171], v[98:99]
    v_pk_mul_f32 v[172:173], v[172:173], v[100:101]
    v_pk_mul_f32 v[174:175], v[174:175], v[102:103]
    v_cvt_pk_bf16_f32 v88, v168, v169
    v_cvt_pk_bf16_f32 v89, v170, v171
    v_cvt_pk_bf16_f32 v90, v172, v173
    v_cvt_pk_bf16_f32 v91, v174, v175
    buffer_store_dwordx4 v[88:91], v46, s[4:7], s25 offen offset:2048 sc1
    v_pk_add_f32 v[184:185], v[184:185], v[16:17]
    v_pk_add_f32 v[186:187], v[186:187], v[18:19]
    v_pk_add_f32 v[188:189], v[188:189], v[20:21]
    v_pk_add_f32 v[190:191], v[190:191], v[22:23]
    v_pk_mul_f32 v[96:97], v[184:185], s[60:61]
    v_pk_mul_f32 v[98:99], v[186:187], s[60:61]
    v_pk_mul_f32 v[100:101], v[188:189], s[60:61]
    v_pk_mul_f32 v[102:103], v[190:191], s[60:61]
    v_min_f32 v96, s64, v96
    v_min_f32 v97, s64, v97
    v_min_f32 v98, s64, v98
    v_min_f32 v99, s64, v99
    v_min_f32 v100, s64, v100
    v_min_f32 v101, s64, v101
    v_min_f32 v102, s64, v102
    v_min_f32 v103, s64, v103
    v_exp_f32 v96, v96
    v_exp_f32 v97, v97
    v_exp_f32 v98, v98
    v_exp_f32 v99, v99
    v_exp_f32 v100, v100
    v_exp_f32 v101, v101
    v_exp_f32 v102, v102
    v_exp_f32 v103, v103
    v_pk_add_f32 v[104:105], v[96:97], s[62:63]
    v_pk_add_f32 v[106:107], v[98:99], s[62:63]
    v_pk_add_f32 v[108:109], v[100:101], s[62:63]
    v_pk_add_f32 v[110:111], v[102:103], s[62:63]
    v_pk_mul_f32 v[96:97], v[96:97], v[104:105]
    v_pk_mul_f32 v[98:99], v[98:99], v[106:107]
    v_pk_mul_f32 v[100:101], v[100:101], v[108:109]
    v_pk_mul_f32 v[102:103], v[102:103], v[110:111]
    v_pk_add_f32 v[104:105], v[96:97], s[62:63]
    v_pk_add_f32 v[106:107], v[98:99], s[62:63]
    v_pk_add_f32 v[108:109], v[100:101], s[62:63]
    v_pk_add_f32 v[110:111], v[102:103], s[62:63]
    v_rcp_f32 v104, v104
    v_rcp_f32 v105, v105
    v_rcp_f32 v106, v106
    v_rcp_f32 v107, v107
    v_rcp_f32 v108, v108
    v_rcp_f32 v109, v109
    v_rcp_f32 v110, v110
    v_rcp_f32 v111, v111
    v_pk_mul_f32 v[96:97], v[96:97], v[104:105]
    v_pk_mul_f32 v[98:99], v[98:99], v[106:107]
    v_pk_mul_f32 v[100:101], v[100:101], v[108:109]
    v_pk_mul_f32 v[102:103], v[102:103], v[110:111]
    v_pk_mul_f32 v[184:185], v[184:185], v[96:97]
    v_pk_mul_f32 v[186:187], v[186:187], v[98:99]
    v_pk_mul_f32 v[188:189], v[188:189], v[100:101]
    v_pk_mul_f32 v[190:191], v[190:191], v[102:103]
    v_cvt_pk_bf16_f32 v92, v184, v185
    v_cvt_pk_bf16_f32 v93, v186, v187
    v_cvt_pk_bf16_f32 v94, v188, v189
    v_cvt_pk_bf16_f32 v95, v190, v191
    buffer_store_dwordx4 v[92:95], v46, s[4:7], s25 offen offset:2304 sc1
    s_add_u32 s25, s37, 983040
    v_pk_add_f32 v[192:193], v[192:193], v[8:9]
    v_pk_add_f32 v[194:195], v[194:195], v[10:11]
    v_pk_add_f32 v[196:197], v[196:197], v[12:13]
    v_pk_add_f32 v[198:199], v[198:199], v[14:15]
    v_pk_mul_f32 v[96:97], v[192:193], s[60:61]
    v_pk_mul_f32 v[98:99], v[194:195], s[60:61]
    v_pk_mul_f32 v[100:101], v[196:197], s[60:61]
    v_pk_mul_f32 v[102:103], v[198:199], s[60:61]
    v_min_f32 v96, s64, v96
    v_min_f32 v97, s64, v97
    v_min_f32 v98, s64, v98
    v_min_f32 v99, s64, v99
    v_min_f32 v100, s64, v100
    v_min_f32 v101, s64, v101
    v_min_f32 v102, s64, v102
    v_min_f32 v103, s64, v103
    v_exp_f32 v96, v96
    v_exp_f32 v97, v97
    v_exp_f32 v98, v98
    v_exp_f32 v99, v99
    v_exp_f32 v100, v100
    v_exp_f32 v101, v101
    v_exp_f32 v102, v102
    v_exp_f32 v103, v103
    v_pk_add_f32 v[104:105], v[96:97], s[62:63]
    v_pk_add_f32 v[106:107], v[98:99], s[62:63]
    v_pk_add_f32 v[108:109], v[100:101], s[62:63]
    v_pk_add_f32 v[110:111], v[102:103], s[62:63]
    v_pk_mul_f32 v[96:97], v[96:97], v[104:105]
    v_pk_mul_f32 v[98:99], v[98:99], v[106:107]
    v_pk_mul_f32 v[100:101], v[100:101], v[108:109]
    v_pk_mul_f32 v[102:103], v[102:103], v[110:111]
    v_pk_add_f32 v[104:105], v[96:97], s[62:63]
    v_pk_add_f32 v[106:107], v[98:99], s[62:63]
    v_pk_add_f32 v[108:109], v[100:101], s[62:63]
    v_pk_add_f32 v[110:111], v[102:103], s[62:63]
    v_rcp_f32 v104, v104
    v_rcp_f32 v105, v105
    v_rcp_f32 v106, v106
    v_rcp_f32 v107, v107
    v_rcp_f32 v108, v108
    v_rcp_f32 v109, v109
    v_rcp_f32 v110, v110
    v_rcp_f32 v111, v111
    v_pk_mul_f32 v[96:97], v[96:97], v[104:105]
    v_pk_mul_f32 v[98:99], v[98:99], v[106:107]
    v_pk_mul_f32 v[100:101], v[100:101], v[108:109]
    v_pk_mul_f32 v[102:103], v[102:103], v[110:111]
    v_pk_mul_f32 v[192:193], v[192:193], v[96:97]
    v_pk_mul_f32 v[194:195], v[194:195], v[98:99]
    v_pk_mul_f32 v[196:197], v[196:197], v[100:101]
    v_pk_mul_f32 v[198:199], v[198:199], v[102:103]
    v_cvt_pk_bf16_f32 v64, v192, v193
    v_cvt_pk_bf16_f32 v65, v194, v195
    v_cvt_pk_bf16_f32 v66, v196, v197
    v_cvt_pk_bf16_f32 v67, v198, v199
    buffer_store_dwordx4 v[64:67], v46, s[4:7], s25 offen offset:0 sc1
    v_pk_add_f32 v[208:209], v[208:209], v[8:9]
    v_pk_add_f32 v[210:211], v[210:211], v[10:11]
    v_pk_add_f32 v[212:213], v[212:213], v[12:13]
    v_pk_add_f32 v[214:215], v[214:215], v[14:15]
    v_pk_mul_f32 v[96:97], v[208:209], s[60:61]
    v_pk_mul_f32 v[98:99], v[210:211], s[60:61]
    v_pk_mul_f32 v[100:101], v[212:213], s[60:61]
    v_pk_mul_f32 v[102:103], v[214:215], s[60:61]
    v_min_f32 v96, s64, v96
    v_min_f32 v97, s64, v97
    v_min_f32 v98, s64, v98
    v_min_f32 v99, s64, v99
    v_min_f32 v100, s64, v100
    v_min_f32 v101, s64, v101
    v_min_f32 v102, s64, v102
    v_min_f32 v103, s64, v103
    v_exp_f32 v96, v96
    v_exp_f32 v97, v97
    v_exp_f32 v98, v98
    v_exp_f32 v99, v99
    v_exp_f32 v100, v100
    v_exp_f32 v101, v101
    v_exp_f32 v102, v102
    v_exp_f32 v103, v103
    v_pk_add_f32 v[104:105], v[96:97], s[62:63]
    v_pk_add_f32 v[106:107], v[98:99], s[62:63]
    v_pk_add_f32 v[108:109], v[100:101], s[62:63]
    v_pk_add_f32 v[110:111], v[102:103], s[62:63]
    v_pk_mul_f32 v[96:97], v[96:97], v[104:105]
    v_pk_mul_f32 v[98:99], v[98:99], v[106:107]
    v_pk_mul_f32 v[100:101], v[100:101], v[108:109]
    v_pk_mul_f32 v[102:103], v[102:103], v[110:111]
    v_pk_add_f32 v[104:105], v[96:97], s[62:63]
    v_pk_add_f32 v[106:107], v[98:99], s[62:63]
    v_pk_add_f32 v[108:109], v[100:101], s[62:63]
    v_pk_add_f32 v[110:111], v[102:103], s[62:63]
    v_rcp_f32 v104, v104
    v_rcp_f32 v105, v105
    v_rcp_f32 v106, v106
    v_rcp_f32 v107, v107
    v_rcp_f32 v108, v108
    v_rcp_f32 v109, v109
    v_rcp_f32 v110, v110
    v_rcp_f32 v111, v111
    v_pk_mul_f32 v[96:97], v[96:97], v[104:105]
    v_pk_mul_f32 v[98:99], v[98:99], v[106:107]
    v_pk_mul_f32 v[100:101], v[100:101], v[108:109]
    v_pk_mul_f32 v[102:103], v[102:103], v[110:111]
    v_pk_mul_f32 v[208:209], v[208:209], v[96:97]
    v_pk_mul_f32 v[210:211], v[210:211], v[98:99]
    v_pk_mul_f32 v[212:213], v[212:213], v[100:101]
    v_pk_mul_f32 v[214:215], v[214:215], v[102:103]
    v_cvt_pk_bf16_f32 v68, v208, v209
    v_cvt_pk_bf16_f32 v69, v210, v211
    v_cvt_pk_bf16_f32 v70, v212, v213
    v_cvt_pk_bf16_f32 v71, v214, v215
    buffer_store_dwordx4 v[68:71], v46, s[4:7], s25 offen offset:256 sc1
    v_pk_add_f32 v[200:201], v[200:201], v[16:17]
    v_pk_add_f32 v[202:203], v[202:203], v[18:19]
    v_pk_add_f32 v[204:205], v[204:205], v[20:21]
    v_pk_add_f32 v[206:207], v[206:207], v[22:23]
    v_pk_mul_f32 v[96:97], v[200:201], s[60:61]
    v_pk_mul_f32 v[98:99], v[202:203], s[60:61]
    v_pk_mul_f32 v[100:101], v[204:205], s[60:61]
    v_pk_mul_f32 v[102:103], v[206:207], s[60:61]
    v_min_f32 v96, s64, v96
    v_min_f32 v97, s64, v97
    v_min_f32 v98, s64, v98
    v_min_f32 v99, s64, v99
    v_min_f32 v100, s64, v100
    v_min_f32 v101, s64, v101
    v_min_f32 v102, s64, v102
    v_min_f32 v103, s64, v103
    v_exp_f32 v96, v96
    v_exp_f32 v97, v97
    v_exp_f32 v98, v98
    v_exp_f32 v99, v99
    v_exp_f32 v100, v100
    v_exp_f32 v101, v101
    v_exp_f32 v102, v102
    v_exp_f32 v103, v103
    v_pk_add_f32 v[104:105], v[96:97], s[62:63]
    v_pk_add_f32 v[106:107], v[98:99], s[62:63]
    v_pk_add_f32 v[108:109], v[100:101], s[62:63]
    v_pk_add_f32 v[110:111], v[102:103], s[62:63]
    v_pk_mul_f32 v[96:97], v[96:97], v[104:105]
    v_pk_mul_f32 v[98:99], v[98:99], v[106:107]
    v_pk_mul_f32 v[100:101], v[100:101], v[108:109]
    v_pk_mul_f32 v[102:103], v[102:103], v[110:111]
    v_pk_add_f32 v[104:105], v[96:97], s[62:63]
    v_pk_add_f32 v[106:107], v[98:99], s[62:63]
    v_pk_add_f32 v[108:109], v[100:101], s[62:63]
    v_pk_add_f32 v[110:111], v[102:103], s[62:63]
    v_rcp_f32 v104, v104
    v_rcp_f32 v105, v105
    v_rcp_f32 v106, v106
    v_rcp_f32 v107, v107
    v_rcp_f32 v108, v108
    v_rcp_f32 v109, v109
    v_rcp_f32 v110, v110
    v_rcp_f32 v111, v111
    v_pk_mul_f32 v[96:97], v[96:97], v[104:105]
    v_pk_mul_f32 v[98:99], v[98:99], v[106:107]
    v_pk_mul_f32 v[100:101], v[100:101], v[108:109]
    v_pk_mul_f32 v[102:103], v[102:103], v[110:111]
    v_pk_mul_f32 v[200:201], v[200:201], v[96:97]
    v_pk_mul_f32 v[202:203], v[202:203], v[98:99]
    v_pk_mul_f32 v[204:205], v[204:205], v[100:101]
    v_pk_mul_f32 v[206:207], v[206:207], v[102:103]
    v_cvt_pk_bf16_f32 v72, v200, v201
    v_cvt_pk_bf16_f32 v73, v202, v203
    v_cvt_pk_bf16_f32 v74, v204, v205
    v_cvt_pk_bf16_f32 v75, v206, v207
    buffer_store_dwordx4 v[72:75], v46, s[4:7], s25 offen offset:2048 sc1
    v_pk_add_f32 v[216:217], v[216:217], v[16:17]
    v_pk_add_f32 v[218:219], v[218:219], v[18:19]
    v_pk_add_f32 v[220:221], v[220:221], v[20:21]
    v_pk_add_f32 v[222:223], v[222:223], v[22:23]
    v_pk_mul_f32 v[96:97], v[216:217], s[60:61]
    v_pk_mul_f32 v[98:99], v[218:219], s[60:61]
    v_pk_mul_f32 v[100:101], v[220:221], s[60:61]
    v_pk_mul_f32 v[102:103], v[222:223], s[60:61]
    v_min_f32 v96, s64, v96
    v_min_f32 v97, s64, v97
    v_min_f32 v98, s64, v98
    v_min_f32 v99, s64, v99
    v_min_f32 v100, s64, v100
    v_min_f32 v101, s64, v101
    v_min_f32 v102, s64, v102
    v_min_f32 v103, s64, v103
    v_exp_f32 v96, v96
    v_exp_f32 v97, v97
    v_exp_f32 v98, v98
    v_exp_f32 v99, v99
    v_exp_f32 v100, v100
    v_exp_f32 v101, v101
    v_exp_f32 v102, v102
    v_exp_f32 v103, v103
    v_pk_add_f32 v[104:105], v[96:97], s[62:63]
    v_pk_add_f32 v[106:107], v[98:99], s[62:63]
    v_pk_add_f32 v[108:109], v[100:101], s[62:63]
    v_pk_add_f32 v[110:111], v[102:103], s[62:63]
    v_pk_mul_f32 v[96:97], v[96:97], v[104:105]
    v_pk_mul_f32 v[98:99], v[98:99], v[106:107]
    v_pk_mul_f32 v[100:101], v[100:101], v[108:109]
    v_pk_mul_f32 v[102:103], v[102:103], v[110:111]
    v_pk_add_f32 v[104:105], v[96:97], s[62:63]
    v_pk_add_f32 v[106:107], v[98:99], s[62:63]
    v_pk_add_f32 v[108:109], v[100:101], s[62:63]
    v_pk_add_f32 v[110:111], v[102:103], s[62:63]
    v_rcp_f32 v104, v104
    v_rcp_f32 v105, v105
    v_rcp_f32 v106, v106
    v_rcp_f32 v107, v107
    v_rcp_f32 v108, v108
    v_rcp_f32 v109, v109
    v_rcp_f32 v110, v110
    v_rcp_f32 v111, v111
    v_pk_mul_f32 v[96:97], v[96:97], v[104:105]
    v_pk_mul_f32 v[98:99], v[98:99], v[106:107]
    v_pk_mul_f32 v[100:101], v[100:101], v[108:109]
    v_pk_mul_f32 v[102:103], v[102:103], v[110:111]
    v_pk_mul_f32 v[216:217], v[216:217], v[96:97]
    v_pk_mul_f32 v[218:219], v[218:219], v[98:99]
    v_pk_mul_f32 v[220:221], v[220:221], v[100:101]
    v_pk_mul_f32 v[222:223], v[222:223], v[102:103]
    v_cvt_pk_bf16_f32 v76, v216, v217
    v_cvt_pk_bf16_f32 v77, v218, v219
    v_cvt_pk_bf16_f32 v78, v220, v221
    v_cvt_pk_bf16_f32 v79, v222, v223
    buffer_store_dwordx4 v[76:79], v46, s[4:7], s25 offen offset:2304 sc1
    s_add_u32 s25, s37, 1474560
    v_pk_add_f32 v[224:225], v[224:225], v[8:9]
    v_pk_add_f32 v[226:227], v[226:227], v[10:11]
    v_pk_add_f32 v[228:229], v[228:229], v[12:13]
    v_pk_add_f32 v[230:231], v[230:231], v[14:15]
    v_pk_mul_f32 v[96:97], v[224:225], s[60:61]
    v_pk_mul_f32 v[98:99], v[226:227], s[60:61]
    v_pk_mul_f32 v[100:101], v[228:229], s[60:61]
    v_pk_mul_f32 v[102:103], v[230:231], s[60:61]
    v_min_f32 v96, s64, v96
    v_min_f32 v97, s64, v97
    v_min_f32 v98, s64, v98
    v_min_f32 v99, s64, v99
    v_min_f32 v100, s64, v100
    v_min_f32 v101, s64, v101
    v_min_f32 v102, s64, v102
    v_min_f32 v103, s64, v103
    v_exp_f32 v96, v96
    v_exp_f32 v97, v97
    v_exp_f32 v98, v98
    v_exp_f32 v99, v99
    v_exp_f32 v100, v100
    v_exp_f32 v101, v101
    v_exp_f32 v102, v102
    v_exp_f32 v103, v103
    v_pk_add_f32 v[104:105], v[96:97], s[62:63]
    v_pk_add_f32 v[106:107], v[98:99], s[62:63]
    v_pk_add_f32 v[108:109], v[100:101], s[62:63]
    v_pk_add_f32 v[110:111], v[102:103], s[62:63]
    v_pk_mul_f32 v[96:97], v[96:97], v[104:105]
    v_pk_mul_f32 v[98:99], v[98:99], v[106:107]
    v_pk_mul_f32 v[100:101], v[100:101], v[108:109]
    v_pk_mul_f32 v[102:103], v[102:103], v[110:111]
    v_pk_add_f32 v[104:105], v[96:97], s[62:63]
    v_pk_add_f32 v[106:107], v[98:99], s[62:63]
    v_pk_add_f32 v[108:109], v[100:101], s[62:63]
    v_pk_add_f32 v[110:111], v[102:103], s[62:63]
    v_rcp_f32 v104, v104
    v_rcp_f32 v105, v105
    v_rcp_f32 v106, v106
    v_rcp_f32 v107, v107
    v_rcp_f32 v108, v108
    v_rcp_f32 v109, v109
    v_rcp_f32 v110, v110
    v_rcp_f32 v111, v111
    v_pk_mul_f32 v[96:97], v[96:97], v[104:105]
    v_pk_mul_f32 v[98:99], v[98:99], v[106:107]
    v_pk_mul_f32 v[100:101], v[100:101], v[108:109]
    v_pk_mul_f32 v[102:103], v[102:103], v[110:111]
    v_pk_mul_f32 v[224:225], v[224:225], v[96:97]
    v_pk_mul_f32 v[226:227], v[226:227], v[98:99]
    v_pk_mul_f32 v[228:229], v[228:229], v[100:101]
    v_pk_mul_f32 v[230:231], v[230:231], v[102:103]
    v_cvt_pk_bf16_f32 v80, v224, v225
    v_cvt_pk_bf16_f32 v81, v226, v227
    v_cvt_pk_bf16_f32 v82, v228, v229
    v_cvt_pk_bf16_f32 v83, v230, v231
    buffer_store_dwordx4 v[80:83], v46, s[4:7], s25 offen offset:0 sc1
    v_pk_add_f32 v[240:241], v[240:241], v[8:9]
    v_pk_add_f32 v[242:243], v[242:243], v[10:11]
    v_pk_add_f32 v[244:245], v[244:245], v[12:13]
    v_pk_add_f32 v[246:247], v[246:247], v[14:15]
    v_pk_mul_f32 v[96:97], v[240:241], s[60:61]
    v_pk_mul_f32 v[98:99], v[242:243], s[60:61]
    v_pk_mul_f32 v[100:101], v[244:245], s[60:61]
    v_pk_mul_f32 v[102:103], v[246:247], s[60:61]
    v_min_f32 v96, s64, v96
    v_min_f32 v97, s64, v97
    v_min_f32 v98, s64, v98
    v_min_f32 v99, s64, v99
    v_min_f32 v100, s64, v100
    v_min_f32 v101, s64, v101
    v_min_f32 v102, s64, v102
    v_min_f32 v103, s64, v103
    v_exp_f32 v96, v96
    v_exp_f32 v97, v97
    v_exp_f32 v98, v98
    v_exp_f32 v99, v99
    v_exp_f32 v100, v100
    v_exp_f32 v101, v101
    v_exp_f32 v102, v102
    v_exp_f32 v103, v103
    v_pk_add_f32 v[104:105], v[96:97], s[62:63]
    v_pk_add_f32 v[106:107], v[98:99], s[62:63]
    v_pk_add_f32 v[108:109], v[100:101], s[62:63]
    v_pk_add_f32 v[110:111], v[102:103], s[62:63]
    v_pk_mul_f32 v[96:97], v[96:97], v[104:105]
    v_pk_mul_f32 v[98:99], v[98:99], v[106:107]
    v_pk_mul_f32 v[100:101], v[100:101], v[108:109]
    v_pk_mul_f32 v[102:103], v[102:103], v[110:111]
    v_pk_add_f32 v[104:105], v[96:97], s[62:63]
    v_pk_add_f32 v[106:107], v[98:99], s[62:63]
    v_pk_add_f32 v[108:109], v[100:101], s[62:63]
    v_pk_add_f32 v[110:111], v[102:103], s[62:63]
    v_rcp_f32 v104, v104
    v_rcp_f32 v105, v105
    v_rcp_f32 v106, v106
    v_rcp_f32 v107, v107
    v_rcp_f32 v108, v108
    v_rcp_f32 v109, v109
    v_rcp_f32 v110, v110
    v_rcp_f32 v111, v111
    v_pk_mul_f32 v[96:97], v[96:97], v[104:105]
    v_pk_mul_f32 v[98:99], v[98:99], v[106:107]
    v_pk_mul_f32 v[100:101], v[100:101], v[108:109]
    v_pk_mul_f32 v[102:103], v[102:103], v[110:111]
    v_pk_mul_f32 v[240:241], v[240:241], v[96:97]
    v_pk_mul_f32 v[242:243], v[242:243], v[98:99]
    v_pk_mul_f32 v[244:245], v[244:245], v[100:101]
    v_pk_mul_f32 v[246:247], v[246:247], v[102:103]
    v_cvt_pk_bf16_f32 v84, v240, v241
    v_cvt_pk_bf16_f32 v85, v242, v243
    v_cvt_pk_bf16_f32 v86, v244, v245
    v_cvt_pk_bf16_f32 v87, v246, v247
    buffer_store_dwordx4 v[84:87], v46, s[4:7], s25 offen offset:256 sc1
    v_pk_add_f32 v[232:233], v[232:233], v[16:17]
    v_pk_add_f32 v[234:235], v[234:235], v[18:19]
    v_pk_add_f32 v[236:237], v[236:237], v[20:21]
    v_pk_add_f32 v[238:239], v[238:239], v[22:23]
    v_pk_mul_f32 v[96:97], v[232:233], s[60:61]
    v_pk_mul_f32 v[98:99], v[234:235], s[60:61]
    v_pk_mul_f32 v[100:101], v[236:237], s[60:61]
    v_pk_mul_f32 v[102:103], v[238:239], s[60:61]
    v_min_f32 v96, s64, v96
    v_min_f32 v97, s64, v97
    v_min_f32 v98, s64, v98
    v_min_f32 v99, s64, v99
    v_min_f32 v100, s64, v100
    v_min_f32 v101, s64, v101
    v_min_f32 v102, s64, v102
    v_min_f32 v103, s64, v103
    v_exp_f32 v96, v96
    v_exp_f32 v97, v97
    v_exp_f32 v98, v98
    v_exp_f32 v99, v99
    v_exp_f32 v100, v100
    v_exp_f32 v101, v101
    v_exp_f32 v102, v102
    v_exp_f32 v103, v103
    v_pk_add_f32 v[104:105], v[96:97], s[62:63]
    v_pk_add_f32 v[106:107], v[98:99], s[62:63]
    v_pk_add_f32 v[108:109], v[100:101], s[62:63]
    v_pk_add_f32 v[110:111], v[102:103], s[62:63]
    v_pk_mul_f32 v[96:97], v[96:97], v[104:105]
    v_pk_mul_f32 v[98:99], v[98:99], v[106:107]
    v_pk_mul_f32 v[100:101], v[100:101], v[108:109]
    v_pk_mul_f32 v[102:103], v[102:103], v[110:111]
    v_pk_add_f32 v[104:105], v[96:97], s[62:63]
    v_pk_add_f32 v[106:107], v[98:99], s[62:63]
    v_pk_add_f32 v[108:109], v[100:101], s[62:63]
    v_pk_add_f32 v[110:111], v[102:103], s[62:63]
    v_rcp_f32 v104, v104
    v_rcp_f32 v105, v105
    v_rcp_f32 v106, v106
    v_rcp_f32 v107, v107
    v_rcp_f32 v108, v108
    v_rcp_f32 v109, v109
    v_rcp_f32 v110, v110
    v_rcp_f32 v111, v111
    v_pk_mul_f32 v[96:97], v[96:97], v[104:105]
    v_pk_mul_f32 v[98:99], v[98:99], v[106:107]
    v_pk_mul_f32 v[100:101], v[100:101], v[108:109]
    v_pk_mul_f32 v[102:103], v[102:103], v[110:111]
    v_pk_mul_f32 v[232:233], v[232:233], v[96:97]
    v_pk_mul_f32 v[234:235], v[234:235], v[98:99]
    v_pk_mul_f32 v[236:237], v[236:237], v[100:101]
    v_pk_mul_f32 v[238:239], v[238:239], v[102:103]
    v_cvt_pk_bf16_f32 v88, v232, v233
    v_cvt_pk_bf16_f32 v89, v234, v235
    v_cvt_pk_bf16_f32 v90, v236, v237
    v_cvt_pk_bf16_f32 v91, v238, v239
    buffer_store_dwordx4 v[88:91], v46, s[4:7], s25 offen offset:2048 sc1
    v_pk_add_f32 v[248:249], v[248:249], v[16:17]
    v_pk_add_f32 v[250:251], v[250:251], v[18:19]
    v_pk_add_f32 v[252:253], v[252:253], v[20:21]
    v_pk_add_f32 v[254:255], v[254:255], v[22:23]
    v_pk_mul_f32 v[96:97], v[248:249], s[60:61]
    v_pk_mul_f32 v[98:99], v[250:251], s[60:61]
    v_pk_mul_f32 v[100:101], v[252:253], s[60:61]
    v_pk_mul_f32 v[102:103], v[254:255], s[60:61]
    v_min_f32 v96, s64, v96
    v_min_f32 v97, s64, v97
    v_min_f32 v98, s64, v98
    v_min_f32 v99, s64, v99
    v_min_f32 v100, s64, v100
    v_min_f32 v101, s64, v101
    v_min_f32 v102, s64, v102
    v_min_f32 v103, s64, v103
    v_exp_f32 v96, v96
    v_exp_f32 v97, v97
    v_exp_f32 v98, v98
    v_exp_f32 v99, v99
    v_exp_f32 v100, v100
    v_exp_f32 v101, v101
    v_exp_f32 v102, v102
    v_exp_f32 v103, v103
    v_pk_add_f32 v[104:105], v[96:97], s[62:63]
    v_pk_add_f32 v[106:107], v[98:99], s[62:63]
    v_pk_add_f32 v[108:109], v[100:101], s[62:63]
    v_pk_add_f32 v[110:111], v[102:103], s[62:63]
    v_pk_mul_f32 v[96:97], v[96:97], v[104:105]
    v_pk_mul_f32 v[98:99], v[98:99], v[106:107]
    v_pk_mul_f32 v[100:101], v[100:101], v[108:109]
    v_pk_mul_f32 v[102:103], v[102:103], v[110:111]
    v_pk_add_f32 v[104:105], v[96:97], s[62:63]
    v_pk_add_f32 v[106:107], v[98:99], s[62:63]
    v_pk_add_f32 v[108:109], v[100:101], s[62:63]
    v_pk_add_f32 v[110:111], v[102:103], s[62:63]
    v_rcp_f32 v104, v104
    v_rcp_f32 v105, v105
    v_rcp_f32 v106, v106
    v_rcp_f32 v107, v107
    v_rcp_f32 v108, v108
    v_rcp_f32 v109, v109
    v_rcp_f32 v110, v110
    v_rcp_f32 v111, v111
    v_pk_mul_f32 v[96:97], v[96:97], v[104:105]
    v_pk_mul_f32 v[98:99], v[98:99], v[106:107]
    v_pk_mul_f32 v[100:101], v[100:101], v[108:109]
    v_pk_mul_f32 v[102:103], v[102:103], v[110:111]
    v_pk_mul_f32 v[248:249], v[248:249], v[96:97]
    v_pk_mul_f32 v[250:251], v[250:251], v[98:99]
    v_pk_mul_f32 v[252:253], v[252:253], v[100:101]
    v_pk_mul_f32 v[254:255], v[254:255], v[102:103]
    v_cvt_pk_bf16_f32 v92, v248, v249
    v_cvt_pk_bf16_f32 v93, v250, v251
    v_cvt_pk_bf16_f32 v94, v252, v253
    v_cvt_pk_bf16_f32 v95, v254, v255
    buffer_store_dwordx4 v[92:95], v46, s[4:7], s25 offen offset:2304 sc1
    s_mov_b32 s57, 1
    s_branch mk_done
mk_ef:
    s_cmp_lt_u32 s79, 106
    s_cbranch_scc1 mk_cont
mk_efs:
    s_add_u32 s25, s37, 0
    v_cvt_pk_bf16_f32 v64, v128, v129
    v_cvt_pk_bf16_f32 v65, v130, v131
    v_cvt_pk_bf16_f32 v66, v132, v133
    v_cvt_pk_bf16_f32 v67, v134, v135
    buffer_store_dwordx4 v[64:67], v46, s[4:7], s25 offen offset:0 sc1
    v_cvt_pk_bf16_f32 v68, v144, v145
    v_cvt_pk_bf16_f32 v69, v146, v147
    v_cvt_pk_bf16_f32 v70, v148, v149
    v_cvt_pk_bf16_f32 v71, v150, v151
    buffer_store_dwordx4 v[68:71], v46, s[4:7], s25 offen offset:256 sc1
    v_cvt_pk_bf16_f32 v72, v136, v137
    v_cvt_pk_bf16_f32 v73, v138, v139
    v_cvt_pk_bf16_f32 v74, v140, v141
    v_cvt_pk_bf16_f32 v75, v142, v143
    buffer_store_dwordx4 v[72:75], v46, s[4:7], s25 offen offset:2048 sc1
    v_cvt_pk_bf16_f32 v76, v152, v153
    v_cvt_pk_bf16_f32 v77, v154, v155
    v_cvt_pk_bf16_f32 v78, v156, v157
    v_cvt_pk_bf16_f32 v79, v158, v159
    buffer_store_dwordx4 v[76:79], v46, s[4:7], s25 offen offset:2304 sc1
    s_add_u32 s25, s37, 65536
    v_cvt_pk_bf16_f32 v80, v160, v161
    v_cvt_pk_bf16_f32 v81, v162, v163
    v_cvt_pk_bf16_f32 v82, v164, v165
    v_cvt_pk_bf16_f32 v83, v166, v167
    buffer_store_dwordx4 v[80:83], v46, s[4:7], s25 offen offset:0 sc1
    v_cvt_pk_bf16_f32 v84, v176, v177
    v_cvt_pk_bf16_f32 v85, v178, v179
    v_cvt_pk_bf16_f32 v86, v180, v181
    v_cvt_pk_bf16_f32 v87, v182, v183
    buffer_store_dwordx4 v[84:87], v46, s[4:7], s25 offen offset:256 sc1
    v_cvt_pk_bf16_f32 v88, v168, v169
    v_cvt_pk_bf16_f32 v89, v170, v171
    v_cvt_pk_bf16_f32 v90, v172, v173
    v_cvt_pk_bf16_f32 v91, v174, v175
    buffer_store_dwordx4 v[88:91], v46, s[4:7], s25 offen offset:2048 sc1
    v_cvt_pk_bf16_f32 v92, v184, v185
    v_cvt_pk_bf16_f32 v93, v186, v187
    v_cvt_pk_bf16_f32 v94, v188, v189
    v_cvt_pk_bf16_f32 v95, v190, v191
    buffer_store_dwordx4 v[92:95], v46, s[4:7], s25 offen offset:2304 sc1
    s_add_u32 s25, s37, 131072
    v_cvt_pk_bf16_f32 v64, v192, v193
    v_cvt_pk_bf16_f32 v65, v194, v195
    v_cvt_pk_bf16_f32 v66, v196, v197
    v_cvt_pk_bf16_f32 v67, v198, v199
    buffer_store_dwordx4 v[64:67], v46, s[4:7], s25 offen offset:0 sc1
    v_cvt_pk_bf16_f32 v68, v208, v209
    v_cvt_pk_bf16_f32 v69, v210, v211
    v_cvt_pk_bf16_f32 v70, v212, v213
    v_cvt_pk_bf16_f32 v71, v214, v215
    buffer_store_dwordx4 v[68:71], v46, s[4:7], s25 offen offset:256 sc1
    v_cvt_pk_bf16_f32 v72, v200, v201
    v_cvt_pk_bf16_f32 v73, v202, v203
    v_cvt_pk_bf16_f32 v74, v204, v205
    v_cvt_pk_bf16_f32 v75, v206, v207
    buffer_store_dwordx4 v[72:75], v46, s[4:7], s25 offen offset:2048 sc1
    v_cvt_pk_bf16_f32 v76, v216, v217
    v_cvt_pk_bf16_f32 v77, v218, v219
    v_cvt_pk_bf16_f32 v78, v220, v221
    v_cvt_pk_bf16_f32 v79, v222, v223
    buffer_store_dwordx4 v[76:79], v46, s[4:7], s25 offen offset:2304 sc1
    s_add_u32 s25, s37, 196608
    v_cvt_pk_bf16_f32 v80, v224, v225
    v_cvt_pk_bf16_f32 v81, v226, v227
    v_cvt_pk_bf16_f32 v82, v228, v229
    v_cvt_pk_bf16_f32 v83, v230, v231
    buffer_store_dwordx4 v[80:83], v46, s[4:7], s25 offen offset:0 sc1
    v_cvt_pk_bf16_f32 v84, v240, v241
    v_cvt_pk_bf16_f32 v85, v242, v243
    v_cvt_pk_bf16_f32 v86, v244, v245
    v_cvt_pk_bf16_f32 v87, v246, v247
    buffer_store_dwordx4 v[84:87], v46, s[4:7], s25 offen offset:256 sc1
    v_cvt_pk_bf16_f32 v88, v232, v233
    v_cvt_pk_bf16_f32 v89, v234, v235
    v_cvt_pk_bf16_f32 v90, v236, v237
    v_cvt_pk_bf16_f32 v91, v238, v239
    buffer_store_dwordx4 v[88:91], v46, s[4:7], s25 offen offset:2048 sc1
    v_cvt_pk_bf16_f32 v92, v248, v249
    v_cvt_pk_bf16_f32 v93, v250, v251
    v_cvt_pk_bf16_f32 v94, v252, v253
    v_cvt_pk_bf16_f32 v95, v254, v255
    buffer_store_dwordx4 v[92:95], v46, s[4:7], s25 offen offset:2304 sc1
    s_mov_b32 s57, 1
mk_done:
    s_mov_b32 s56, s40
    s_cmp_eq_u32 s73, 1
    s_cbranch_scc1 mk_run
    s_waitcnt vmcnt(0)
    s_barrier
    s_cmp_lg_u32 s20, 0
    s_cbranch_scc1 mk_dn2
    v_and_b32 v1, 63, v0
    v_min_u32 v1, 1, v1
    v_lshlrev_b32 v1, 30, v1
    v_mov_b32 v2, s57
    buffer_atomic_add v2, v1, s[4:7], s56 offen sc1
mk_dn2:
    s_mov_b32 s56, 0
    s_branch mk_start
mk_cont:
    s_cmp_eq_u32 s73, 1
    s_cbranch_scc1 mk_run
    s_waitcnt vmcnt(0)
    s_branch mk_start
mk_serv:
    s_sub_u32 s23, s58, 1
    s_cmp_eq_u32 s19, s23
    s_cbranch_scc1 mk_sv1
    s_cmp_eq_u32 s19, 4
    s_cbranch_scc1 mk_sv4
    s_cmp_eq_u32 s19, 3
    s_cbranch_scc1 mk_sv3
    s_cmp_eq_u32 s19, 2
    s_cbranch_scc1 mk_sv2
    s_setpc_b64 s[26:27]
mk_sv1:
    s_cmp_eq_u32 s56, 0
    s_cbranch_scc1 mk_svr
    v_and_b32 v40, 63, v0
    v_min_u32 v40, 1, v40
    v_lshlrev_b32 v40, 30, v40
    v_mov_b32 v41, s57
    buffer_atomic_add v41, v40, s[4:7], s56 offen sc1
    s_mov_b32 s56, 0
mk_svr:
    s_setpc_b64 s[26:27]
mk_sv4:
    s_sub_u32 s23, s79, 96
    s_cmp_lt_u32 s23, 10
    s_cbranch_scc1 mk_svr
    v_and_b32 v40, 63, v0
    v_min_u32 v40, 1, v40
    v_lshlrev_b32 v40, 30, v40
    v_mov_b32 v42, 1
    buffer_atomic_add v42, v40, s[4:7], s59 offen sc0 sc1
    s_setpc_b64 s[26:27]
mk_sv3:
    s_add_u32 s72, s79, 32
    s_sub_u32 s23, s79, 96
    s_cmp_lt_u32 s23, 10
    s_cbranch_scc1 mk_sv3b
    v_readfirstlane_b32 s23, v42
    s_min_u32 s23, s23, 127
    s_add_u32 s23, s23, 131072
    v_mov_b32 v42, s23
    ds_read_u8 v42, v42
    s_waitcnt lgkmcnt(0)
    v_readfirstlane_b32 s72, v42
mk_sv3b:
    s_bfe_u32 s23, s72, 0x40001
    s_lshl_b32 s23, s23, 7
    s_lshr_b32 s25, s72, 5
    s_cmp_eq_u32 s25, 3
    s_cselect_b32 s24, 14, 0
    s_cmp_eq_u32 s25, 4
    s_cselect_b32 s24, 1, s24
    s_cselect_b32 s25, 3072, 0
    s_add_u32 s23, s23, s25
    s_add_u32 s23, s23, 167858176
    v_mov_b32 v40, 0
    buffer_load_dword v43, v40, s[4:7], s23 offen sc1
    s_setpc_b64 s[26:27]
mk_sv2:
    s_bfe_u32 s23, s72, 0x40001
    s_lshl_b32 s23, s23, 7
    s_lshr_b32 s25, s72, 5
    s_cmp_eq_u32 s25, 3
    s_cselect_b32 s24, 14, 0
    s_cmp_eq_u32 s25, 4
    s_cselect_b32 s24, 1, s24
    s_cselect_b32 s25, 3072, 0
    s_add_u32 s23, s23, s25
    s_add_u32 s23, s23, 167858176
    v_readfirstlane_b32 s23, v43
    s_cmp_ge_u32 s23, s24
    s_cselect_b32 s23, 0x100, 0
    s_cmp_ge_u32 s72, 160
    s_cselect_b32 s23, 0, s23
    s_or_b32 s23, s23, s72
    v_mov_b32 v41, s23
    v_mov_b32 v40, 131200
    ds_write_b32 v40, v41
    s_setpc_b64 s[26:27]
mk_switch:
    v_mov_b32 v40, 131200
    ds_read_b32 v41, v40
    s_waitcnt lgkmcnt(0)
    v_readfirstlane_b32 s72, v41
    s_lshr_b32 s73, s72, 8
    s_and_b32 s72, s72, 0xff
    s_cmp_eq_u32 s73, 1
    s_cbranch_scc1 mk_prep
    s_mov_b32 s6, 0
    s_mov_b32 s10, 0
    s_setpc_b64 s[26:27]
mk_prep:
    s_lshr_b32 s25, s72, 5
    s_and_b32 s34, s72, 31
    s_lshr_b32 s38, s20, 2
    s_lshl_b32 s38, s38, 2
    s_and_b32 s39, s20, 3
    s_lshl_b32 s39, s39, 1
    s_mov_b32 s30, 8
    s_cmp_ge_u32 s25, 3
    s_cbranch_scc1 mk_pf
    s_mov_b32 s29, 65536
    s_cmp_eq_u32 s25, 2
    s_cbranch_scc1 mk_ph
    s_mov_b32 s28, 8192
    s_mov_b32 s10, 8388608
    s_cmp_eq_u32 s25, 1
    s_cbranch_scc1 mk_pq
    s_lshr_b32 s35, s34, 2
    s_add_u32 s35, s35, 2
    s_and_b32 s36, s34, 3
    s_lshl_b32 s23, s80, 2
    s_add_u32 s23, s23, s36
    s_and_b32 s36, s23, 15
    s_lshl_b32 s32, s35, 5
    s_add_u32 s32, s32, s23
    s_lshl_b32 s32, s32, 7
    s_add_u32 s32, s32, 167772160
    s_cmp_ge_u32 s80, 4
    s_cselect_b32 s8, s90, s88
    s_cselect_b32 s9, s91, s89
    s_mov_b32 s33, 20971520
    s_cselect_b32 s33, 37748736, s33
    s_branch mk_pq2
mk_pq:
    s_lshr_b32 s35, s34, 1
    s_and_b32 s36, s34, 1
    s_lshl_b32 s23, s80, 1
    s_add_u32 s36, s36, s23
    s_lshl_b32 s32, s35, 4
    s_add_u32 s32, s32, s36
    s_lshl_b32 s32, s32, 7
    s_add_u32 s32, s32, 167804928
    s_mov_b32 s8, s86
    s_mov_b32 s9, s87
    s_mov_b32 s33, 4194304
mk_pq2:
    s_lshl_b32 s31, s35, 3
    s_add_u32 s31, s31, s38
    s_lshl_b32 s31, s31, 18
    s_add_u32 s31, s31, s33
    s_branch mk_px
mk_ph:
    s_mov_b32 s28, 7168
    s_mov_b32 s10, 7340032
    s_mov_b32 s8, s94
    s_mov_b32 s9, s95
    s_mov_b32 s35, s80
    s_mov_b32 s36, s34
    s_lshl_b32 s32, s80, 7
    s_add_u32 s32, s32, 167858176
    s_lshl_b32 s33, s36, 9
    s_lshl_b32 s23, s39, 6
    s_add_u32 s33, s33, s23
    s_lshl_b32 s31, s35, 3
    s_add_u32 s31, s31, s38
    s_mul_i32 s31, s31, 491520
    s_add_u32 s31, s31, 54525952
mk_px:
    s_lshl_b32 s16, s35, 19
    s_lshl_b32 s17, s36, 9
    s_branch mk_pc
mk_pf:
    s_mov_b32 s28, 2048
    s_mov_b32 s29, 491520
    s_lshr_b32 s35, s34, 1
    s_and_b32 s36, s34, 1
    s_and_b32 s23, s80, 1
    s_lshl_b32 s23, s23, 1
    s_add_u32 s36, s36, s23
    s_lshr_b32 s24, s80, 1
    s_lshl_b32 s32, s35, 2
    s_add_u32 s32, s32, s36
    s_lshl_b32 s32, s32, 7
    s_add_u32 s32, s32, 167821312
    s_lshl_b32 s31, s35, 3
    s_add_u32 s31, s31, s38
    s_lshl_b32 s31, s31, 16
    s_lshl_b32 s33, s36, 3
    s_add_u32 s33, s33, s39
    s_lshl_b32 s33, s33, 6
    s_add_u32 s33, s33, s31
    s_add_u32 s31, s31, 150994944
    s_lshl_b32 s23, s24, 22
    s_add_u32 s31, s31, s23
    s_mul_i32 s16, s35, 3932160
    s_add_u32 s16, s16, 54525952
    s_lshl_b32 s17, s36, 9
    s_cmp_eq_u32 s25, 4
    s_cbranch_scc1 mk_pw
    s_mov_b32 s30, 7
    s_mov_b32 s8, s98
    s_mov_b32 s9, s99
    s_mov_b32 s10, 7340032
    s_mul_i32 s23, s24, 57344
    s_add_u32 s16, s16, s23
    s_mul_i32 s23, s24, 1835008
    s_add_u32 s17, s17, s23
    s_branch mk_pc
mk_pw:
    s_mov_b32 s8, s92
    s_mov_b32 s9, s93
    s_mov_b32 s10, 8388608
    s_lshl_b32 s23, s24, 16
    s_add_u32 s16, s16, s23
    s_add_u32 s16, s16, 229376
    s_lshl_b32 s23, s24, 21
    s_add_u32 s17, s17, s23
mk_pc:
    s_and_b32 s9, s9, 0xffff
    s_mov_b32 s11, 0x00020000
    s_lshl_b32 s23, s36, 3
    s_add_u32 s23, s23, s39
    s_lshl_b32 s23, s23, 11
    s_add_u32 s31, s31, s23
    s_lshl_b32 s18, s28, 5
    s_mul_i32 s23, s20, s29
    v_lshlrev_b32 v48, 4, v47
    v_add_u32 v48, s23, v48
    s_mul_i32 s23, s20, s28
    s_lshl_b32 s23, s23, 2
    v_lshrrev_b32 v40, 5, v47
    v_and_b32 v41, 31, v47
    v_lshlrev_b32 v42, 2, v40
    v_xor_b32 v41, v41, v42
    s_and_b32 s24, s20, 1
    s_lshl_b32 s24, s24, 1
    v_xor_b32 v41, s24, v41
    v_mul_lo_u32 v40, v40, s28
    v_add_u32 v40, s23, v40
    v_lshl_add_u32 v49, v41, 4, v40
    v_xor_b32 v41, 8, v41
    v_lshl_add_u32 v50, v41, 4, v40
    s_lshl_b32 s23, s28, 1
    s_sub_u32 s23, s23, 1024
    v_add_u32 v50, s23, v50
    s_setpc_b64 s[26:27]
mk_other:
    s_and_b32 s34, s72, 31
    s_cmp_ge_u32 s72, 224
    s_cbranch_scc1 mk_stream
mk_nopre:
    s_cmp_lt_u32 s72, 192
    s_cbranch_scc1 mk_fix
    s_lshl_b32 s68, s34, 3
    s_add_u32 s68, s68, s20
    s_mov_b32 s69, 16
    s_mov_b32 s70, 260
mk_attn:
    v_and_b32 v1, 63, v0
    v_and_b32 v14, 15, v1
    v_lshrrev_b32 v15, 4, v1
    v_lshlrev_b32 v12, 9, v15
    v_lshl_add_u32 v12, v14, 4, v12
    v_lshlrev_b32 v13, 4, v1
    v_lshlrev_b32 v15, 2, v15
    v_mov_b32 v4, 0xf149f2ca
    v_mov_b32 v8, 0xf149f2ca
    v_mov_b32 v5, 0xf149f2ca
    v_mov_b32 v9, 0xf149f2ca
    v_mov_b32 v6, 0xf149f2ca
    v_mov_b32 v10, 0xf149f2ca
    v_mov_b32 v7, 0xf149f2ca
    v_mov_b32 v11, 0xf149f2ca
    v_cmp_le_u32 vcc, 8, v15
    s_nop 1
    v_cndmask_b32 v4, v4, 0, vcc
    v_cndmask_b32 v5, v5, 0, vcc
    v_cndmask_b32 v6, v6, 0, vcc
    v_cndmask_b32 v7, v7, 0, vcc
    v_cmp_le_u32 vcc, v15, v14
    s_nop 1
    v_cndmask_b32 v8, v8, 0, vcc
    v_add_u32 v15, 1, v15
    v_cmp_le_u32 vcc, v15, v14
    s_nop 1
    v_cndmask_b32 v9, v9, 0, vcc
    v_add_u32 v15, 1, v15
    v_cmp_le_u32 vcc, v15, v14
    s_nop 1
    v_cndmask_b32 v10, v10, 0, vcc
    v_add_u32 v15, 1, v15
    v_cmp_le_u32 vcc, v15, v14
    s_nop 1
    v_cndmask_b32 v11, v11, 0, vcc
    v_add_u32 v15, 1, v15
    s_mov_b32 s37, 0x3e0293ee
    v_and_b32 v2, 1, v1
    v_lshlrev_b32 v2, 11, v2
    v_mov_b32 v3, 0
    v_and_b32 v190, 0, v1
    v_lshlrev_b32 v190, 2, v190
    v_min_u32 v191, 1, v1
    v_lshlrev_b32 v191, 30, v191
mk_at:
    s_lshr_b32 s30, s68, 2
    s_cmp_eq_u32 s30, 63
    s_cselect_b32 s71, 1, 3
    s_cmp_eq_u32 s30, 64
    s_cselect_b32 s71, 2, s71
    s_min_u32 s30, s30, 63
    s_and_b32 s31, s68, 3
    s_lshl_b32 s40, s80, 2
    s_add_u32 s31, s31, s40
    s_lshr_b32 s43, s30, 3
    s_lshr_b32 s40, s31, 1
    s_lshl_b32 s40, s40, 7
    s_lshl_b32 s41, s43, 11
    s_add_u32 s41, s41, s40
    s_add_u32 s41, s41, 167804928
    s_lshl_b32 s42, s43, 12
    s_add_u32 s40, s40, s42
    s_add_u32 s40, s40, 167772160
    s_lshl_b32 s42, s31, 7
    s_add_u32 s42, s42, 167854080
wf_41:
    buffer_load_dword v189, v2, s[4:7], s40 offen sc1
    s_waitcnt vmcnt(0)
    v_cmp_gt_u32 vcc, 4, v189
    s_cbranch_vccz wfo_42
    s_sleep 16
    s_sub_u32 s78, s78, 1
    s_cbranch_scc0 wf_41
    s_mov_b32 s78, 0
wfo_42:
wf_43:
    buffer_load_dword v189, v3, s[4:7], s41 offen sc1
    s_waitcnt vmcnt(0)
    v_cmp_gt_u32 vcc, 4, v189
    s_cbranch_vccz wfo_44
    s_sleep 16
    s_sub_u32 s78, s78, 1
    s_cbranch_scc0 wf_43
    s_mov_b32 s78, 0
wfo_44:
    s_add_u32 s43, s30, 1
    s_cmp_ge_u32 s30, 59
    s_sub_u32 s76, s30, 1
    s_cmp_ge_u32 s30, 59
    s_cselect_b32 s43, s76, s43
    s_lshl_b32 s60, s30, 18
    s_lshl_b32 s61, s31, 13
    s_add_u32 s60, s60, s61
    s_mul_i32 s62, s30, 0x30000
    s_mul_i32 s63, s31, 6144
    s_add_u32 s62, s62, s63
    s_add_u32 s62, s62, 92274688
    s_add_u32 s63, s62, 4096
    s_add_u32 s64, s60, 4194304
    s_add_u32 s65, s60, 4198400
    buffer_load_dwordx4 v[16:19], v12, s[4:7], s64 offen offset:0 sc1
    buffer_load_dwordx4 v[32:35], v12, s[4:7], s64 offen offset:256 sc1
    buffer_load_dwordx4 v[20:23], v12, s[4:7], s64 offen offset:2048 sc1
    buffer_load_dwordx4 v[36:39], v12, s[4:7], s64 offen offset:2304 sc1
    buffer_load_dwordx4 v[24:27], v12, s[4:7], s65 offen offset:0 sc1
    buffer_load_dwordx4 v[40:43], v12, s[4:7], s65 offen offset:256 sc1
    buffer_load_dwordx4 v[28:31], v12, s[4:7], s65 offen offset:2048 sc1
    buffer_load_dwordx4 v[44:47], v12, s[4:7], s65 offen offset:2304 sc1
    s_add_u32 s64, s60, 20971520
    s_add_u32 s65, s60, 20975616
    buffer_load_dwordx4 v[48:51], v12, s[4:7], s64 offen offset:0 sc1
    buffer_load_dwordx4 v[64:67], v12, s[4:7], s64 offen offset:256 sc1
    buffer_load_dwordx4 v[52:55], v12, s[4:7], s64 offen offset:2048 sc1
    buffer_load_dwordx4 v[68:71], v12, s[4:7], s64 offen offset:2304 sc1
    buffer_load_dwordx4 v[56:59], v12, s[4:7], s65 offen offset:0 sc1
    buffer_load_dwordx4 v[72:75], v12, s[4:7], s65 offen offset:256 sc1
    buffer_load_dwordx4 v[60:63], v12, s[4:7], s65 offen offset:2048 sc1
    buffer_load_dwordx4 v[76:79], v12, s[4:7], s65 offen offset:2304 sc1
    s_add_u32 s64, s60, 37748736
    s_add_u32 s65, s60, 37752832
    buffer_load_dwordx4 v[96:99], v12, s[4:7], s64 offen offset:0 sc1
    buffer_load_dwordx4 v[100:103], v12, s[4:7], s64 offen offset:256 sc1
    buffer_load_dwordx4 v[104:107], v12, s[4:7], s64 offen offset:2048 sc1
    buffer_load_dwordx4 v[108:111], v12, s[4:7], s64 offen offset:2304 sc1
    buffer_load_dwordx4 v[112:115], v12, s[4:7], s65 offen offset:0 sc1
    buffer_load_dwordx4 v[116:119], v12, s[4:7], s65 offen offset:256 sc1
    buffer_load_dwordx4 v[120:123], v12, s[4:7], s65 offen offset:2048 sc1
    buffer_load_dwordx4 v[124:127], v12, s[4:7], s65 offen offset:2304 sc1
wf_45:
    buffer_load_dword v189, v190, s[4:7], s42 offen sc1
    s_waitcnt vmcnt(0)
    v_cmp_gt_u32 vcc, s43, v189
    s_cbranch_vccz wfo_46
    v_readfirstlane_b32 s76, v189
    s_add_u32 s76, s76, 1
    s_cmp_ge_u32 s76, s43
    s_cbranch_scc1 wn_47
    s_sleep 64
wn_47:
    s_sleep 4
    s_sub_u32 s78, s78, 1
    s_cbranch_scc0 wf_45
    s_mov_b32 s78, 0
wfo_46:
rp_48:
    buffer_load_dwordx4 v[80:83], v13, s[4:7], s62 offen offset:0 sc1
    buffer_load_dwordx4 v[84:87], v13, s[4:7], s62 offen offset:1024 sc1
    buffer_load_dwordx4 v[88:91], v13, s[4:7], s62 offen offset:2048 sc1
    buffer_load_dwordx4 v[92:95], v13, s[4:7], s62 offen offset:3072 sc1
    v_lshrrev_b32 v180, 1, v13
    buffer_load_dwordx2 v[128:129], v180, s[4:7], s63 offen offset:0 sc1
    buffer_load_dwordx2 v[130:131], v180, s[4:7], s63 offen offset:512 sc1
    buffer_load_dwordx2 v[132:133], v180, s[4:7], s63 offen offset:1024 sc1
    buffer_load_dwordx2 v[134:135], v180, s[4:7], s63 offen offset:1536 sc1
    s_waitcnt vmcnt(0)
    v_max3_u32 v180, v80, v81, v82
    v_max3_u32 v180, v180, v83, v84
    v_max3_u32 v180, v180, v85, v86
    v_max3_u32 v180, v180, v87, v88
    v_max3_u32 v180, v180, v89, v90
    v_max3_u32 v180, v180, v91, v92
    v_max3_u32 v180, v180, v93, v94
    v_max3_u32 v180, v180, v95, v128
    v_max3_u32 v180, v180, v129, v130
    v_max3_u32 v180, v180, v131, v132
    v_max3_u32 v180, v180, v133, v134
    v_max_u32 v180, v180, v135
    v_cmp_eq_u32 vcc, -1, v180
    s_cbranch_vccz ro_49
    s_sub_u32 s78, s78, 1
    s_cbranch_scc0 rp_48
    s_mov_b32 s78, 0
ro_49:
    s_mul_i32 s66, s30, 491520
    s_add_u32 s66, s66, s61
    s_add_u32 s66, s66, 54755328
    s_add_u32 s67, s66, 4096
    s_bitcmp1_b32 s71, 0
    s_cbranch_scc0 at_skip0
    s_waitcnt vmcnt(2)
    v_mfma_f32_16x16x32_bf16 v[136:139], v[80:83], v[16:19], v[4:7]
    v_mfma_f32_16x16x32_bf16 v[140:143], v[48:51], v[16:19], v[8:11]
    v_mfma_f32_16x16x32_bf16 v[136:139], v[84:87], v[20:23], v[136:139]
    v_mfma_f32_16x16x32_bf16 v[140:143], v[52:55], v[20:23], v[140:143]
    v_mfma_f32_16x16x32_bf16 v[136:139], v[88:91], v[24:27], v[136:139]
    v_mfma_f32_16x16x32_bf16 v[140:143], v[56:59], v[24:27], v[140:143]
    v_mfma_f32_16x16x32_bf16 v[136:139], v[92:95], v[28:31], v[136:139]
    v_mfma_f32_16x16x32_bf16 v[140:143], v[60:63], v[28:31], v[140:143]
    s_nop 6
    v_max3_f32 v186, v136, v137, v138
    v_max3_f32 v187, v139, v140, v141
    v_max3_f32 v186, v186, v142, v143
    v_max_f32 v186, v186, v187
    v_mov_b32 v187, v186
    s_nop 1
    v_permlane32_swap_b32 v186, v187
    v_max_f32 v186, v186, v187
    v_mov_b32 v187, v186
    s_nop 1
    v_permlane16_swap_b32 v186, v187
    v_max_f32 v186, v186, v187
    v_mul_f32 v186, s37, v186
    v_fma_f32 v136, v136, s37, -v186
    v_fma_f32 v137, v137, s37, -v186
    v_fma_f32 v138, v138, s37, -v186
    v_fma_f32 v139, v139, s37, -v186
    v_fma_f32 v140, v140, s37, -v186
    v_fma_f32 v141, v141, s37, -v186
    v_fma_f32 v142, v142, s37, -v186
    v_fma_f32 v143, v143, s37, -v186
    v_exp_f32 v136, v136
    v_exp_f32 v137, v137
    v_exp_f32 v138, v138
    v_exp_f32 v139, v139
    v_exp_f32 v140, v140
    v_exp_f32 v141, v141
    v_exp_f32 v142, v142
    v_exp_f32 v143, v143
    v_cvt_pk_bf16_f32 v180, v140, v141
    v_cvt_pk_bf16_f32 v181, v142, v143
    v_mov_b32 v182, 0
    v_mov_b32 v183, 0
    v_cvt_pk_bf16_f32 v184, v136, v137
    v_cvt_pk_bf16_f32 v185, v138, v139
    s_nop 1
    v_permlane32_swap_b32 v184, v185
    v_mov_b32 v186, v185
    v_mov_b32 v187, 0
    s_waitcnt vmcnt(0)
    v_mfma_f32_16x16x32_bf16 v[148:151], v[96:99], v[180:183], 0
    v_mfma_f32_16x16x32_bf16 v[152:155], v[100:103], v[180:183], 0
    v_mfma_f32_16x16x32_bf16 v[156:159], v[104:107], v[180:183], 0
    v_mfma_f32_16x16x32_bf16 v[160:163], v[108:111], v[180:183], 0
    v_mfma_f32_16x16x32_bf16 v[164:167], v[112:115], v[180:183], 0
    v_mfma_f32_16x16x32_bf16 v[168:171], v[116:119], v[180:183], 0
    v_mfma_f32_16x16x32_bf16 v[172:175], v[120:123], v[180:183], 0
    v_mfma_f32_16x16x32_bf16 v[176:179], v[124:127], v[180:183], 0
    v_pk_add_f32 v[136:137], v[136:137], v[138:139]
    v_pk_add_f32 v[136:137], v[136:137], v[140:141]
    v_pk_add_f32 v[136:137], v[136:137], v[142:143]
    v_mfma_f32_16x16x16_bf16 v[148:151], v[128:129], v[186:187], v[148:151]
    v_mfma_f32_16x16x16_bf16 v[152:155], v[128:129], v[184:185], v[152:155]
    v_mfma_f32_16x16x16_bf16 v[156:159], v[130:131], v[186:187], v[156:159]
    v_mfma_f32_16x16x16_bf16 v[160:163], v[130:131], v[184:185], v[160:163]
    v_mfma_f32_16x16x16_bf16 v[164:167], v[132:133], v[186:187], v[164:167]
    v_mfma_f32_16x16x16_bf16 v[168:171], v[132:133], v[184:185], v[168:171]
    v_mfma_f32_16x16x16_bf16 v[172:175], v[134:135], v[186:187], v[172:175]
    v_mfma_f32_16x16x16_bf16 v[176:179], v[134:135], v[184:185], v[176:179]
    v_add_f32 v136, v136, v137
    v_mov_b32 v137, v136
    s_nop 1
    v_permlane32_swap_b32 v136, v137
    v_add_f32 v136, v136, v137
    v_mov_b32 v137, v136
    s_nop 1
    v_permlane16_swap_b32 v136, v137
    v_add_f32 v136, v136, v137
    v_rcp_f32 v136, v136
    s_nop 0
    v_pk_mul_f32 v[148:149], v[148:149], v[136:137] op_sel_hi:[1,0]
    v_pk_mul_f32 v[150:151], v[150:151], v[136:137] op_sel_hi:[1,0]
    v_pk_mul_f32 v[152:153], v[152:153], v[136:137] op_sel_hi:[1,0]
    v_pk_mul_f32 v[154:155], v[154:155], v[136:137] op_sel_hi:[1,0]
    v_cvt_pk_bf16_f32 v16, v148, v149
    v_cvt_pk_bf16_f32 v17, v150, v151
    v_cvt_pk_bf16_f32 v18, v152, v153
    v_cvt_pk_bf16_f32 v19, v154, v155
    buffer_store_dwordx4 v[16:19], v12, s[4:7], s66 offen offset:0 sc1
    v_pk_mul_f32 v[156:157], v[156:157], v[136:137] op_sel_hi:[1,0]
    v_pk_mul_f32 v[158:159], v[158:159], v[136:137] op_sel_hi:[1,0]
    v_pk_mul_f32 v[160:161], v[160:161], v[136:137] op_sel_hi:[1,0]
    v_pk_mul_f32 v[162:163], v[162:163], v[136:137] op_sel_hi:[1,0]
    v_cvt_pk_bf16_f32 v20, v156, v157
    v_cvt_pk_bf16_f32 v21, v158, v159
    v_cvt_pk_bf16_f32 v22, v160, v161
    v_cvt_pk_bf16_f32 v23, v162, v163
    buffer_store_dwordx4 v[20:23], v12, s[4:7], s66 offen offset:2048 sc1
    v_pk_mul_f32 v[164:165], v[164:165], v[136:137] op_sel_hi:[1,0]
    v_pk_mul_f32 v[166:167], v[166:167], v[136:137] op_sel_hi:[1,0]
    v_pk_mul_f32 v[168:169], v[168:169], v[136:137] op_sel_hi:[1,0]
    v_pk_mul_f32 v[170:171], v[170:171], v[136:137] op_sel_hi:[1,0]
    v_cvt_pk_bf16_f32 v24, v164, v165
    v_cvt_pk_bf16_f32 v25, v166, v167
    v_cvt_pk_bf16_f32 v26, v168, v169
    v_cvt_pk_bf16_f32 v27, v170, v171
    buffer_store_dwordx4 v[24:27], v12, s[4:7], s67 offen offset:0 sc1
    v_pk_mul_f32 v[172:173], v[172:173], v[136:137] op_sel_hi:[1,0]
    v_pk_mul_f32 v[174:175], v[174:175], v[136:137] op_sel_hi:[1,0]
    v_pk_mul_f32 v[176:177], v[176:177], v[136:137] op_sel_hi:[1,0]
    v_pk_mul_f32 v[178:179], v[178:179], v[136:137] op_sel_hi:[1,0]
    v_cvt_pk_bf16_f32 v28, v172, v173
    v_cvt_pk_bf16_f32 v29, v174, v175
    v_cvt_pk_bf16_f32 v30, v176, v177
    v_cvt_pk_bf16_f32 v31, v178, v179
    buffer_store_dwordx4 v[28:31], v12, s[4:7], s67 offen offset:2048 sc1
at_skip0:
    s_bitcmp1_b32 s71, 1
    s_cbranch_scc0 at_skip1
    v_mfma_f32_16x16x32_bf16 v[136:139], v[80:83], v[32:35], v[4:7]
    v_mfma_f32_16x16x32_bf16 v[140:143], v[48:51], v[32:35], 0
    v_mfma_f32_16x16x32_bf16 v[144:147], v[64:67], v[32:35], v[8:11]
    v_mfma_f32_16x16x32_bf16 v[136:139], v[84:87], v[36:39], v[136:139]
    v_mfma_f32_16x16x32_bf16 v[140:143], v[52:55], v[36:39], v[140:143]
    v_mfma_f32_16x16x32_bf16 v[144:147], v[68:71], v[36:39], v[144:147]
    v_mfma_f32_16x16x32_bf16 v[136:139], v[88:91], v[40:43], v[136:139]
    v_mfma_f32_16x16x32_bf16 v[140:143], v[56:59], v[40:43], v[140:143]
    v_mfma_f32_16x16x32_bf16 v[144:147], v[72:75], v[40:43], v[144:147]
    v_mfma_f32_16x16x32_bf16 v[136:139], v[92:95], v[44:47], v[136:139]
    v_mfma_f32_16x16x32_bf16 v[140:143], v[60:63], v[44:47], v[140:143]
    v_mfma_f32_16x16x32_bf16 v[144:147], v[76:79], v[44:47], v[144:147]
    s_nop 5
    v_max3_f32 v186, v136, v137, v138
    v_max3_f32 v187, v139, v140, v141
    v_max3_f32 v186, v186, v142, v143
    v_max3_f32 v187, v187, v144, v145
    v_max3_f32 v186, v186, v146, v147
    v_max_f32 v186, v186, v187
    v_mov_b32 v187, v186
    s_nop 1
    v_permlane32_swap_b32 v186, v187
    v_max_f32 v186, v186, v187
    v_mov_b32 v187, v186
    s_nop 1
    v_permlane16_swap_b32 v186, v187
    v_max_f32 v186, v186, v187
    v_mul_f32 v186, s37, v186
    v_fma_f32 v136, v136, s37, -v186
    v_fma_f32 v137, v137, s37, -v186
    v_fma_f32 v138, v138, s37, -v186
    v_fma_f32 v139, v139, s37, -v186
    v_fma_f32 v140, v140, s37, -v186
    v_fma_f32 v141, v141, s37, -v186
    v_fma_f32 v142, v142, s37, -v186
    v_fma_f32 v143, v143, s37, -v186
    v_fma_f32 v144, v144, s37, -v186
    v_fma_f32 v145, v145, s37, -v186
    v_fma_f32 v146, v146, s37, -v186
    v_fma_f32 v147, v147, s37, -v186
    v_exp_f32 v136, v136
    v_exp_f32 v137, v137
    v_exp_f32 v138, v138
    v_exp_f32 v139, v139
    v_exp_f32 v140, v140
    v_exp_f32 v141, v141
    v_exp_f32 v142, v142
    v_exp_f32 v143, v143
    v_exp_f32 v144, v144
    v_exp_f32 v145, v145
    v_exp_f32 v146, v146
    v_exp_f32 v147, v147
    v_cvt_pk_bf16_f32 v180, v140, v141
    v_cvt_pk_bf16_f32 v181, v142, v143
    v_cvt_pk_bf16_f32 v182, v144, v145
    v_cvt_pk_bf16_f32 v183, v146, v147
    v_cvt_pk_bf16_f32 v184, v136, v137
    v_cvt_pk_bf16_f32 v185, v138, v139
    s_nop 1
    v_permlane32_swap_b32 v184, v185
    v_mov_b32 v186, v185
    v_mov_b32 v187, 0
    v_mfma_f32_16x16x32_bf16 v[148:151], v[96:99], v[180:183], 0
    v_mfma_f32_16x16x32_bf16 v[152:155], v[100:103], v[180:183], 0
    v_mfma_f32_16x16x32_bf16 v[156:159], v[104:107], v[180:183], 0
    v_mfma_f32_16x16x32_bf16 v[160:163], v[108:111], v[180:183], 0
    v_mfma_f32_16x16x32_bf16 v[164:167], v[112:115], v[180:183], 0
    v_mfma_f32_16x16x32_bf16 v[168:171], v[116:119], v[180:183], 0
    v_mfma_f32_16x16x32_bf16 v[172:175], v[120:123], v[180:183], 0
    v_mfma_f32_16x16x32_bf16 v[176:179], v[124:127], v[180:183], 0
    v_pk_add_f32 v[136:137], v[136:137], v[138:139]
    v_pk_add_f32 v[136:137], v[136:137], v[140:141]
    v_pk_add_f32 v[136:137], v[136:137], v[142:143]
    v_pk_add_f32 v[136:137], v[136:137], v[144:145]
    v_pk_add_f32 v[136:137], v[136:137], v[146:147]
    v_mfma_f32_16x16x16_bf16 v[148:151], v[128:129], v[186:187], v[148:151]
    v_mfma_f32_16x16x16_bf16 v[152:155], v[128:129], v[184:185], v[152:155]
    v_mfma_f32_16x16x16_bf16 v[156:159], v[130:131], v[186:187], v[156:159]
    v_mfma_f32_16x16x16_bf16 v[160:163], v[130:131], v[184:185], v[160:163]
    v_mfma_f32_16x16x16_bf16 v[164:167], v[132:133], v[186:187], v[164:167]
    v_mfma_f32_16x16x16_bf16 v[168:171], v[132:133], v[184:185], v[168:171]
    v_mfma_f32_16x16x16_bf16 v[172:175], v[134:135], v[186:187], v[172:175]
    v_mfma_f32_16x16x16_bf16 v[176:179], v[134:135], v[184:185], v[176:179]
    v_add_f32 v136, v136, v137
    v_mov_b32 v137, v136
    s_nop 1
    v_permlane32_swap_b32 v136, v137
    v_add_f32 v136, v136, v137
    v_mov_b32 v137, v136
    s_nop 1
    v_permlane16_swap_b32 v136, v137
    v_add_f32 v136, v136, v137
    v_rcp_f32 v136, v136
    s_nop 0
    v_pk_mul_f32 v[148:149], v[148:149], v[136:137] op_sel_hi:[1,0]
    v_pk_mul_f32 v[150:151], v[150:151], v[136:137] op_sel_hi:[1,0]
    v_pk_mul_f32 v[152:153], v[152:153], v[136:137] op_sel_hi:[1,0]
    v_pk_mul_f32 v[154:155], v[154:155], v[136:137] op_sel_hi:[1,0]
    v_cvt_pk_bf16_f32 v32, v148, v149
    v_cvt_pk_bf16_f32 v33, v150, v151
    v_cvt_pk_bf16_f32 v34, v152, v153
    v_cvt_pk_bf16_f32 v35, v154, v155
    buffer_store_dwordx4 v[32:35], v12, s[4:7], s66 offen offset:256 sc1
    v_pk_mul_f32 v[156:157], v[156:157], v[136:137] op_sel_hi:[1,0]
    v_pk_mul_f32 v[158:159], v[158:159], v[136:137] op_sel_hi:[1,0]
    v_pk_mul_f32 v[160:161], v[160:161], v[136:137] op_sel_hi:[1,0]
    v_pk_mul_f32 v[162:163], v[162:163], v[136:137] op_sel_hi:[1,0]
    v_cvt_pk_bf16_f32 v36, v156, v157
    v_cvt_pk_bf16_f32 v37, v158, v159
    v_cvt_pk_bf16_f32 v38, v160, v161
    v_cvt_pk_bf16_f32 v39, v162, v163
    buffer_store_dwordx4 v[36:39], v12, s[4:7], s66 offen offset:2304 sc1
    v_pk_mul_f32 v[164:165], v[164:165], v[136:137] op_sel_hi:[1,0]
    v_pk_mul_f32 v[166:167], v[166:167], v[136:137] op_sel_hi:[1,0]
    v_pk_mul_f32 v[168:169], v[168:169], v[136:137] op_sel_hi:[1,0]
    v_pk_mul_f32 v[170:171], v[170:171], v[136:137] op_sel_hi:[1,0]
    v_cvt_pk_bf16_f32 v40, v164, v165
    v_cvt_pk_bf16_f32 v41, v166, v167
    v_cvt_pk_bf16_f32 v42, v168, v169
    v_cvt_pk_bf16_f32 v43, v170, v171
    buffer_store_dwordx4 v[40:43], v12, s[4:7], s67 offen offset:256 sc1
    v_pk_mul_f32 v[172:173], v[172:173], v[136:137] op_sel_hi:[1,0]
    v_pk_mul_f32 v[174:175], v[174:175], v[136:137] op_sel_hi:[1,0]
    v_pk_mul_f32 v[176:177], v[176:177], v[136:137] op_sel_hi:[1,0]
    v_pk_mul_f32 v[178:179], v[178:179], v[136:137] op_sel_hi:[1,0]
    v_cvt_pk_bf16_f32 v44, v172, v173
    v_cvt_pk_bf16_f32 v45, v174, v175
    v_cvt_pk_bf16_f32 v46, v176, v177
    v_cvt_pk_bf16_f32 v47, v178, v179
    buffer_store_dwordx4 v[44:47], v12, s[4:7], s67 offen offset:2304 sc1
at_skip1:
    s_waitcnt vmcnt(0)
    s_cmp_lt_u32 s30, 40
    s_cbranch_scc1 mk_ate
    s_lshl_b32 s43, s30, 7
    s_add_u32 s43, s43, 167837696
    s_cmp_eq_u32 s30, 63
    s_cselect_b32 s42, 63, 31
    v_mov_b32 v192, 1
    buffer_atomic_add v192, v191, s[4:7], s43 offen sc0 sc1
    s_waitcnt vmcnt(0)
    v_readfirstlane_b32 s76, v192
    s_cmp_lg_u32 s76, s42
    s_cbranch_scc1 cr_50
    s_add_u32 s76, s43, 8192
    v_mov_b32 v192, 4
    s_nop 0
    buffer_store_dword v192, v191, s[4:7], s76 offen sc1
cr_50:
    s_branch mk_atn
mk_ate:
    s_lshr_b32 s43, s30, 3
    s_lshl_b32 s43, s43, 7
    s_add_u32 s43, s43, 167860224
    v_mov_b32 v192, 1
    buffer_atomic_add v192, v191, s[4:7], s43 offen sc0 sc1
    s_waitcnt vmcnt(0)
    v_readfirstlane_b32 s76, v192
    s_cmp_lg_u32 s76, 255
    s_cbranch_scc1 cr_51
    s_add_u32 s76, s43, 1024
    v_mov_b32 v192, 4
    s_nop 0
    buffer_store_dword v192, v191, s[4:7], s76 offen sc1
cr_51:
mk_atn:
    s_add_u32 s68, s68, s69
    s_cmp_lt_u32 s68, s70
    s_cbranch_scc1 mk_at
    s_endpgm
mk_fix:
    v_and_b32 v47, 63, v0
    s_lshl_b32 s34, s34, 3
    s_add_u32 s34, s34, s80
    s_cmp_ge_u32 s34, 20
    s_cbranch_scc1 mk_fetch
    s_lshr_b32 s35, s34, 2
    s_and_b32 s36, s34, 3
    s_lshl_b32 s40, s35, 2
    s_add_u32 s40, s40, s36
    s_lshl_b32 s40, s40, 7
    s_add_u32 s40, s40, 167821312
    s_lshr_b32 s37, s20, 2
    s_lshl_b32 s37, s37, 2
    s_lshl_b32 s38, s35, 3
    s_add_u32 s37, s37, s38
    s_lshl_b32 s37, s37, 16
    s_and_b32 s38, s20, 3
    s_lshl_b32 s38, s38, 1
    s_lshl_b32 s39, s36, 3
    s_add_u32 s38, s38, s39
    s_lshl_b32 s39, s38, 6
    s_add_u32 s41, s37, s39
    s_lshl_b32 s38, s38, 11
    s_add_u32 s37, s37, s38
    s_add_u32 s37, s37, 150994944
    v_mov_b32 v3, 0
wf_52:
    buffer_load_dword v2, v3, s[4:7], s40 offen sc1
    s_waitcnt vmcnt(0)
    v_cmp_gt_u32 vcc, 4, v2
    s_cbranch_vccz wfo_53
    s_sleep 16
    s_sub_u32 s78, s78, 1
    s_cbranch_scc0 wf_52
    s_mov_b32 s78, 0
wfo_53:
    s_mov_b32 s44, s84
    s_and_b32 s45, s85, 0xffff
    s_mov_b32 s46, 4194304
    s_mov_b32 s47, 0x00020000
    v_lshlrev_b32 v1, 4, v47
    v_and_b32 v2, 31, v47
    v_lshrrev_b32 v3, 5, v47
    v_lshlrev_b32 v4, 11, v2
    v_lshl_add_u32 v5, v3, 4, v4
    v_lshl_add_u32 v4, v3, 3, v4
    s_add_u32 s25, s37, 0
    buffer_load_dwordx4 v[48:51], v1, s[4:7], s25 offen offset:0 sc1
    buffer_load_dwordx4 v[52:55], v1, s[4:7], s25 offen offset:1024 sc1
    s_add_u32 s25, s37, 4194304
    buffer_load_dwordx4 v[56:59], v1, s[4:7], s25 offen offset:0 sc1
    buffer_load_dwordx4 v[60:63], v1, s[4:7], s25 offen offset:1024 sc1
    s_add_u32 s25, s37, 8388608
    buffer_load_dwordx4 v[64:67], v1, s[4:7], s25 offen offset:0 sc1
    buffer_load_dwordx4 v[68:71], v1, s[4:7], s25 offen offset:1024 sc1
    s_add_u32 s25, s37, 12582912
    buffer_load_dwordx4 v[72:75], v1, s[4:7], s25 offen offset:0 sc1
    buffer_load_dwordx4 v[76:79], v1, s[4:7], s25 offen offset:1024 sc1
    s_add_u32 s25, s37, 20971520
    buffer_load_dwordx4 v[80:83], v1, s[4:7], s25 offen offset:0 sc1
    buffer_load_dwordx4 v[84:87], v1, s[4:7], s25 offen offset:1024 sc1
    s_add_u32 s25, s37, 2048
    buffer_load_dwordx4 v[88:91], v1, s[4:7], s25 offen offset:0 sc1
    buffer_load_dwordx4 v[92:95], v1, s[4:7], s25 offen offset:1024 sc1
    s_add_u32 s25, s37, 4196352
    buffer_load_dwordx4 v[96:99], v1, s[4:7], s25 offen offset:0 sc1
    buffer_load_dwordx4 v[100:103], v1, s[4:7], s25 offen offset:1024 sc1
    s_add_u32 s25, s37, 8390656
    buffer_load_dwordx4 v[104:107], v1, s[4:7], s25 offen offset:0 sc1
    buffer_load_dwordx4 v[108:111], v1, s[4:7], s25 offen offset:1024 sc1
    s_add_u32 s25, s37, 12584960
    buffer_load_dwordx4 v[112:115], v1, s[4:7], s25 offen offset:0 sc1
    buffer_load_dwordx4 v[116:119], v1, s[4:7], s25 offen offset:1024 sc1
    s_add_u32 s25, s37, 20973568
    buffer_load_dwordx4 v[120:123], v1, s[4:7], s25 offen offset:0 sc1
    buffer_load_dwordx4 v[124:127], v1, s[4:7], s25 offen offset:1024 sc1
    s_add_u32 s25, s37, 65536
    buffer_load_dwordx4 v[128:131], v1, s[4:7], s25 offen offset:0 sc1
    buffer_load_dwordx4 v[132:135], v1, s[4:7], s25 offen offset:1024 sc1
    s_add_u32 s25, s37, 4259840
    buffer_load_dwordx4 v[136:139], v1, s[4:7], s25 offen offset:0 sc1
    buffer_load_dwordx4 v[140:143], v1, s[4:7], s25 offen offset:1024 sc1
    s_add_u32 s25, s37, 8454144
    buffer_load_dwordx4 v[144:147], v1, s[4:7], s25 offen offset:0 sc1
    buffer_load_dwordx4 v[148:151], v1, s[4:7], s25 offen offset:1024 sc1
    s_add_u32 s25, s37, 12648448
    buffer_load_dwordx4 v[152:155], v1, s[4:7], s25 offen offset:0 sc1
    buffer_load_dwordx4 v[156:159], v1, s[4:7], s25 offen offset:1024 sc1
    s_add_u32 s25, s37, 21037056
    buffer_load_dwordx4 v[160:163], v1, s[4:7], s25 offen offset:0 sc1
    buffer_load_dwordx4 v[164:167], v1, s[4:7], s25 offen offset:1024 sc1
    s_add_u32 s25, s37, 67584
    buffer_load_dwordx4 v[168:171], v1, s[4:7], s25 offen offset:0 sc1
    buffer_load_dwordx4 v[172:175], v1, s[4:7], s25 offen offset:1024 sc1
    s_add_u32 s25, s37, 4261888
    buffer_load_dwordx4 v[176:179], v1, s[4:7], s25 offen offset:0 sc1
    buffer_load_dwordx4 v[180:183], v1, s[4:7], s25 offen offset:1024 sc1
    s_add_u32 s25, s37, 8456192
    buffer_load_dwordx4 v[184:187], v1, s[4:7], s25 offen offset:0 sc1
    buffer_load_dwordx4 v[188:191], v1, s[4:7], s25 offen offset:1024 sc1
    s_add_u32 s25, s37, 12650496
    buffer_load_dwordx4 v[192:195], v1, s[4:7], s25 offen offset:0 sc1
    buffer_load_dwordx4 v[196:199], v1, s[4:7], s25 offen offset:1024 sc1
    s_add_u32 s25, s37, 21039104
    buffer_load_dwordx4 v[200:203], v1, s[4:7], s25 offen offset:0 sc1
    buffer_load_dwordx4 v[204:207], v1, s[4:7], s25 offen offset:1024 sc1
    s_add_u32 s25, s37, 131072
    buffer_load_dwordx4 v[208:211], v1, s[4:7], s25 offen offset:0 sc1
    buffer_load_dwordx4 v[212:215], v1, s[4:7], s25 offen offset:1024 sc1
    s_add_u32 s25, s37, 4325376
    buffer_load_dwordx4 v[216:219], v1, s[4:7], s25 offen offset:0 sc1
    buffer_load_dwordx4 v[220:223], v1, s[4:7], s25 offen offset:1024 sc1
    s_add_u32 s25, s37, 8519680
    buffer_load_dwordx4 v[224:227], v1, s[4:7], s25 offen offset:0 sc1
    buffer_load_dwordx4 v[228:231], v1, s[4:7], s25 offen offset:1024 sc1
    s_add_u32 s25, s37, 12713984
    buffer_load_dwordx4 v[232:235], v1, s[4:7], s25 offen offset:0 sc1
    buffer_load_dwordx4 v[236:239], v1, s[4:7], s25 offen offset:1024 sc1
    s_add_u32 s25, s37, 21102592
    buffer_load_dwordx4 v[240:243], v1, s[4:7], s25 offen offset:0 sc1
    buffer_load_dwordx4 v[244:247], v1, s[4:7], s25 offen offset:1024 sc1
    s_waitcnt vmcnt(40)
    v_lshlrev_b32 v8, 16, v48
    v_and_b32 v9, 0xffff0000, v48
    v_lshlrev_b32 v10, 16, v49
    v_and_b32 v11, 0xffff0000, v49
    v_lshlrev_b32 v16, 16, v50
    v_and_b32 v17, 0xffff0000, v50
    v_lshlrev_b32 v18, 16, v51
    v_and_b32 v19, 0xffff0000, v51
    v_lshlrev_b32 v12, 16, v52
    v_and_b32 v13, 0xffff0000, v52
    v_lshlrev_b32 v14, 16, v53
    v_and_b32 v15, 0xffff0000, v53
    v_lshlrev_b32 v20, 16, v54
    v_and_b32 v21, 0xffff0000, v54
    v_lshlrev_b32 v22, 16, v55
    v_and_b32 v23, 0xffff0000, v55
    v_lshlrev_b32 v6, 16, v56
    v_and_b32 v7, 0xffff0000, v56
    v_pk_add_f32 v[8:9], v[8:9], v[6:7]
    v_lshlrev_b32 v6, 16, v57
    v_and_b32 v7, 0xffff0000, v57
    v_pk_add_f32 v[10:11], v[10:11], v[6:7]
    v_lshlrev_b32 v6, 16, v58
    v_and_b32 v7, 0xffff0000, v58
    v_pk_add_f32 v[16:17], v[16:17], v[6:7]
    v_lshlrev_b32 v6, 16, v59
    v_and_b32 v7, 0xffff0000, v59
    v_pk_add_f32 v[18:19], v[18:19], v[6:7]
    v_lshlrev_b32 v6, 16, v60
    v_and_b32 v7, 0xffff0000, v60
    v_pk_add_f32 v[12:13], v[12:13], v[6:7]
    v_lshlrev_b32 v6, 16, v61
    v_and_b32 v7, 0xffff0000, v61
    v_pk_add_f32 v[14:15], v[14:15], v[6:7]
    v_lshlrev_b32 v6, 16, v62
    v_and_b32 v7, 0xffff0000, v62
    v_pk_add_f32 v[20:21], v[20:21], v[6:7]
    v_lshlrev_b32 v6, 16, v63
    v_and_b32 v7, 0xffff0000, v63
    v_pk_add_f32 v[22:23], v[22:23], v[6:7]
    v_lshlrev_b32 v6, 16, v64
    v_and_b32 v7, 0xffff0000, v64
    v_pk_add_f32 v[8:9], v[8:9], v[6:7]
    v_lshlrev_b32 v6, 16, v65
    v_and_b32 v7, 0xffff0000, v65
    v_pk_add_f32 v[10:11], v[10:11], v[6:7]
    v_lshlrev_b32 v6, 16, v66
    v_and_b32 v7, 0xffff0000, v66
    v_pk_add_f32 v[16:17], v[16:17], v[6:7]
    v_lshlrev_b32 v6, 16, v67
    v_and_b32 v7, 0xffff0000, v67
    v_pk_add_f32 v[18:19], v[18:19], v[6:7]
    v_lshlrev_b32 v6, 16, v68
    v_and_b32 v7, 0xffff0000, v68
    v_pk_add_f32 v[12:13], v[12:13], v[6:7]
    v_lshlrev_b32 v6, 16, v69
    v_and_b32 v7, 0xffff0000, v69
    v_pk_add_f32 v[14:15], v[14:15], v[6:7]
    v_lshlrev_b32 v6, 16, v70
    v_and_b32 v7, 0xffff0000, v70
    v_pk_add_f32 v[20:21], v[20:21], v[6:7]
    v_lshlrev_b32 v6, 16, v71
    v_and_b32 v7, 0xffff0000, v71
    v_pk_add_f32 v[22:23], v[22:23], v[6:7]
    v_lshlrev_b32 v6, 16, v72
    v_and_b32 v7, 0xffff0000, v72
    v_pk_add_f32 v[8:9], v[8:9], v[6:7]
    v_lshlrev_b32 v6, 16, v73
    v_and_b32 v7, 0xffff0000, v73
    v_pk_add_f32 v[10:11], v[10:11], v[6:7]
    v_lshlrev_b32 v6, 16, v74
    v_and_b32 v7, 0xffff0000, v74
    v_pk_add_f32 v[16:17], v[16:17], v[6:7]
    v_lshlrev_b32 v6, 16, v75
    v_and_b32 v7, 0xffff0000, v75
    v_pk_add_f32 v[18:19], v[18:19], v[6:7]
    v_lshlrev_b32 v6, 16, v76
    v_and_b32 v7, 0xffff0000, v76
    v_pk_add_f32 v[12:13], v[12:13], v[6:7]
    v_lshlrev_b32 v6, 16, v77
    v_and_b32 v7, 0xffff0000, v77
    v_pk_add_f32 v[14:15], v[14:15], v[6:7]
    v_lshlrev_b32 v6, 16, v78
    v_and_b32 v7, 0xffff0000, v78
    v_pk_add_f32 v[20:21], v[20:21], v[6:7]
    v_lshlrev_b32 v6, 16, v79
    v_and_b32 v7, 0xffff0000, v79
    v_pk_add_f32 v[22:23], v[22:23], v[6:7]
    v_lshlrev_b32 v6, 16, v80
    v_and_b32 v7, 0xffff0000, v80
    v_pk_add_f32 v[8:9], v[8:9], v[6:7]
    v_lshlrev_b32 v6, 16, v81
    v_and_b32 v7, 0xffff0000, v81
    v_pk_add_f32 v[10:11], v[10:11], v[6:7]
    v_lshlrev_b32 v6, 16, v82
    v_and_b32 v7, 0xffff0000, v82
    v_pk_add_f32 v[16:17], v[16:17], v[6:7]
    v_lshlrev_b32 v6, 16, v83
    v_and_b32 v7, 0xffff0000, v83
    v_pk_add_f32 v[18:19], v[18:19], v[6:7]
    v_lshlrev_b32 v6, 16, v84
    v_and_b32 v7, 0xffff0000, v84
    v_pk_add_f32 v[12:13], v[12:13], v[6:7]
    v_lshlrev_b32 v6, 16, v85
    v_and_b32 v7, 0xffff0000, v85
    v_pk_add_f32 v[14:15], v[14:15], v[6:7]
    v_lshlrev_b32 v6, 16, v86
    v_and_b32 v7, 0xffff0000, v86
    v_pk_add_f32 v[20:21], v[20:21], v[6:7]
    v_lshlrev_b32 v6, 16, v87
    v_and_b32 v7, 0xffff0000, v87
    v_pk_add_f32 v[22:23], v[22:23], v[6:7]
    v_cvt_pk_bf16_f32 v24, v8, v9
    v_cvt_pk_bf16_f32 v25, v10, v11
    v_cvt_pk_bf16_f32 v26, v12, v13
    v_cvt_pk_bf16_f32 v27, v14, v15
    v_cvt_pk_bf16_f32 v28, v16, v17
    v_cvt_pk_bf16_f32 v29, v18, v19
    v_cvt_pk_bf16_f32 v30, v20, v21
    v_cvt_pk_bf16_f32 v31, v22, v23
    s_add_u32 s24, s41, 0
    v_permlane32_swap_b32 v24, v26
    v_permlane32_swap_b32 v25, v27
    buffer_store_dwordx4 v[24:27], v5, s[44:47], s24 offen offset:0
    v_permlane32_swap_b32 v28, v30
    v_permlane32_swap_b32 v29, v31
    buffer_store_dwordx4 v[28:31], v5, s[44:47], s24 offen offset:32
    s_add_u32 s25, s37, 133120
    buffer_load_dwordx4 v[48:51], v1, s[4:7], s25 offen offset:0 sc1
    buffer_load_dwordx4 v[52:55], v1, s[4:7], s25 offen offset:1024 sc1
    s_add_u32 s25, s37, 4327424
    buffer_load_dwordx4 v[56:59], v1, s[4:7], s25 offen offset:0 sc1
    buffer_load_dwordx4 v[60:63], v1, s[4:7], s25 offen offset:1024 sc1
    s_add_u32 s25, s37, 8521728
    buffer_load_dwordx4 v[64:67], v1, s[4:7], s25 offen offset:0 sc1
    buffer_load_dwordx4 v[68:71], v1, s[4:7], s25 offen offset:1024 sc1
    s_add_u32 s25, s37, 12716032
    buffer_load_dwordx4 v[72:75], v1, s[4:7], s25 offen offset:0 sc1
    buffer_load_dwordx4 v[76:79], v1, s[4:7], s25 offen offset:1024 sc1
    s_add_u32 s25, s37, 21104640
    buffer_load_dwordx4 v[80:83], v1, s[4:7], s25 offen offset:0 sc1
    buffer_load_dwordx4 v[84:87], v1, s[4:7], s25 offen offset:1024 sc1
    s_waitcnt vmcnt(40)
    v_lshlrev_b32 v8, 16, v88
    v_and_b32 v9, 0xffff0000, v88
    v_lshlrev_b32 v10, 16, v89
    v_and_b32 v11, 0xffff0000, v89
    v_lshlrev_b32 v16, 16, v90
    v_and_b32 v17, 0xffff0000, v90
    v_lshlrev_b32 v18, 16, v91
    v_and_b32 v19, 0xffff0000, v91
    v_lshlrev_b32 v12, 16, v92
    v_and_b32 v13, 0xffff0000, v92
    v_lshlrev_b32 v14, 16, v93
    v_and_b32 v15, 0xffff0000, v93
    v_lshlrev_b32 v20, 16, v94
    v_and_b32 v21, 0xffff0000, v94
    v_lshlrev_b32 v22, 16, v95
    v_and_b32 v23, 0xffff0000, v95
    v_lshlrev_b32 v6, 16, v96
    v_and_b32 v7, 0xffff0000, v96
    v_pk_add_f32 v[8:9], v[8:9], v[6:7]
    v_lshlrev_b32 v6, 16, v97
    v_and_b32 v7, 0xffff0000, v97
    v_pk_add_f32 v[10:11], v[10:11], v[6:7]
    v_lshlrev_b32 v6, 16, v98
    v_and_b32 v7, 0xffff0000, v98
    v_pk_add_f32 v[16:17], v[16:17], v[6:7]
    v_lshlrev_b32 v6, 16, v99
    v_and_b32 v7, 0xffff0000, v99
    v_pk_add_f32 v[18:19], v[18:19], v[6:7]
    v_lshlrev_b32 v6, 16, v100
    v_and_b32 v7, 0xffff0000, v100
    v_pk_add_f32 v[12:13], v[12:13], v[6:7]
    v_lshlrev_b32 v6, 16, v101
    v_and_b32 v7, 0xffff0000, v101
    v_pk_add_f32 v[14:15], v[14:15], v[6:7]
    v_lshlrev_b32 v6, 16, v102
    v_and_b32 v7, 0xffff0000, v102
    v_pk_add_f32 v[20:21], v[20:21], v[6:7]
    v_lshlrev_b32 v6, 16, v103
    v_and_b32 v7, 0xffff0000, v103
    v_pk_add_f32 v[22:23], v[22:23], v[6:7]
    v_lshlrev_b32 v6, 16, v104
    v_and_b32 v7, 0xffff0000, v104
    v_pk_add_f32 v[8:9], v[8:9], v[6:7]
    v_lshlrev_b32 v6, 16, v105
    v_and_b32 v7, 0xffff0000, v105
    v_pk_add_f32 v[10:11], v[10:11], v[6:7]
    v_lshlrev_b32 v6, 16, v106
    v_and_b32 v7, 0xffff0000, v106
    v_pk_add_f32 v[16:17], v[16:17], v[6:7]
    v_lshlrev_b32 v6, 16, v107
    v_and_b32 v7, 0xffff0000, v107
    v_pk_add_f32 v[18:19], v[18:19], v[6:7]
    v_lshlrev_b32 v6, 16, v108
    v_and_b32 v7, 0xffff0000, v108
    v_pk_add_f32 v[12:13], v[12:13], v[6:7]
    v_lshlrev_b32 v6, 16, v109
    v_and_b32 v7, 0xffff0000, v109
    v_pk_add_f32 v[14:15], v[14:15], v[6:7]
    v_lshlrev_b32 v6, 16, v110
    v_and_b32 v7, 0xffff0000, v110
    v_pk_add_f32 v[20:21], v[20:21], v[6:7]
    v_lshlrev_b32 v6, 16, v111
    v_and_b32 v7, 0xffff0000, v111
    v_pk_add_f32 v[22:23], v[22:23], v[6:7]
    v_lshlrev_b32 v6, 16, v112
    v_and_b32 v7, 0xffff0000, v112
    v_pk_add_f32 v[8:9], v[8:9], v[6:7]
    v_lshlrev_b32 v6, 16, v113
    v_and_b32 v7, 0xffff0000, v113
    v_pk_add_f32 v[10:11], v[10:11], v[6:7]
    v_lshlrev_b32 v6, 16, v114
    v_and_b32 v7, 0xffff0000, v114
    v_pk_add_f32 v[16:17], v[16:17], v[6:7]
    v_lshlrev_b32 v6, 16, v115
    v_and_b32 v7, 0xffff0000, v115
    v_pk_add_f32 v[18:19], v[18:19], v[6:7]
    v_lshlrev_b32 v6, 16, v116
    v_and_b32 v7, 0xffff0000, v116
    v_pk_add_f32 v[12:13], v[12:13], v[6:7]
    v_lshlrev_b32 v6, 16, v117
    v_and_b32 v7, 0xffff0000, v117
    v_pk_add_f32 v[14:15], v[14:15], v[6:7]
    v_lshlrev_b32 v6, 16, v118
    v_and_b32 v7, 0xffff0000, v118
    v_pk_add_f32 v[20:21], v[20:21], v[6:7]
    v_lshlrev_b32 v6, 16, v119
    v_and_b32 v7, 0xffff0000, v119
    v_pk_add_f32 v[22:23], v[22:23], v[6:7]
    v_lshlrev_b32 v6, 16, v120
    v_and_b32 v7, 0xffff0000, v120
    v_pk_add_f32 v[8:9], v[8:9], v[6:7]
    v_lshlrev_b32 v6, 16, v121
    v_and_b32 v7, 0xffff0000, v121
    v_pk_add_f32 v[10:11], v[10:11], v[6:7]
    v_lshlrev_b32 v6, 16, v122
    v_and_b32 v7, 0xffff0000, v122
    v_pk_add_f32 v[16:17], v[16:17], v[6:7]
    v_lshlrev_b32 v6, 16, v123
    v_and_b32 v7, 0xffff0000, v123
    v_pk_add_f32 v[18:19], v[18:19], v[6:7]
    v_lshlrev_b32 v6, 16, v124
    v_and_b32 v7, 0xffff0000, v124
    v_pk_add_f32 v[12:13], v[12:13], v[6:7]
    v_lshlrev_b32 v6, 16, v125
    v_and_b32 v7, 0xffff0000, v125
    v_pk_add_f32 v[14:15], v[14:15], v[6:7]
    v_lshlrev_b32 v6, 16, v126
    v_and_b32 v7, 0xffff0000, v126
    v_pk_add_f32 v[20:21], v[20:21], v[6:7]
    v_lshlrev_b32 v6, 16, v127
    v_and_b32 v7, 0xffff0000, v127
    v_pk_add_f32 v[22:23], v[22:23], v[6:7]
    v_cvt_pk_bf16_f32 v32, v8, v9
    v_cvt_pk_bf16_f32 v33, v10, v11
    v_cvt_pk_bf16_f32 v34, v12, v13
    v_cvt_pk_bf16_f32 v35, v14, v15
    v_cvt_pk_bf16_f32 v36, v16, v17
    v_cvt_pk_bf16_f32 v37, v18, v19
    v_cvt_pk_bf16_f32 v38, v20, v21
    v_cvt_pk_bf16_f32 v39, v22, v23
    s_add_u32 s24, s41, 0
    v_permlane32_swap_b32 v32, v34
    v_permlane32_swap_b32 v33, v35
    buffer_store_dwordx4 v[32:35], v5, s[44:47], s24 offen offset:64
    v_permlane32_swap_b32 v36, v38
    v_permlane32_swap_b32 v37, v39
    buffer_store_dwordx4 v[36:39], v5, s[44:47], s24 offen offset:96
    s_add_u32 s25, s37, 196608
    buffer_load_dwordx4 v[88:91], v1, s[4:7], s25 offen offset:0 sc1
    buffer_load_dwordx4 v[92:95], v1, s[4:7], s25 offen offset:1024 sc1
    s_add_u32 s25, s37, 4390912
    buffer_load_dwordx4 v[96:99], v1, s[4:7], s25 offen offset:0 sc1
    buffer_load_dwordx4 v[100:103], v1, s[4:7], s25 offen offset:1024 sc1
    s_add_u32 s25, s37, 8585216
    buffer_load_dwordx4 v[104:107], v1, s[4:7], s25 offen offset:0 sc1
    buffer_load_dwordx4 v[108:111], v1, s[4:7], s25 offen offset:1024 sc1
    s_add_u32 s25, s37, 12779520
    buffer_load_dwordx4 v[112:115], v1, s[4:7], s25 offen offset:0 sc1
    buffer_load_dwordx4 v[116:119], v1, s[4:7], s25 offen offset:1024 sc1
    s_add_u32 s25, s37, 21168128
    buffer_load_dwordx4 v[120:123], v1, s[4:7], s25 offen offset:0 sc1
    buffer_load_dwordx4 v[124:127], v1, s[4:7], s25 offen offset:1024 sc1
    s_waitcnt vmcnt(40)
    v_lshlrev_b32 v8, 16, v128
    v_and_b32 v9, 0xffff0000, v128
    v_lshlrev_b32 v10, 16, v129
    v_and_b32 v11, 0xffff0000, v129
    v_lshlrev_b32 v16, 16, v130
    v_and_b32 v17, 0xffff0000, v130
    v_lshlrev_b32 v18, 16, v131
    v_and_b32 v19, 0xffff0000, v131
    v_lshlrev_b32 v12, 16, v132
    v_and_b32 v13, 0xffff0000, v132
    v_lshlrev_b32 v14, 16, v133
    v_and_b32 v15, 0xffff0000, v133
    v_lshlrev_b32 v20, 16, v134
    v_and_b32 v21, 0xffff0000, v134
    v_lshlrev_b32 v22, 16, v135
    v_and_b32 v23, 0xffff0000, v135
    v_lshlrev_b32 v6, 16, v136
    v_and_b32 v7, 0xffff0000, v136
    v_pk_add_f32 v[8:9], v[8:9], v[6:7]
    v_lshlrev_b32 v6, 16, v137
    v_and_b32 v7, 0xffff0000, v137
    v_pk_add_f32 v[10:11], v[10:11], v[6:7]
    v_lshlrev_b32 v6, 16, v138
    v_and_b32 v7, 0xffff0000, v138
    v_pk_add_f32 v[16:17], v[16:17], v[6:7]
    v_lshlrev_b32 v6, 16, v139
    v_and_b32 v7, 0xffff0000, v139
    v_pk_add_f32 v[18:19], v[18:19], v[6:7]
    v_lshlrev_b32 v6, 16, v140
    v_and_b32 v7, 0xffff0000, v140
    v_pk_add_f32 v[12:13], v[12:13], v[6:7]
    v_lshlrev_b32 v6, 16, v141
    v_and_b32 v7, 0xffff0000, v141
    v_pk_add_f32 v[14:15], v[14:15], v[6:7]
    v_lshlrev_b32 v6, 16, v142
    v_and_b32 v7, 0xffff0000, v142
    v_pk_add_f32 v[20:21], v[20:21], v[6:7]
    v_lshlrev_b32 v6, 16, v143
    v_and_b32 v7, 0xffff0000, v143
    v_pk_add_f32 v[22:23], v[22:23], v[6:7]
    v_lshlrev_b32 v6, 16, v144
    v_and_b32 v7, 0xffff0000, v144
    v_pk_add_f32 v[8:9], v[8:9], v[6:7]
    v_lshlrev_b32 v6, 16, v145
    v_and_b32 v7, 0xffff0000, v145
    v_pk_add_f32 v[10:11], v[10:11], v[6:7]
    v_lshlrev_b32 v6, 16, v146
    v_and_b32 v7, 0xffff0000, v146
    v_pk_add_f32 v[16:17], v[16:17], v[6:7]
    v_lshlrev_b32 v6, 16, v147
    v_and_b32 v7, 0xffff0000, v147
    v_pk_add_f32 v[18:19], v[18:19], v[6:7]
    v_lshlrev_b32 v6, 16, v148
    v_and_b32 v7, 0xffff0000, v148
    v_pk_add_f32 v[12:13], v[12:13], v[6:7]
    v_lshlrev_b32 v6, 16, v149
    v_and_b32 v7, 0xffff0000, v149
    v_pk_add_f32 v[14:15], v[14:15], v[6:7]
    v_lshlrev_b32 v6, 16, v150
    v_and_b32 v7, 0xffff0000, v150
    v_pk_add_f32 v[20:21], v[20:21], v[6:7]
    v_lshlrev_b32 v6, 16, v151
    v_and_b32 v7, 0xffff0000, v151
    v_pk_add_f32 v[22:23], v[22:23], v[6:7]
    v_lshlrev_b32 v6, 16, v152
    v_and_b32 v7, 0xffff0000, v152
    v_pk_add_f32 v[8:9], v[8:9], v[6:7]
    v_lshlrev_b32 v6, 16, v153
    v_and_b32 v7, 0xffff0000, v153
    v_pk_add_f32 v[10:11], v[10:11], v[6:7]
    v_lshlrev_b32 v6, 16, v154
    v_and_b32 v7, 0xffff0000, v154
    v_pk_add_f32 v[16:17], v[16:17], v[6:7]
    v_lshlrev_b32 v6, 16, v155
    v_and_b32 v7, 0xffff0000, v155
    v_pk_add_f32 v[18:19], v[18:19], v[6:7]
    v_lshlrev_b32 v6, 16, v156
    v_and_b32 v7, 0xffff0000, v156
    v_pk_add_f32 v[12:13], v[12:13], v[6:7]
    v_lshlrev_b32 v6, 16, v157
    v_and_b32 v7, 0xffff0000, v157
    v_pk_add_f32 v[14:15], v[14:15], v[6:7]
    v_lshlrev_b32 v6, 16, v158
    v_and_b32 v7, 0xffff0000, v158
    v_pk_add_f32 v[20:21], v[20:21], v[6:7]
    v_lshlrev_b32 v6, 16, v159
    v_and_b32 v7, 0xffff0000, v159
    v_pk_add_f32 v[22:23], v[22:23], v[6:7]
    v_lshlrev_b32 v6, 16, v160
    v_and_b32 v7, 0xffff0000, v160
    v_pk_add_f32 v[8:9], v[8:9], v[6:7]
    v_lshlrev_b32 v6, 16, v161
    v_and_b32 v7, 0xffff0000, v161
    v_pk_add_f32 v[10:11], v[10:11], v[6:7]
    v_lshlrev_b32 v6, 16, v162
    v_and_b32 v7, 0xffff0000, v162
    v_pk_add_f32 v[16:17], v[16:17], v[6:7]
    v_lshlrev_b32 v6, 16, v163
    v_and_b32 v7, 0xffff0000, v163
    v_pk_add_f32 v[18:19], v[18:19], v[6:7]
    v_lshlrev_b32 v6, 16, v164
    v_and_b32 v7, 0xffff0000, v164
    v_pk_add_f32 v[12:13], v[12:13], v[6:7]
    v_lshlrev_b32 v6, 16, v165
    v_and_b32 v7, 0xffff0000, v165
    v_pk_add_f32 v[14:15], v[14:15], v[6:7]
    v_lshlrev_b32 v6, 16, v166
    v_and_b32 v7, 0xffff0000, v166
    v_pk_add_f32 v[20:21], v[20:21], v[6:7]
    v_lshlrev_b32 v6, 16, v167
    v_and_b32 v7, 0xffff0000, v167
    v_pk_add_f32 v[22:23], v[22:23], v[6:7]
    v_cvt_pk_bf16_f32 v24, v8, v9
    v_cvt_pk_bf16_f32 v25, v10, v11
    v_cvt_pk_bf16_f32 v26, v12, v13
    v_cvt_pk_bf16_f32 v27, v14, v15
    v_cvt_pk_bf16_f32 v28, v16, v17
    v_cvt_pk_bf16_f32 v29, v18, v19
    v_cvt_pk_bf16_f32 v30, v20, v21
    v_cvt_pk_bf16_f32 v31, v22, v23
    s_add_u32 s24, s41, 65536
    v_permlane32_swap_b32 v24, v26
    v_permlane32_swap_b32 v25, v27
    buffer_store_dwordx4 v[24:27], v5, s[44:47], s24 offen offset:0
    v_permlane32_swap_b32 v28, v30
    v_permlane32_swap_b32 v29, v31
    buffer_store_dwordx4 v[28:31], v5, s[44:47], s24 offen offset:32
    s_add_u32 s25, s37, 198656
    buffer_load_dwordx4 v[128:131], v1, s[4:7], s25 offen offset:0 sc1
    buffer_load_dwordx4 v[132:135], v1, s[4:7], s25 offen offset:1024 sc1
    s_add_u32 s25, s37, 4392960
    buffer_load_dwordx4 v[136:139], v1, s[4:7], s25 offen offset:0 sc1
    buffer_load_dwordx4 v[140:143], v1, s[4:7], s25 offen offset:1024 sc1
    s_add_u32 s25, s37, 8587264
    buffer_load_dwordx4 v[144:147], v1, s[4:7], s25 offen offset:0 sc1
    buffer_load_dwordx4 v[148:151], v1, s[4:7], s25 offen offset:1024 sc1
    s_add_u32 s25, s37, 12781568
    buffer_load_dwordx4 v[152:155], v1, s[4:7], s25 offen offset:0 sc1
    buffer_load_dwordx4 v[156:159], v1, s[4:7], s25 offen offset:1024 sc1
    s_add_u32 s25, s37, 21170176
    buffer_load_dwordx4 v[160:163], v1, s[4:7], s25 offen offset:0 sc1
    buffer_load_dwordx4 v[164:167], v1, s[4:7], s25 offen offset:1024 sc1
    s_waitcnt vmcnt(40)
    v_lshlrev_b32 v8, 16, v168
    v_and_b32 v9, 0xffff0000, v168
    v_lshlrev_b32 v10, 16, v169
    v_and_b32 v11, 0xffff0000, v169
    v_lshlrev_b32 v16, 16, v170
    v_and_b32 v17, 0xffff0000, v170
    v_lshlrev_b32 v18, 16, v171
    v_and_b32 v19, 0xffff0000, v171
    v_lshlrev_b32 v12, 16, v172
    v_and_b32 v13, 0xffff0000, v172
    v_lshlrev_b32 v14, 16, v173
    v_and_b32 v15, 0xffff0000, v173
    v_lshlrev_b32 v20, 16, v174
    v_and_b32 v21, 0xffff0000, v174
    v_lshlrev_b32 v22, 16, v175
    v_and_b32 v23, 0xffff0000, v175
    v_lshlrev_b32 v6, 16, v176
    v_and_b32 v7, 0xffff0000, v176
    v_pk_add_f32 v[8:9], v[8:9], v[6:7]
    v_lshlrev_b32 v6, 16, v177
    v_and_b32 v7, 0xffff0000, v177
    v_pk_add_f32 v[10:11], v[10:11], v[6:7]
    v_lshlrev_b32 v6, 16, v178
    v_and_b32 v7, 0xffff0000, v178
    v_pk_add_f32 v[16:17], v[16:17], v[6:7]
    v_lshlrev_b32 v6, 16, v179
    v_and_b32 v7, 0xffff0000, v179
    v_pk_add_f32 v[18:19], v[18:19], v[6:7]
    v_lshlrev_b32 v6, 16, v180
    v_and_b32 v7, 0xffff0000, v180
    v_pk_add_f32 v[12:13], v[12:13], v[6:7]
    v_lshlrev_b32 v6, 16, v181
    v_and_b32 v7, 0xffff0000, v181
    v_pk_add_f32 v[14:15], v[14:15], v[6:7]
    v_lshlrev_b32 v6, 16, v182
    v_and_b32 v7, 0xffff0000, v182
    v_pk_add_f32 v[20:21], v[20:21], v[6:7]
    v_lshlrev_b32 v6, 16, v183
    v_and_b32 v7, 0xffff0000, v183
    v_pk_add_f32 v[22:23], v[22:23], v[6:7]
    v_lshlrev_b32 v6, 16, v184
    v_and_b32 v7, 0xffff0000, v184
    v_pk_add_f32 v[8:9], v[8:9], v[6:7]
    v_lshlrev_b32 v6, 16, v185
    v_and_b32 v7, 0xffff0000, v185
    v_pk_add_f32 v[10:11], v[10:11], v[6:7]
    v_lshlrev_b32 v6, 16, v186
    v_and_b32 v7, 0xffff0000, v186
    v_pk_add_f32 v[16:17], v[16:17], v[6:7]
    v_lshlrev_b32 v6, 16, v187
    v_and_b32 v7, 0xffff0000, v187
    v_pk_add_f32 v[18:19], v[18:19], v[6:7]
    v_lshlrev_b32 v6, 16, v188
    v_and_b32 v7, 0xffff0000, v188
    v_pk_add_f32 v[12:13], v[12:13], v[6:7]
    v_lshlrev_b32 v6, 16, v189
    v_and_b32 v7, 0xffff0000, v189
    v_pk_add_f32 v[14:15], v[14:15], v[6:7]
    v_lshlrev_b32 v6, 16, v190
    v_and_b32 v7, 0xffff0000, v190
    v_pk_add_f32 v[20:21], v[20:21], v[6:7]
    v_lshlrev_b32 v6, 16, v191
    v_and_b32 v7, 0xffff0000, v191
    v_pk_add_f32 v[22:23], v[22:23], v[6:7]
    v_lshlrev_b32 v6, 16, v192
    v_and_b32 v7, 0xffff0000, v192
    v_pk_add_f32 v[8:9], v[8:9], v[6:7]
    v_lshlrev_b32 v6, 16, v193
    v_and_b32 v7, 0xffff0000, v193
    v_pk_add_f32 v[10:11], v[10:11], v[6:7]
    v_lshlrev_b32 v6, 16, v194
    v_and_b32 v7, 0xffff0000, v194
    v_pk_add_f32 v[16:17], v[16:17], v[6:7]
    v_lshlrev_b32 v6, 16, v195
    v_and_b32 v7, 0xffff0000, v195
    v_pk_add_f32 v[18:19], v[18:19], v[6:7]
    v_lshlrev_b32 v6, 16, v196
    v_and_b32 v7, 0xffff0000, v196
    v_pk_add_f32 v[12:13], v[12:13], v[6:7]
    v_lshlrev_b32 v6, 16, v197
    v_and_b32 v7, 0xffff0000, v197
    v_pk_add_f32 v[14:15], v[14:15], v[6:7]
    v_lshlrev_b32 v6, 16, v198
    v_and_b32 v7, 0xffff0000, v198
    v_pk_add_f32 v[20:21], v[20:21], v[6:7]
    v_lshlrev_b32 v6, 16, v199
    v_and_b32 v7, 0xffff0000, v199
    v_pk_add_f32 v[22:23], v[22:23], v[6:7]
    v_lshlrev_b32 v6, 16, v200
    v_and_b32 v7, 0xffff0000, v200
    v_pk_add_f32 v[8:9], v[8:9], v[6:7]
    v_lshlrev_b32 v6, 16, v201
    v_and_b32 v7, 0xffff0000, v201
    v_pk_add_f32 v[10:11], v[10:11], v[6:7]
    v_lshlrev_b32 v6, 16, v202
    v_and_b32 v7, 0xffff0000, v202
    v_pk_add_f32 v[16:17], v[16:17], v[6:7]
    v_lshlrev_b32 v6, 16, v203
    v_and_b32 v7, 0xffff0000, v203
    v_pk_add_f32 v[18:19], v[18:19], v[6:7]
    v_lshlrev_b32 v6, 16, v204
    v_and_b32 v7, 0xffff0000, v204
    v_pk_add_f32 v[12:13], v[12:13], v[6:7]
    v_lshlrev_b32 v6, 16, v205
    v_and_b32 v7, 0xffff0000, v205
    v_pk_add_f32 v[14:15], v[14:15], v[6:7]
    v_lshlrev_b32 v6, 16, v206
    v_and_b32 v7, 0xffff0000, v206
    v_pk_add_f32 v[20:21], v[20:21], v[6:7]
    v_lshlrev_b32 v6, 16, v207
    v_and_b32 v7, 0xffff0000, v207
    v_pk_add_f32 v[22:23], v[22:23], v[6:7]
    v_cvt_pk_bf16_f32 v32, v8, v9
    v_cvt_pk_bf16_f32 v33, v10, v11
    v_cvt_pk_bf16_f32 v34, v12, v13
    v_cvt_pk_bf16_f32 v35, v14, v15
    v_cvt_pk_bf16_f32 v36, v16, v17
    v_cvt_pk_bf16_f32 v37, v18, v19
    v_cvt_pk_bf16_f32 v38, v20, v21
    v_cvt_pk_bf16_f32 v39, v22, v23
    s_add_u32 s24, s41, 65536
    v_permlane32_swap_b32 v32, v34
    v_permlane32_swap_b32 v33, v35
    buffer_store_dwordx4 v[32:35], v5, s[44:47], s24 offen offset:64
    v_permlane32_swap_b32 v36, v38
    v_permlane32_swap_b32 v37, v39
    buffer_store_dwordx4 v[36:39], v5, s[44:47], s24 offen offset:96
    s_waitcnt vmcnt(30)
    v_lshlrev_b32 v8, 16, v208
    v_and_b32 v9, 0xffff0000, v208
    v_lshlrev_b32 v10, 16, v209
    v_and_b32 v11, 0xffff0000, v209
    v_lshlrev_b32 v16, 16, v210
    v_and_b32 v17, 0xffff0000, v210
    v_lshlrev_b32 v18, 16, v211
    v_and_b32 v19, 0xffff0000, v211
    v_lshlrev_b32 v12, 16, v212
    v_and_b32 v13, 0xffff0000, v212
    v_lshlrev_b32 v14, 16, v213
    v_and_b32 v15, 0xffff0000, v213
    v_lshlrev_b32 v20, 16, v214
    v_and_b32 v21, 0xffff0000, v214
    v_lshlrev_b32 v22, 16, v215
    v_and_b32 v23, 0xffff0000, v215
    v_lshlrev_b32 v6, 16, v216
    v_and_b32 v7, 0xffff0000, v216
    v_pk_add_f32 v[8:9], v[8:9], v[6:7]
    v_lshlrev_b32 v6, 16, v217
    v_and_b32 v7, 0xffff0000, v217
    v_pk_add_f32 v[10:11], v[10:11], v[6:7]
    v_lshlrev_b32 v6, 16, v218
    v_and_b32 v7, 0xffff0000, v218
    v_pk_add_f32 v[16:17], v[16:17], v[6:7]
    v_lshlrev_b32 v6, 16, v219
    v_and_b32 v7, 0xffff0000, v219
    v_pk_add_f32 v[18:19], v[18:19], v[6:7]
    v_lshlrev_b32 v6, 16, v220
    v_and_b32 v7, 0xffff0000, v220
    v_pk_add_f32 v[12:13], v[12:13], v[6:7]
    v_lshlrev_b32 v6, 16, v221
    v_and_b32 v7, 0xffff0000, v221
    v_pk_add_f32 v[14:15], v[14:15], v[6:7]
    v_lshlrev_b32 v6, 16, v222
    v_and_b32 v7, 0xffff0000, v222
    v_pk_add_f32 v[20:21], v[20:21], v[6:7]
    v_lshlrev_b32 v6, 16, v223
    v_and_b32 v7, 0xffff0000, v223
    v_pk_add_f32 v[22:23], v[22:23], v[6:7]
    v_lshlrev_b32 v6, 16, v224
    v_and_b32 v7, 0xffff0000, v224
    v_pk_add_f32 v[8:9], v[8:9], v[6:7]
    v_lshlrev_b32 v6, 16, v225
    v_and_b32 v7, 0xffff0000, v225
    v_pk_add_f32 v[10:11], v[10:11], v[6:7]
    v_lshlrev_b32 v6, 16, v226
    v_and_b32 v7, 0xffff0000, v226
    v_pk_add_f32 v[16:17], v[16:17], v[6:7]
    v_lshlrev_b32 v6, 16, v227
    v_and_b32 v7, 0xffff0000, v227
    v_pk_add_f32 v[18:19], v[18:19], v[6:7]
    v_lshlrev_b32 v6, 16, v228
    v_and_b32 v7, 0xffff0000, v228
    v_pk_add_f32 v[12:13], v[12:13], v[6:7]
    v_lshlrev_b32 v6, 16, v229
    v_and_b32 v7, 0xffff0000, v229
    v_pk_add_f32 v[14:15], v[14:15], v[6:7]
    v_lshlrev_b32 v6, 16, v230
    v_and_b32 v7, 0xffff0000, v230
    v_pk_add_f32 v[20:21], v[20:21], v[6:7]
    v_lshlrev_b32 v6, 16, v231
    v_and_b32 v7, 0xffff0000, v231
    v_pk_add_f32 v[22:23], v[22:23], v[6:7]
    v_lshlrev_b32 v6, 16, v232
    v_and_b32 v7, 0xffff0000, v232
    v_pk_add_f32 v[8:9], v[8:9], v[6:7]
    v_lshlrev_b32 v6, 16, v233
    v_and_b32 v7, 0xffff0000, v233
    v_pk_add_f32 v[10:11], v[10:11], v[6:7]
    v_lshlrev_b32 v6, 16, v234
    v_and_b32 v7, 0xffff0000, v234
    v_pk_add_f32 v[16:17], v[16:17], v[6:7]
    v_lshlrev_b32 v6, 16, v235
    v_and_b32 v7, 0xffff0000, v235
    v_pk_add_f32 v[18:19], v[18:19], v[6:7]
    v_lshlrev_b32 v6, 16, v236
    v_and_b32 v7, 0xffff0000, v236
    v_pk_add_f32 v[12:13], v[12:13], v[6:7]
    v_lshlrev_b32 v6, 16, v237
    v_and_b32 v7, 0xffff0000, v237
    v_pk_add_f32 v[14:15], v[14:15], v[6:7]
    v_lshlrev_b32 v6, 16, v238
    v_and_b32 v7, 0xffff0000, v238
    v_pk_add_f32 v[20:21], v[20:21], v[6:7]
    v_lshlrev_b32 v6, 16, v239
    v_and_b32 v7, 0xffff0000, v239
    v_pk_add_f32 v[22:23], v[22:23], v[6:7]
    v_lshlrev_b32 v6, 16, v240
    v_and_b32 v7, 0xffff0000, v240
    v_pk_add_f32 v[8:9], v[8:9], v[6:7]
    v_lshlrev_b32 v6, 16, v241
    v_and_b32 v7, 0xffff0000, v241
    v_pk_add_f32 v[10:11], v[10:11], v[6:7]
    v_lshlrev_b32 v6, 16, v242
    v_and_b32 v7, 0xffff0000, v242
    v_pk_add_f32 v[16:17], v[16:17], v[6:7]
    v_lshlrev_b32 v6, 16, v243
    v_and_b32 v7, 0xffff0000, v243
    v_pk_add_f32 v[18:19], v[18:19], v[6:7]
    v_lshlrev_b32 v6, 16, v244
    v_and_b32 v7, 0xffff0000, v244
    v_pk_add_f32 v[12:13], v[12:13], v[6:7]
    v_lshlrev_b32 v6, 16, v245
    v_and_b32 v7, 0xffff0000, v245
    v_pk_add_f32 v[14:15], v[14:15], v[6:7]
    v_lshlrev_b32 v6, 16, v246
    v_and_b32 v7, 0xffff0000, v246
    v_pk_add_f32 v[20:21], v[20:21], v[6:7]
    v_lshlrev_b32 v6, 16, v247
    v_and_b32 v7, 0xffff0000, v247
    v_pk_add_f32 v[22:23], v[22:23], v[6:7]
    v_cvt_pk_bf16_f32 v24, v8, v9
    v_cvt_pk_bf16_f32 v25, v10, v11
    v_cvt_pk_bf16_f32 v26, v12, v13
    v_cvt_pk_bf16_f32 v27, v14, v15
    v_cvt_pk_bf16_f32 v28, v16, v17
    v_cvt_pk_bf16_f32 v29, v18, v19
    v_cvt_pk_bf16_f32 v30, v20, v21
    v_cvt_pk_bf16_f32 v31, v22, v23
    s_add_u32 s24, s41, 131072
    v_permlane32_swap_b32 v24, v26
    v_permlane32_swap_b32 v25, v27
    buffer_store_dwordx4 v[24:27], v5, s[44:47], s24 offen offset:0
    v_permlane32_swap_b32 v28, v30
    v_permlane32_swap_b32 v29, v31
    buffer_store_dwordx4 v[28:31], v5, s[44:47], s24 offen offset:32
    s_waitcnt vmcnt(20)
    v_lshlrev_b32 v8, 16, v48
    v_and_b32 v9, 0xffff0000, v48
    v_lshlrev_b32 v10, 16, v49
    v_and_b32 v11, 0xffff0000, v49
    v_lshlrev_b32 v16, 16, v50
    v_and_b32 v17, 0xffff0000, v50
    v_lshlrev_b32 v18, 16, v51
    v_and_b32 v19, 0xffff0000, v51
    v_lshlrev_b32 v12, 16, v52
    v_and_b32 v13, 0xffff0000, v52
    v_lshlrev_b32 v14, 16, v53
    v_and_b32 v15, 0xffff0000, v53
    v_lshlrev_b32 v20, 16, v54
    v_and_b32 v21, 0xffff0000, v54
    v_lshlrev_b32 v22, 16, v55
    v_and_b32 v23, 0xffff0000, v55
    v_lshlrev_b32 v6, 16, v56
    v_and_b32 v7, 0xffff0000, v56
    v_pk_add_f32 v[8:9], v[8:9], v[6:7]
    v_lshlrev_b32 v6, 16, v57
    v_and_b32 v7, 0xffff0000, v57
    v_pk_add_f32 v[10:11], v[10:11], v[6:7]
    v_lshlrev_b32 v6, 16, v58
    v_and_b32 v7, 0xffff0000, v58
    v_pk_add_f32 v[16:17], v[16:17], v[6:7]
    v_lshlrev_b32 v6, 16, v59
    v_and_b32 v7, 0xffff0000, v59
    v_pk_add_f32 v[18:19], v[18:19], v[6:7]
    v_lshlrev_b32 v6, 16, v60
    v_and_b32 v7, 0xffff0000, v60
    v_pk_add_f32 v[12:13], v[12:13], v[6:7]
    v_lshlrev_b32 v6, 16, v61
    v_and_b32 v7, 0xffff0000, v61
    v_pk_add_f32 v[14:15], v[14:15], v[6:7]
    v_lshlrev_b32 v6, 16, v62
    v_and_b32 v7, 0xffff0000, v62
    v_pk_add_f32 v[20:21], v[20:21], v[6:7]
    v_lshlrev_b32 v6, 16, v63
    v_and_b32 v7, 0xffff0000, v63
    v_pk_add_f32 v[22:23], v[22:23], v[6:7]
    v_lshlrev_b32 v6, 16, v64
    v_and_b32 v7, 0xffff0000, v64
    v_pk_add_f32 v[8:9], v[8:9], v[6:7]
    v_lshlrev_b32 v6, 16, v65
    v_and_b32 v7, 0xffff0000, v65
    v_pk_add_f32 v[10:11], v[10:11], v[6:7]
    v_lshlrev_b32 v6, 16, v66
    v_and_b32 v7, 0xffff0000, v66
    v_pk_add_f32 v[16:17], v[16:17], v[6:7]
    v_lshlrev_b32 v6, 16, v67
    v_and_b32 v7, 0xffff0000, v67
    v_pk_add_f32 v[18:19], v[18:19], v[6:7]
    v_lshlrev_b32 v6, 16, v68
    v_and_b32 v7, 0xffff0000, v68
    v_pk_add_f32 v[12:13], v[12:13], v[6:7]
    v_lshlrev_b32 v6, 16, v69
    v_and_b32 v7, 0xffff0000, v69
    v_pk_add_f32 v[14:15], v[14:15], v[6:7]
    v_lshlrev_b32 v6, 16, v70
    v_and_b32 v7, 0xffff0000, v70
    v_pk_add_f32 v[20:21], v[20:21], v[6:7]
    v_lshlrev_b32 v6, 16, v71
    v_and_b32 v7, 0xffff0000, v71
    v_pk_add_f32 v[22:23], v[22:23], v[6:7]
    v_lshlrev_b32 v6, 16, v72
    v_and_b32 v7, 0xffff0000, v72
    v_pk_add_f32 v[8:9], v[8:9], v[6:7]
    v_lshlrev_b32 v6, 16, v73
    v_and_b32 v7, 0xffff0000, v73
    v_pk_add_f32 v[10:11], v[10:11], v[6:7]
    v_lshlrev_b32 v6, 16, v74
    v_and_b32 v7, 0xffff0000, v74
    v_pk_add_f32 v[16:17], v[16:17], v[6:7]
    v_lshlrev_b32 v6, 16, v75
    v_and_b32 v7, 0xffff0000, v75
    v_pk_add_f32 v[18:19], v[18:19], v[6:7]
    v_lshlrev_b32 v6, 16, v76
    v_and_b32 v7, 0xffff0000, v76
    v_pk_add_f32 v[12:13], v[12:13], v[6:7]
    v_lshlrev_b32 v6, 16, v77
    v_and_b32 v7, 0xffff0000, v77
    v_pk_add_f32 v[14:15], v[14:15], v[6:7]
    v_lshlrev_b32 v6, 16, v78
    v_and_b32 v7, 0xffff0000, v78
    v_pk_add_f32 v[20:21], v[20:21], v[6:7]
    v_lshlrev_b32 v6, 16, v79
    v_and_b32 v7, 0xffff0000, v79
    v_pk_add_f32 v[22:23], v[22:23], v[6:7]
    v_lshlrev_b32 v6, 16, v80
    v_and_b32 v7, 0xffff0000, v80
    v_pk_add_f32 v[8:9], v[8:9], v[6:7]
    v_lshlrev_b32 v6, 16, v81
    v_and_b32 v7, 0xffff0000, v81
    v_pk_add_f32 v[10:11], v[10:11], v[6:7]
    v_lshlrev_b32 v6, 16, v82
    v_and_b32 v7, 0xffff0000, v82
    v_pk_add_f32 v[16:17], v[16:17], v[6:7]
    v_lshlrev_b32 v6, 16, v83
    v_and_b32 v7, 0xffff0000, v83
    v_pk_add_f32 v[18:19], v[18:19], v[6:7]
    v_lshlrev_b32 v6, 16, v84
    v_and_b32 v7, 0xffff0000, v84
    v_pk_add_f32 v[12:13], v[12:13], v[6:7]
    v_lshlrev_b32 v6, 16, v85
    v_and_b32 v7, 0xffff0000, v85
    v_pk_add_f32 v[14:15], v[14:15], v[6:7]
    v_lshlrev_b32 v6, 16, v86
    v_and_b32 v7, 0xffff0000, v86
    v_pk_add_f32 v[20:21], v[20:21], v[6:7]
    v_lshlrev_b32 v6, 16, v87
    v_and_b32 v7, 0xffff0000, v87
    v_pk_add_f32 v[22:23], v[22:23], v[6:7]
    v_cvt_pk_bf16_f32 v32, v8, v9
    v_cvt_pk_bf16_f32 v33, v10, v11
    v_cvt_pk_bf16_f32 v34, v12, v13
    v_cvt_pk_bf16_f32 v35, v14, v15
    v_cvt_pk_bf16_f32 v36, v16, v17
    v_cvt_pk_bf16_f32 v37, v18, v19
    v_cvt_pk_bf16_f32 v38, v20, v21
    v_cvt_pk_bf16_f32 v39, v22, v23
    s_add_u32 s24, s41, 131072
    v_permlane32_swap_b32 v32, v34
    v_permlane32_swap_b32 v33, v35
    buffer_store_dwordx4 v[32:35], v5, s[44:47], s24 offen offset:64
    v_permlane32_swap_b32 v36, v38
    v_permlane32_swap_b32 v37, v39
    buffer_store_dwordx4 v[36:39], v5, s[44:47], s24 offen offset:96
    s_waitcnt vmcnt(10)
    v_lshlrev_b32 v8, 16, v88
    v_and_b32 v9, 0xffff0000, v88
    v_lshlrev_b32 v10, 16, v89
    v_and_b32 v11, 0xffff0000, v89
    v_lshlrev_b32 v16, 16, v90
    v_and_b32 v17, 0xffff0000, v90
    v_lshlrev_b32 v18, 16, v91
    v_and_b32 v19, 0xffff0000, v91
    v_lshlrev_b32 v12, 16, v92
    v_and_b32 v13, 0xffff0000, v92
    v_lshlrev_b32 v14, 16, v93
    v_and_b32 v15, 0xffff0000, v93
    v_lshlrev_b32 v20, 16, v94
    v_and_b32 v21, 0xffff0000, v94
    v_lshlrev_b32 v22, 16, v95
    v_and_b32 v23, 0xffff0000, v95
    v_lshlrev_b32 v6, 16, v96
    v_and_b32 v7, 0xffff0000, v96
    v_pk_add_f32 v[8:9], v[8:9], v[6:7]
    v_lshlrev_b32 v6, 16, v97
    v_and_b32 v7, 0xffff0000, v97
    v_pk_add_f32 v[10:11], v[10:11], v[6:7]
    v_lshlrev_b32 v6, 16, v98
    v_and_b32 v7, 0xffff0000, v98
    v_pk_add_f32 v[16:17], v[16:17], v[6:7]
    v_lshlrev_b32 v6, 16, v99
    v_and_b32 v7, 0xffff0000, v99
    v_pk_add_f32 v[18:19], v[18:19], v[6:7]
    v_lshlrev_b32 v6, 16, v100
    v_and_b32 v7, 0xffff0000, v100
    v_pk_add_f32 v[12:13], v[12:13], v[6:7]
    v_lshlrev_b32 v6, 16, v101
    v_and_b32 v7, 0xffff0000, v101
    v_pk_add_f32 v[14:15], v[14:15], v[6:7]
    v_lshlrev_b32 v6, 16, v102
    v_and_b32 v7, 0xffff0000, v102
    v_pk_add_f32 v[20:21], v[20:21], v[6:7]
    v_lshlrev_b32 v6, 16, v103
    v_and_b32 v7, 0xffff0000, v103
    v_pk_add_f32 v[22:23], v[22:23], v[6:7]
    v_lshlrev_b32 v6, 16, v104
    v_and_b32 v7, 0xffff0000, v104
    v_pk_add_f32 v[8:9], v[8:9], v[6:7]
    v_lshlrev_b32 v6, 16, v105
    v_and_b32 v7, 0xffff0000, v105
    v_pk_add_f32 v[10:11], v[10:11], v[6:7]
    v_lshlrev_b32 v6, 16, v106
    v_and_b32 v7, 0xffff0000, v106
    v_pk_add_f32 v[16:17], v[16:17], v[6:7]
    v_lshlrev_b32 v6, 16, v107
    v_and_b32 v7, 0xffff0000, v107
    v_pk_add_f32 v[18:19], v[18:19], v[6:7]
    v_lshlrev_b32 v6, 16, v108
    v_and_b32 v7, 0xffff0000, v108
    v_pk_add_f32 v[12:13], v[12:13], v[6:7]
    v_lshlrev_b32 v6, 16, v109
    v_and_b32 v7, 0xffff0000, v109
    v_pk_add_f32 v[14:15], v[14:15], v[6:7]
    v_lshlrev_b32 v6, 16, v110
    v_and_b32 v7, 0xffff0000, v110
    v_pk_add_f32 v[20:21], v[20:21], v[6:7]
    v_lshlrev_b32 v6, 16, v111
    v_and_b32 v7, 0xffff0000, v111
    v_pk_add_f32 v[22:23], v[22:23], v[6:7]
    v_lshlrev_b32 v6, 16, v112
    v_and_b32 v7, 0xffff0000, v112
    v_pk_add_f32 v[8:9], v[8:9], v[6:7]
    v_lshlrev_b32 v6, 16, v113
    v_and_b32 v7, 0xffff0000, v113
    v_pk_add_f32 v[10:11], v[10:11], v[6:7]
    v_lshlrev_b32 v6, 16, v114
    v_and_b32 v7, 0xffff0000, v114
    v_pk_add_f32 v[16:17], v[16:17], v[6:7]
    v_lshlrev_b32 v6, 16, v115
    v_and_b32 v7, 0xffff0000, v115
    v_pk_add_f32 v[18:19], v[18:19], v[6:7]
    v_lshlrev_b32 v6, 16, v116
    v_and_b32 v7, 0xffff0000, v116
    v_pk_add_f32 v[12:13], v[12:13], v[6:7]
    v_lshlrev_b32 v6, 16, v117
    v_and_b32 v7, 0xffff0000, v117
    v_pk_add_f32 v[14:15], v[14:15], v[6:7]
    v_lshlrev_b32 v6, 16, v118
    v_and_b32 v7, 0xffff0000, v118
    v_pk_add_f32 v[20:21], v[20:21], v[6:7]
    v_lshlrev_b32 v6, 16, v119
    v_and_b32 v7, 0xffff0000, v119
    v_pk_add_f32 v[22:23], v[22:23], v[6:7]
    v_lshlrev_b32 v6, 16, v120
    v_and_b32 v7, 0xffff0000, v120
    v_pk_add_f32 v[8:9], v[8:9], v[6:7]
    v_lshlrev_b32 v6, 16, v121
    v_and_b32 v7, 0xffff0000, v121
    v_pk_add_f32 v[10:11], v[10:11], v[6:7]
    v_lshlrev_b32 v6, 16, v122
    v_and_b32 v7, 0xffff0000, v122
    v_pk_add_f32 v[16:17], v[16:17], v[6:7]
    v_lshlrev_b32 v6, 16, v123
    v_and_b32 v7, 0xffff0000, v123
    v_pk_add_f32 v[18:19], v[18:19], v[6:7]
    v_lshlrev_b32 v6, 16, v124
    v_and_b32 v7, 0xffff0000, v124
    v_pk_add_f32 v[12:13], v[12:13], v[6:7]
    v_lshlrev_b32 v6, 16, v125
    v_and_b32 v7, 0xffff0000, v125
    v_pk_add_f32 v[14:15], v[14:15], v[6:7]
    v_lshlrev_b32 v6, 16, v126
    v_and_b32 v7, 0xffff0000, v126
    v_pk_add_f32 v[20:21], v[20:21], v[6:7]
    v_lshlrev_b32 v6, 16, v127
    v_and_b32 v7, 0xffff0000, v127
    v_pk_add_f32 v[22:23], v[22:23], v[6:7]
    v_cvt_pk_bf16_f32 v24, v8, v9
    v_cvt_pk_bf16_f32 v25, v10, v11
    v_cvt_pk_bf16_f32 v26, v12, v13
    v_cvt_pk_bf16_f32 v27, v14, v15
    v_cvt_pk_bf16_f32 v28, v16, v17
    v_cvt_pk_bf16_f32 v29, v18, v19
    v_cvt_pk_bf16_f32 v30, v20, v21
    v_cvt_pk_bf16_f32 v31, v22, v23
    s_add_u32 s24, s41, 196608
    v_permlane32_swap_b32 v24, v26
    v_permlane32_swap_b32 v25, v27
    buffer_store_dwordx4 v[24:27], v5, s[44:47], s24 offen offset:0
    v_permlane32_swap_b32 v28, v30
    v_permlane32_swap_b32 v29, v31
    buffer_store_dwordx4 v[28:31], v5, s[44:47], s24 offen offset:32
    s_waitcnt vmcnt(0)
    v_lshlrev_b32 v8, 16, v128
    v_and_b32 v9, 0xffff0000, v128
    v_lshlrev_b32 v10, 16, v129
    v_and_b32 v11, 0xffff0000, v129
    v_lshlrev_b32 v16, 16, v130
    v_and_b32 v17, 0xffff0000, v130
    v_lshlrev_b32 v18, 16, v131
    v_and_b32 v19, 0xffff0000, v131
    v_lshlrev_b32 v12, 16, v132
    v_and_b32 v13, 0xffff0000, v132
    v_lshlrev_b32 v14, 16, v133
    v_and_b32 v15, 0xffff0000, v133
    v_lshlrev_b32 v20, 16, v134
    v_and_b32 v21, 0xffff0000, v134
    v_lshlrev_b32 v22, 16, v135
    v_and_b32 v23, 0xffff0000, v135
    v_lshlrev_b32 v6, 16, v136
    v_and_b32 v7, 0xffff0000, v136
    v_pk_add_f32 v[8:9], v[8:9], v[6:7]
    v_lshlrev_b32 v6, 16, v137
    v_and_b32 v7, 0xffff0000, v137
    v_pk_add_f32 v[10:11], v[10:11], v[6:7]
    v_lshlrev_b32 v6, 16, v138
    v_and_b32 v7, 0xffff0000, v138
    v_pk_add_f32 v[16:17], v[16:17], v[6:7]
    v_lshlrev_b32 v6, 16, v139
    v_and_b32 v7, 0xffff0000, v139
    v_pk_add_f32 v[18:19], v[18:19], v[6:7]
    v_lshlrev_b32 v6, 16, v140
    v_and_b32 v7, 0xffff0000, v140
    v_pk_add_f32 v[12:13], v[12:13], v[6:7]
    v_lshlrev_b32 v6, 16, v141
    v_and_b32 v7, 0xffff0000, v141
    v_pk_add_f32 v[14:15], v[14:15], v[6:7]
    v_lshlrev_b32 v6, 16, v142
    v_and_b32 v7, 0xffff0000, v142
    v_pk_add_f32 v[20:21], v[20:21], v[6:7]
    v_lshlrev_b32 v6, 16, v143
    v_and_b32 v7, 0xffff0000, v143
    v_pk_add_f32 v[22:23], v[22:23], v[6:7]
    v_lshlrev_b32 v6, 16, v144
    v_and_b32 v7, 0xffff0000, v144
    v_pk_add_f32 v[8:9], v[8:9], v[6:7]
    v_lshlrev_b32 v6, 16, v145
    v_and_b32 v7, 0xffff0000, v145
    v_pk_add_f32 v[10:11], v[10:11], v[6:7]
    v_lshlrev_b32 v6, 16, v146
    v_and_b32 v7, 0xffff0000, v146
    v_pk_add_f32 v[16:17], v[16:17], v[6:7]
    v_lshlrev_b32 v6, 16, v147
    v_and_b32 v7, 0xffff0000, v147
    v_pk_add_f32 v[18:19], v[18:19], v[6:7]
    v_lshlrev_b32 v6, 16, v148
    v_and_b32 v7, 0xffff0000, v148
    v_pk_add_f32 v[12:13], v[12:13], v[6:7]
    v_lshlrev_b32 v6, 16, v149
    v_and_b32 v7, 0xffff0000, v149
    v_pk_add_f32 v[14:15], v[14:15], v[6:7]
    v_lshlrev_b32 v6, 16, v150
    v_and_b32 v7, 0xffff0000, v150
    v_pk_add_f32 v[20:21], v[20:21], v[6:7]
    v_lshlrev_b32 v6, 16, v151
    v_and_b32 v7, 0xffff0000, v151
    v_pk_add_f32 v[22:23], v[22:23], v[6:7]
    v_lshlrev_b32 v6, 16, v152
    v_and_b32 v7, 0xffff0000, v152
    v_pk_add_f32 v[8:9], v[8:9], v[6:7]
    v_lshlrev_b32 v6, 16, v153
    v_and_b32 v7, 0xffff0000, v153
    v_pk_add_f32 v[10:11], v[10:11], v[6:7]
    v_lshlrev_b32 v6, 16, v154
    v_and_b32 v7, 0xffff0000, v154
    v_pk_add_f32 v[16:17], v[16:17], v[6:7]
    v_lshlrev_b32 v6, 16, v155
    v_and_b32 v7, 0xffff0000, v155
    v_pk_add_f32 v[18:19], v[18:19], v[6:7]
    v_lshlrev_b32 v6, 16, v156
    v_and_b32 v7, 0xffff0000, v156
    v_pk_add_f32 v[12:13], v[12:13], v[6:7]
    v_lshlrev_b32 v6, 16, v157
    v_and_b32 v7, 0xffff0000, v157
    v_pk_add_f32 v[14:15], v[14:15], v[6:7]
    v_lshlrev_b32 v6, 16, v158
    v_and_b32 v7, 0xffff0000, v158
    v_pk_add_f32 v[20:21], v[20:21], v[6:7]
    v_lshlrev_b32 v6, 16, v159
    v_and_b32 v7, 0xffff0000, v159
    v_pk_add_f32 v[22:23], v[22:23], v[6:7]
    v_lshlrev_b32 v6, 16, v160
    v_and_b32 v7, 0xffff0000, v160
    v_pk_add_f32 v[8:9], v[8:9], v[6:7]
    v_lshlrev_b32 v6, 16, v161
    v_and_b32 v7, 0xffff0000, v161
    v_pk_add_f32 v[10:11], v[10:11], v[6:7]
    v_lshlrev_b32 v6, 16, v162
    v_and_b32 v7, 0xffff0000, v162
    v_pk_add_f32 v[16:17], v[16:17], v[6:7]
    v_lshlrev_b32 v6, 16, v163
    v_and_b32 v7, 0xffff0000, v163
    v_pk_add_f32 v[18:19], v[18:19], v[6:7]
    v_lshlrev_b32 v6, 16, v164
    v_and_b32 v7, 0xffff0000, v164
    v_pk_add_f32 v[12:13], v[12:13], v[6:7]
    v_lshlrev_b32 v6, 16, v165
    v_and_b32 v7, 0xffff0000, v165
    v_pk_add_f32 v[14:15], v[14:15], v[6:7]
    v_lshlrev_b32 v6, 16, v166
    v_and_b32 v7, 0xffff0000, v166
    v_pk_add_f32 v[20:21], v[20:21], v[6:7]
    v_lshlrev_b32 v6, 16, v167
    v_and_b32 v7, 0xffff0000, v167
    v_pk_add_f32 v[22:23], v[22:23], v[6:7]
    v_cvt_pk_bf16_f32 v32, v8, v9
    v_cvt_pk_bf16_f32 v33, v10, v11
    v_cvt_pk_bf16_f32 v34, v12, v13
    v_cvt_pk_bf16_f32 v35, v14, v15
    v_cvt_pk_bf16_f32 v36, v16, v17
    v_cvt_pk_bf16_f32 v37, v18, v19
    v_cvt_pk_bf16_f32 v38, v20, v21
    v_cvt_pk_bf16_f32 v39, v22, v23
    s_add_u32 s24, s41, 196608
    v_permlane32_swap_b32 v32, v34
    v_permlane32_swap_b32 v33, v35
    buffer_store_dwordx4 v[32:35], v5, s[44:47], s24 offen offset:64
    v_permlane32_swap_b32 v36, v38
    v_permlane32_swap_b32 v37, v39
    buffer_store_dwordx4 v[36:39], v5, s[44:47], s24 offen offset:96
    v_and_b32 v47, 63, v0
    s_branch mk_fetch
mk_stream:
    s_lshl_b32 s31, s80, 2
    s_add_u32 s31, s31, s34
    v_and_b32 v47, 63, v0
    s_mov_b32 s8, s92
    s_and_b32 s9, s93, 0xffff
    s_mov_b32 s10, 8388608
    s_mov_b32 s11, 0x00020000
    s_mov_b32 s12, s84
    s_and_b32 s13, s85, 0xffff
    s_mov_b32 s14, 4194304
    s_mov_b32 s15, 0x00020000
    s_mov_b32 s44, s100
    s_and_b32 s45, s101, 0xffff
    s_mov_b32 s46, 4194304
    s_mov_b32 s47, 0x00020000
    v_mov_b32 v1, v47
    v_lshrrev_b32 v2, 2, v1
    v_lshlrev_b32 v2, 11, v2
    v_and_b32 v3, 3, v1
    v_lshl_add_u32 v2, v3, 4, v2
    s_lshl_b32 s16, s20, 20
    s_lshl_b32 s17, s31, 6
    s_add_u32 s16, s16, s17
    s_lshl_b32 s21, s20, 14
    v_bfe_u32 v4, v1, 2, 2
    v_lshrrev_b32 v5, 5, v1
    v_lshl_add_u32 v4, v5, 2, v4
    v_lshlrev_b32 v4, 6, v4
    v_bfe_u32 v5, v1, 4, 1
    v_lshl_add_u32 v4, v5, 5, v4
    v_lshl_add_u32 v4, v3, 3, v4
    v_add_u32 v4, s21, v4
    s_add_u32 m0, s21, 0
    s_add_u32 s17, s16, 0
    buffer_load_dwordx4 v2, s[8:11], s17 offen lds
    s_add_u32 m0, s21, 1024
    s_add_u32 s17, s16, 32768
    buffer_load_dwordx4 v2, s[8:11], s17 offen lds
    s_add_u32 m0, s21, 2048
    s_add_u32 s17, s16, 65536
    buffer_load_dwordx4 v2, s[8:11], s17 offen lds
    s_add_u32 m0, s21, 3072
    s_add_u32 s17, s16, 98304
    buffer_load_dwordx4 v2, s[8:11], s17 offen lds
    s_add_u32 m0, s21, 4096
    s_add_u32 s17, s16, 131072
    buffer_load_dwordx4 v2, s[8:11], s17 offen lds
    s_add_u32 m0, s21, 5120
    s_add_u32 s17, s16, 163840
    buffer_load_dwordx4 v2, s[8:11], s17 offen lds
    s_add_u32 m0, s21, 6144
    s_add_u32 s17, s16, 196608
    buffer_load_dwordx4 v2, s[8:11], s17 offen lds
    s_add_u32 m0, s21, 7168
    s_add_u32 s17, s16, 229376
    buffer_load_dwordx4 v2, s[8:11], s17 offen lds
    s_add_u32 m0, s21, 8192
    s_add_u32 s17, s16, 262144
    buffer_load_dwordx4 v2, s[8:11], s17 offen lds
    s_add_u32 m0, s21, 9216
    s_add_u32 s17, s16, 294912
    buffer_load_dwordx4 v2, s[8:11], s17 offen lds
    s_add_u32 m0, s21, 10240
    s_add_u32 s17, s16, 327680
    buffer_load_dwordx4 v2, s[8:11], s17 offen lds
    s_add_u32 m0, s21, 11264
    s_add_u32 s17, s16, 360448
    buffer_load_dwordx4 v2, s[8:11], s17 offen lds
    s_add_u32 m0, s21, 12288
    s_add_u32 s17, s16, 393216
    buffer_load_dwordx4 v2, s[8:11], s17 offen lds
    s_add_u32 m0, s21, 13312
    s_add_u32 s17, s16, 425984
    buffer_load_dwordx4 v2, s[8:11], s17 offen lds
    s_add_u32 m0, s21, 14336
    s_add_u32 s17, s16, 458752
    buffer_load_dwordx4 v2, s[8:11], s17 offen lds
    s_add_u32 m0, s21, 15360
    s_add_u32 s17, s16, 491520
    buffer_load_dwordx4 v2, s[8:11], s17 offen lds
    s_add_u32 s17, s16, 524288
    buffer_load_dwordx4 v[64:67], v2, s[8:11], s17 offen
    s_add_u32 s17, s16, 557056
    buffer_load_dwordx4 v[68:71], v2, s[8:11], s17 offen
    s_add_u32 s17, s16, 589824
    buffer_load_dwordx4 v[72:75], v2, s[8:11], s17 offen
    s_add_u32 s17, s16, 622592
    buffer_load_dwordx4 v[76:79], v2, s[8:11], s17 offen
    s_add_u32 s17, s16, 655360
    buffer_load_dwordx4 v[80:83], v2, s[8:11], s17 offen
    s_add_u32 s17, s16, 688128
    buffer_load_dwordx4 v[84:87], v2, s[8:11], s17 offen
    s_add_u32 s17, s16, 720896
    buffer_load_dwordx4 v[88:91], v2, s[8:11], s17 offen
    s_add_u32 s17, s16, 753664
    buffer_load_dwordx4 v[92:95], v2, s[8:11], s17 offen
    s_add_u32 s17, s16, 786432
    buffer_load_dwordx4 v[96:99], v2, s[8:11], s17 offen
    s_add_u32 s17, s16, 819200
    buffer_load_dwordx4 v[100:103], v2, s[8:11], s17 offen
    s_add_u32 s17, s16, 851968
    buffer_load_dwordx4 v[104:107], v2, s[8:11], s17 offen
    s_add_u32 s17, s16, 884736
    buffer_load_dwordx4 v[108:111], v2, s[8:11], s17 offen
    s_add_u32 s17, s16, 917504
    buffer_load_dwordx4 v[112:115], v2, s[8:11], s17 offen
    s_add_u32 s17, s16, 950272
    buffer_load_dwordx4 v[116:119], v2, s[8:11], s17 offen
    s_add_u32 s17, s16, 983040
    buffer_load_dwordx4 v[120:123], v2, s[8:11], s17 offen
    s_add_u32 s17, s16, 1015808
    buffer_load_dwordx4 v[124:127], v2, s[8:11], s17 offen
    v_lshlrev_b32 v5, 4, v1
    v_add_u32 v5, s21, v5
    s_waitcnt vmcnt(16)
    ds_read_b64_tr_b16 v[128:129], v4 offset:0
    ds_read_b64_tr_b16 v[130:131], v4 offset:1024
    ds_read_b64_tr_b16 v[132:133], v4 offset:512
    ds_read_b64_tr_b16 v[134:135], v4 offset:1536
    ds_read_b64_tr_b16 v[136:137], v4 offset:2048
    ds_read_b64_tr_b16 v[138:139], v4 offset:3072
    ds_read_b64_tr_b16 v[140:141], v4 offset:2560
    ds_read_b64_tr_b16 v[142:143], v4 offset:3584
    ds_read_b64_tr_b16 v[144:145], v4 offset:4096
    ds_read_b64_tr_b16 v[146:147], v4 offset:5120
    ds_read_b64_tr_b16 v[148:149], v4 offset:4608
    ds_read_b64_tr_b16 v[150:151], v4 offset:5632
    ds_read_b64_tr_b16 v[152:153], v4 offset:6144
    ds_read_b64_tr_b16 v[154:155], v4 offset:7168
    ds_read_b64_tr_b16 v[156:157], v4 offset:6656
    ds_read_b64_tr_b16 v[158:159], v4 offset:7680
    ds_read_b64_tr_b16 v[160:161], v4 offset:8192
    ds_read_b64_tr_b16 v[162:163], v4 offset:9216
    ds_read_b64_tr_b16 v[164:165], v4 offset:8704
    ds_read_b64_tr_b16 v[166:167], v4 offset:9728
    ds_read_b64_tr_b16 v[168:169], v4 offset:10240
    ds_read_b64_tr_b16 v[170:171], v4 offset:11264
    ds_read_b64_tr_b16 v[172:173], v4 offset:10752
    ds_read_b64_tr_b16 v[174:175], v4 offset:11776
    ds_read_b64_tr_b16 v[176:177], v4 offset:12288
    ds_read_b64_tr_b16 v[178:179], v4 offset:13312
    ds_read_b64_tr_b16 v[180:181], v4 offset:12800
    ds_read_b64_tr_b16 v[182:183], v4 offset:13824
    ds_read_b64_tr_b16 v[184:185], v4 offset:14336
    ds_read_b64_tr_b16 v[186:187], v4 offset:15360
    ds_read_b64_tr_b16 v[188:189], v4 offset:14848
    ds_read_b64_tr_b16 v[190:191], v4 offset:15872
    s_waitcnt lgkmcnt(0)
    s_waitcnt vmcnt(0)
    ds_write_b128 v5, v[64:67] offset:0
    ds_write_b128 v5, v[68:71] offset:1024
    ds_write_b128 v5, v[72:75] offset:2048
    ds_write_b128 v5, v[76:79] offset:3072
    ds_write_b128 v5, v[80:83] offset:4096
    ds_write_b128 v5, v[84:87] offset:5120
    ds_write_b128 v5, v[88:91] offset:6144
    ds_write_b128 v5, v[92:95] offset:7168
    ds_write_b128 v5, v[96:99] offset:8192
    ds_write_b128 v5, v[100:103] offset:9216
    ds_write_b128 v5, v[104:107] offset:10240
    ds_write_b128 v5, v[108:111] offset:11264
    ds_write_b128 v5, v[112:115] offset:12288
    ds_write_b128 v5, v[116:119] offset:13312
    ds_write_b128 v5, v[120:123] offset:14336
    ds_write_b128 v5, v[124:127] offset:15360
    s_waitcnt lgkmcnt(0)
    ds_read_b64_tr_b16 v[192:193], v4 offset:0
    ds_read_b64_tr_b16 v[194:195], v4 offset:1024
    ds_read_b64_tr_b16 v[196:197], v4 offset:512
    ds_read_b64_tr_b16 v[198:199], v4 offset:1536
    ds_read_b64_tr_b16 v[200:201], v4 offset:2048
    ds_read_b64_tr_b16 v[202:203], v4 offset:3072
    ds_read_b64_tr_b16 v[204:205], v4 offset:2560
    ds_read_b64_tr_b16 v[206:207], v4 offset:3584
    ds_read_b64_tr_b16 v[208:209], v4 offset:4096
    ds_read_b64_tr_b16 v[210:211], v4 offset:5120
    ds_read_b64_tr_b16 v[212:213], v4 offset:4608
    ds_read_b64_tr_b16 v[214:215], v4 offset:5632
    ds_read_b64_tr_b16 v[216:217], v4 offset:6144
    ds_read_b64_tr_b16 v[218:219], v4 offset:7168
    ds_read_b64_tr_b16 v[220:221], v4 offset:6656
    ds_read_b64_tr_b16 v[222:223], v4 offset:7680
    ds_read_b64_tr_b16 v[224:225], v4 offset:8192
    ds_read_b64_tr_b16 v[226:227], v4 offset:9216
    ds_read_b64_tr_b16 v[228:229], v4 offset:8704
    ds_read_b64_tr_b16 v[230:231], v4 offset:9728
    ds_read_b64_tr_b16 v[232:233], v4 offset:10240
    ds_read_b64_tr_b16 v[234:235], v4 offset:11264
    ds_read_b64_tr_b16 v[236:237], v4 offset:10752
    ds_read_b64_tr_b16 v[238:239], v4 offset:11776
    ds_read_b64_tr_b16 v[240:241], v4 offset:12288
    ds_read_b64_tr_b16 v[242:243], v4 offset:13312
    ds_read_b64_tr_b16 v[244:245], v4 offset:12800
    ds_read_b64_tr_b16 v[246:247], v4 offset:13824
    ds_read_b64_tr_b16 v[248:249], v4 offset:14336
    ds_read_b64_tr_b16 v[250:251], v4 offset:15360
    ds_read_b64_tr_b16 v[252:253], v4 offset:14848
    ds_read_b64_tr_b16 v[254:255], v4 offset:15872
    s_waitcnt lgkmcnt(0)
    v_lshlrev_b32 v2, 4, v1
    v_mov_b32 v3, 0
    s_lshl_b32 s21, s20, 12
    v_add_u32 v4, s21, v2
    v_lshrrev_b32 v6, 4, v0
    v_bfe_u32 v7, v0, 2, 2
    v_lshlrev_b32 v5, 10, v7
    v_bfe_u32 v7, v0, 1, 1
    v_lshl_add_u32 v5, v7, 9, v5
    v_lshl_add_u32 v5, v6, 4, v5
    v_and_b32 v7, 1, v0
    v_lshl_add_u32 v5, v7, 3, v5
    v_and_b32 v7, 15, v0
    v_lshlrev_b32 v6, 11, v6
    v_lshl_add_u32 v6, v7, 2, v6
    v_bfe_u32 v7, v0, 1, 2
    v_lshlrev_b32 v7, 9, v7
    v_and_b32 v8, 0x1f8, v0
    v_add_u32 v7, v7, v8
    v_and_b32 v8, 1, v0
    v_lshl_add_u32 v7, v8, 2, v7
    s_barrier
    v_min_u32 v14, 1, v1
    v_lshlrev_b32 v14, 30, v14
    v_mov_b32 v15, 0x8000
    s_lshl_b32 s42, s31, 7
    s_add_u32 s42, s42, 167870464
    v_mov_b32 v43, 1
    s_cmp_lg_u32 s20, 0
    s_cbranch_scc1 mk_st
    buffer_atomic_add v43, v14, s[4:7], s42 offen sc0 sc1
    s_waitcnt vmcnt(0)
    v_readfirstlane_b32 s43, v43
mk_st:
    s_cmp_lg_u32 s20, 0
    s_cbranch_scc1 mk_stw
    s_add_u32 s30, s43, 40
    v_mov_b32 v8, s30
    ds_write_b32 v15, v8
    s_cmp_ge_u32 s30, 65
    s_cbranch_scc1 mk_stw
    s_min_u32 s30, s30, 63
    s_lshr_b32 s40, s30, 3
    s_lshl_b32 s40, s40, 2
    s_lshr_b32 s41, s31, 3
    s_add_u32 s40, s40, s41
    s_lshl_b32 s40, s40, 7
    s_add_u32 s40, s40, 49152
    s_lshl_b32 s41, s30, 7
    s_add_u32 s41, s41, 73728
    v_mov_b32 v9, s40
    v_mov_b32 v10, s41
    v_and_b32 v11, 1, v1
    v_cmp_eq_u32 vcc, 1, v11
    s_nop 1
    v_cndmask_b32 v9, v9, v10, vcc
    s_mov_b32 s40, 167772160
wf_54:
    buffer_load_dword v8, v9, s[4:7], s40 offen sc1
    s_waitcnt vmcnt(0)
    v_cmp_gt_u32 vcc, 4, v8
    s_cbranch_vccz wfo_55
    s_sleep 4
    s_sub_u32 s78, s78, 1
    s_cbranch_scc0 wf_54
    s_mov_b32 s78, 0
wfo_55:
mk_stw:
    s_waitcnt lgkmcnt(0)
    s_barrier
    ds_read_b32 v8, v15
    s_waitcnt lgkmcnt(0)
    v_readfirstlane_b32 s30, v8
    s_cmp_lt_u32 s30, 65
    s_cbranch_scc1 mk_stg
    s_endpgm
mk_stg:
    s_mov_b32 s39, s30
    s_min_u32 s30, s30, 63
    s_mul_i32 s16, s30, 491520
    s_lshl_b32 s17, s20, 15
    s_add_u32 s16, s16, s17
    s_add_u32 s16, s16, 54755328
    s_lshl_b32 s36, s30, 16
    s_lshl_b32 s17, s31, 6
    s_add_u32 s36, s36, s17
    s_lshl_b32 s38, s30, 16
    s_lshl_b32 s17, s31, 11
    s_add_u32 s38, s38, s17
    s_cmp_ge_u32 s39, 63
    s_cbranch_scc1 mk_sth
    s_add_u32 s17, s16, 0
    buffer_load_dwordx4 v[16:19], v2, s[4:7], s17 offen offset:0 sc1
    buffer_load_dwordx4 v[20:23], v2, s[4:7], s17 offen offset:1024 sc1
    buffer_load_dwordx4 v[24:27], v2, s[4:7], s17 offen offset:2048 sc1
    buffer_load_dwordx4 v[28:31], v2, s[4:7], s17 offen offset:3072 sc1
    s_add_u32 s17, s16, 4096
    buffer_load_dwordx4 v[32:35], v2, s[4:7], s17 offen offset:0 sc1
    buffer_load_dwordx4 v[36:39], v2, s[4:7], s17 offen offset:1024 sc1
    buffer_load_dwordx4 v[40:43], v2, s[4:7], s17 offen offset:2048 sc1
    buffer_load_dwordx4 v[44:47], v2, s[4:7], s17 offen offset:3072 sc1
    s_add_u32 s17, s16, 8192
    buffer_load_dwordx4 v[48:51], v2, s[4:7], s17 offen offset:0 sc1
    buffer_load_dwordx4 v[52:55], v2, s[4:7], s17 offen offset:1024 sc1
    buffer_load_dwordx4 v[56:59], v2, s[4:7], s17 offen offset:2048 sc1
    buffer_load_dwordx4 v[60:63], v2, s[4:7], s17 offen offset:3072 sc1
    s_add_u32 s17, s16, 12288
    buffer_load_dwordx4 v[64:67], v2, s[4:7], s17 offen offset:0 sc1
    buffer_load_dwordx4 v[68:71], v2, s[4:7], s17 offen offset:1024 sc1
    buffer_load_dwordx4 v[72:75], v2, s[4:7], s17 offen offset:2048 sc1
    buffer_load_dwordx4 v[76:79], v2, s[4:7], s17 offen offset:3072 sc1
    s_add_u32 s17, s16, 16384
    buffer_load_dwordx4 v[80:83], v2, s[4:7], s17 offen offset:0 sc1
    buffer_load_dwordx4 v[84:87], v2, s[4:7], s17 offen offset:1024 sc1
    buffer_load_dwordx4 v[88:91], v2, s[4:7], s17 offen offset:2048 sc1
    buffer_load_dwordx4 v[92:95], v2, s[4:7], s17 offen offset:3072 sc1
    s_add_u32 s17, s16, 20480
    buffer_load_dwordx4 v[96:99], v2, s[4:7], s17 offen offset:0 sc1
    buffer_load_dwordx4 v[100:103], v2, s[4:7], s17 offen offset:1024 sc1
    buffer_load_dwordx4 v[104:107], v2, s[4:7], s17 offen offset:2048 sc1
    buffer_load_dwordx4 v[108:111], v2, s[4:7], s17 offen offset:3072 sc1
    s_waitcnt vmcnt(23)
    v_mfma_f32_32x32x16_bf16 v[112:127], v[128:131], v[16:19], 0
    s_add_u32 s17, s16, 24576
    buffer_load_dwordx4 v[16:19], v2, s[4:7], s17 offen offset:0 sc1
    s_waitcnt vmcnt(23)
    v_mfma_f32_32x32x16_bf16 v[112:127], v[132:135], v[20:23], v[112:127]
    buffer_load_dwordx4 v[20:23], v2, s[4:7], s17 offen offset:1024 sc1
    s_waitcnt vmcnt(23)
    v_mfma_f32_32x32x16_bf16 v[112:127], v[136:139], v[24:27], v[112:127]
    buffer_load_dwordx4 v[24:27], v2, s[4:7], s17 offen offset:2048 sc1
    s_waitcnt vmcnt(23)
    v_mfma_f32_32x32x16_bf16 v[112:127], v[140:143], v[28:31], v[112:127]
    buffer_load_dwordx4 v[28:31], v2, s[4:7], s17 offen offset:3072 sc1
    s_waitcnt vmcnt(23)
    v_mfma_f32_32x32x16_bf16 v[112:127], v[144:147], v[32:35], v[112:127]
    s_add_u32 s17, s16, 28672
    buffer_load_dwordx4 v[32:35], v2, s[4:7], s17 offen offset:0 sc1
    s_waitcnt vmcnt(23)
    v_mfma_f32_32x32x16_bf16 v[112:127], v[148:151], v[36:39], v[112:127]
    buffer_load_dwordx4 v[36:39], v2, s[4:7], s17 offen offset:1024 sc1
    s_waitcnt vmcnt(23)
    v_mfma_f32_32x32x16_bf16 v[112:127], v[152:155], v[40:43], v[112:127]
    buffer_load_dwordx4 v[40:43], v2, s[4:7], s17 offen offset:2048 sc1
    s_waitcnt vmcnt(23)
    v_mfma_f32_32x32x16_bf16 v[112:127], v[156:159], v[44:47], v[112:127]
    buffer_load_dwordx4 v[44:47], v2, s[4:7], s17 offen offset:3072 sc1
    s_cmp_lg_u32 s20, 0
    s_cbranch_scc1 stt_56
    v_mov_b32 v3, 1
    buffer_atomic_add v3, v14, s[4:7], s42 offen sc0 sc1
stt_56:
    buffer_load_dword v8, v6, s[44:47], s36 offen
    s_add_u32 s17, s38, 150994944
    buffer_load_dword v9, v7, s[4:7], s17 offen sc1
    s_add_u32 s17, s38, 155189248
    buffer_load_dword v10, v7, s[4:7], s17 offen sc1
    s_add_u32 s17, s38, 159383552
    buffer_load_dword v11, v7, s[4:7], s17 offen sc1
    s_add_u32 s17, s38, 163577856
    buffer_load_dword v12, v7, s[4:7], s17 offen sc1
    s_waitcnt vmcnt(28)
    v_mfma_f32_32x32x16_bf16 v[112:127], v[160:163], v[48:51], v[112:127]
    s_waitcnt vmcnt(27)
    v_mfma_f32_32x32x16_bf16 v[112:127], v[164:167], v[52:55], v[112:127]
    s_waitcnt vmcnt(26)
    v_mfma_f32_32x32x16_bf16 v[112:127], v[168:171], v[56:59], v[112:127]
    s_waitcnt vmcnt(25)
    v_mfma_f32_32x32x16_bf16 v[112:127], v[172:175], v[60:63], v[112:127]
    s_waitcnt vmcnt(24)
    v_mfma_f32_32x32x16_bf16 v[112:127], v[176:179], v[64:67], v[112:127]
    s_waitcnt vmcnt(23)
    v_mfma_f32_32x32x16_bf16 v[112:127], v[180:183], v[68:71], v[112:127]
    s_waitcnt vmcnt(22)
    v_mfma_f32_32x32x16_bf16 v[112:127], v[184:187], v[72:75], v[112:127]
    s_waitcnt vmcnt(21)
    v_mfma_f32_32x32x16_bf16 v[112:127], v[188:191], v[76:79], v[112:127]
    s_waitcnt vmcnt(20)
    v_mfma_f32_32x32x16_bf16 v[112:127], v[192:195], v[80:83], v[112:127]
    s_waitcnt vmcnt(19)
    v_mfma_f32_32x32x16_bf16 v[112:127], v[196:199], v[84:87], v[112:127]
    s_waitcnt vmcnt(18)
    v_mfma_f32_32x32x16_bf16 v[112:127], v[200:203], v[88:91], v[112:127]
    s_waitcnt vmcnt(17)
    v_mfma_f32_32x32x16_bf16 v[112:127], v[204:207], v[92:95], v[112:127]
    s_waitcnt vmcnt(16)
    v_mfma_f32_32x32x16_bf16 v[112:127], v[208:211], v[96:99], v[112:127]
    s_waitcnt vmcnt(15)
    v_mfma_f32_32x32x16_bf16 v[112:127], v[212:215], v[100:103], v[112:127]
    s_waitcnt vmcnt(14)
    v_mfma_f32_32x32x16_bf16 v[112:127], v[216:219], v[104:107], v[112:127]
    s_waitcnt vmcnt(13)
    v_mfma_f32_32x32x16_bf16 v[112:127], v[220:223], v[108:111], v[112:127]
    s_waitcnt vmcnt(12)
    v_mfma_f32_32x32x16_bf16 v[112:127], v[224:227], v[16:19], v[112:127]
    s_waitcnt vmcnt(11)
    v_mfma_f32_32x32x16_bf16 v[112:127], v[228:231], v[20:23], v[112:127]
    s_waitcnt vmcnt(10)
    v_mfma_f32_32x32x16_bf16 v[112:127], v[232:235], v[24:27], v[112:127]
    s_waitcnt vmcnt(9)
    v_mfma_f32_32x32x16_bf16 v[112:127], v[236:239], v[28:31], v[112:127]
    s_waitcnt vmcnt(8)
    v_mfma_f32_32x32x16_bf16 v[112:127], v[240:243], v[32:35], v[112:127]
    s_waitcnt vmcnt(7)
    v_mfma_f32_32x32x16_bf16 v[112:127], v[244:247], v[36:39], v[112:127]
    s_waitcnt vmcnt(6)
    v_mfma_f32_32x32x16_bf16 v[112:127], v[248:251], v[40:43], v[112:127]
    s_waitcnt vmcnt(5)
    v_mfma_f32_32x32x16_bf16 v[112:127], v[252:255], v[44:47], v[112:127]
    s_nop 11
    ds_write_b128 v4, v[112:115] offset:0
    ds_write_b128 v4, v[116:119] offset:1024
    ds_write_b128 v4, v[120:123] offset:2048
    ds_write_b128 v4, v[124:127] offset:3072
    s_waitcnt vmcnt(0) lgkmcnt(0)
    s_barrier
    ds_read_b64 v[16:17], v5 offset:0
    ds_read_b64 v[18:19], v5 offset:4096
    ds_read_b64 v[20:21], v5 offset:8192
    ds_read_b64 v[22:23], v5 offset:12288
    ds_read_b64 v[24:25], v5 offset:16384
    ds_read_b64 v[26:27], v5 offset:20480
    ds_read_b64 v[28:29], v5 offset:24576
    ds_read_b64 v[30:31], v5 offset:28672
    v_lshlrev_b32 v32, 16, v8
    v_and_b32 v33, 0xffff0000, v8
    v_lshlrev_b32 v34, 16, v9
    v_and_b32 v35, 0xffff0000, v9
    v_lshlrev_b32 v36, 16, v10
    v_and_b32 v37, 0xffff0000, v10
    v_lshlrev_b32 v38, 16, v11
    v_and_b32 v39, 0xffff0000, v11
    v_lshlrev_b32 v40, 16, v12
    v_and_b32 v41, 0xffff0000, v12
    v_pk_add_f32 v[32:33], v[32:33], v[34:35]
    v_pk_add_f32 v[32:33], v[32:33], v[36:37]
    v_pk_add_f32 v[32:33], v[32:33], v[38:39]
    v_pk_add_f32 v[32:33], v[32:33], v[40:41]
    s_waitcnt lgkmcnt(7)
    v_pk_add_f32 v[32:33], v[32:33], v[16:17]
    s_waitcnt lgkmcnt(6)
    v_pk_add_f32 v[32:33], v[32:33], v[18:19]
    s_waitcnt lgkmcnt(5)
    v_pk_add_f32 v[32:33], v[32:33], v[20:21]
    s_waitcnt lgkmcnt(4)
    v_pk_add_f32 v[32:33], v[32:33], v[22:23]
    s_waitcnt lgkmcnt(3)
    v_pk_add_f32 v[32:33], v[32:33], v[24:25]
    s_waitcnt lgkmcnt(2)
    v_pk_add_f32 v[32:33], v[32:33], v[26:27]
    s_waitcnt lgkmcnt(1)
    v_pk_add_f32 v[32:33], v[32:33], v[28:29]
    s_waitcnt lgkmcnt(0)
    v_pk_add_f32 v[32:33], v[32:33], v[30:31]
    v_cvt_pk_bf16_f32 v13, v32, v33
    v_readfirstlane_b32 s43, v3
    buffer_store_dword v13, v6, s[12:15], s36 offen
    s_branch mk_st
mk_sth:
    s_sub_u32 s39, s39, 63
    v_bfe_u32 v80, v1, 4, 1
    v_lshlrev_b32 v81, 10, v80
    v_lshrrev_b32 v82, 5, v1
    v_lshl_add_u32 v81, v82, 9, v81
    v_and_b32 v82, 15, v1
    v_lshl_add_u32 v81, v82, 4, v81
    s_lshl_b32 s17, s39, 8
    s_add_u32 s16, s16, s17
    s_add_u32 s17, s16, 0
    buffer_load_dwordx4 v[16:19], v81, s[4:7], s17 offen offset:0 sc1
    buffer_load_dwordx4 v[20:23], v81, s[4:7], s17 offen offset:2048 sc1
    s_add_u32 s17, s16, 4096
    buffer_load_dwordx4 v[24:27], v81, s[4:7], s17 offen offset:0 sc1
    buffer_load_dwordx4 v[28:31], v81, s[4:7], s17 offen offset:2048 sc1
    s_add_u32 s17, s16, 8192
    buffer_load_dwordx4 v[32:35], v81, s[4:7], s17 offen offset:0 sc1
    buffer_load_dwordx4 v[36:39], v81, s[4:7], s17 offen offset:2048 sc1
    s_add_u32 s17, s16, 12288
    buffer_load_dwordx4 v[40:43], v81, s[4:7], s17 offen offset:0 sc1
    buffer_load_dwordx4 v[44:47], v81, s[4:7], s17 offen offset:2048 sc1
    s_add_u32 s17, s16, 16384
    buffer_load_dwordx4 v[48:51], v81, s[4:7], s17 offen offset:0 sc1
    buffer_load_dwordx4 v[52:55], v81, s[4:7], s17 offen offset:2048 sc1
    s_add_u32 s17, s16, 20480
    buffer_load_dwordx4 v[56:59], v81, s[4:7], s17 offen offset:0 sc1
    buffer_load_dwordx4 v[60:63], v81, s[4:7], s17 offen offset:2048 sc1
    s_add_u32 s17, s16, 24576
    buffer_load_dwordx4 v[64:67], v81, s[4:7], s17 offen offset:0 sc1
    buffer_load_dwordx4 v[68:71], v81, s[4:7], s17 offen offset:2048 sc1
    s_add_u32 s17, s16, 28672
    buffer_load_dwordx4 v[72:75], v81, s[4:7], s17 offen offset:0 sc1
    buffer_load_dwordx4 v[76:79], v81, s[4:7], s17 offen offset:2048 sc1
    s_cmp_lg_u32 s20, 0
    s_cbranch_scc1 stt_57
    v_mov_b32 v3, 1
    buffer_atomic_add v3, v14, s[4:7], s42 offen sc0 sc1
stt_57:
    buffer_load_dword v8, v6, s[44:47], s36 offen
    s_add_u32 s17, s38, 150994944
    buffer_load_dword v9, v7, s[4:7], s17 offen sc1
    s_add_u32 s17, s38, 155189248
    buffer_load_dword v10, v7, s[4:7], s17 offen sc1
    s_add_u32 s17, s38, 159383552
    buffer_load_dword v11, v7, s[4:7], s17 offen sc1
    s_add_u32 s17, s38, 163577856
    buffer_load_dword v12, v7, s[4:7], s17 offen sc1
    v_cmp_eq_u32 vcc, 1, v80
    s_waitcnt vmcnt(20)
    v_mfma_f32_32x32x16_bf16 v[112:127], v[128:131], v[16:19], 0
    v_mfma_f32_32x32x16_bf16 v[96:111], v[132:135], v[16:19], 0
    s_waitcnt vmcnt(19)
    v_mfma_f32_32x32x16_bf16 v[112:127], v[136:139], v[20:23], v[112:127]
    v_mfma_f32_32x32x16_bf16 v[96:111], v[140:143], v[20:23], v[96:111]
    s_waitcnt vmcnt(18)
    v_mfma_f32_32x32x16_bf16 v[112:127], v[144:147], v[24:27], v[112:127]
    v_mfma_f32_32x32x16_bf16 v[96:111], v[148:151], v[24:27], v[96:111]
    s_waitcnt vmcnt(17)
    v_mfma_f32_32x32x16_bf16 v[112:127], v[152:155], v[28:31], v[112:127]
    v_mfma_f32_32x32x16_bf16 v[96:111], v[156:159], v[28:31], v[96:111]
    s_waitcnt vmcnt(16)
    v_mfma_f32_32x32x16_bf16 v[112:127], v[160:163], v[32:35], v[112:127]
    v_mfma_f32_32x32x16_bf16 v[96:111], v[164:167], v[32:35], v[96:111]
    s_waitcnt vmcnt(15)
    v_mfma_f32_32x32x16_bf16 v[112:127], v[168:171], v[36:39], v[112:127]
    v_mfma_f32_32x32x16_bf16 v[96:111], v[172:175], v[36:39], v[96:111]
    s_waitcnt vmcnt(14)
    v_mfma_f32_32x32x16_bf16 v[112:127], v[176:179], v[40:43], v[112:127]
    v_mfma_f32_32x32x16_bf16 v[96:111], v[180:183], v[40:43], v[96:111]
    s_waitcnt vmcnt(13)
    v_mfma_f32_32x32x16_bf16 v[112:127], v[184:187], v[44:47], v[112:127]
    v_mfma_f32_32x32x16_bf16 v[96:111], v[188:191], v[44:47], v[96:111]
    s_waitcnt vmcnt(12)
    v_mfma_f32_32x32x16_bf16 v[112:127], v[192:195], v[48:51], v[112:127]
    v_mfma_f32_32x32x16_bf16 v[96:111], v[196:199], v[48:51], v[96:111]
    s_waitcnt vmcnt(11)
    v_mfma_f32_32x32x16_bf16 v[112:127], v[200:203], v[52:55], v[112:127]
    v_mfma_f32_32x32x16_bf16 v[96:111], v[204:207], v[52:55], v[96:111]
    s_waitcnt vmcnt(10)
    v_mfma_f32_32x32x16_bf16 v[112:127], v[208:211], v[56:59], v[112:127]
    v_mfma_f32_32x32x16_bf16 v[96:111], v[212:215], v[56:59], v[96:111]
    s_waitcnt vmcnt(9)
    v_mfma_f32_32x32x16_bf16 v[112:127], v[216:219], v[60:63], v[112:127]
    v_mfma_f32_32x32x16_bf16 v[96:111], v[220:223], v[60:63], v[96:111]
    s_waitcnt vmcnt(8)
    v_mfma_f32_32x32x16_bf16 v[112:127], v[224:227], v[64:67], v[112:127]
    v_mfma_f32_32x32x16_bf16 v[96:111], v[228:231], v[64:67], v[96:111]
    s_waitcnt vmcnt(7)
    v_mfma_f32_32x32x16_bf16 v[112:127], v[232:235], v[68:71], v[112:127]
    v_mfma_f32_32x32x16_bf16 v[96:111], v[236:239], v[68:71], v[96:111]
    s_waitcnt vmcnt(6)
    v_mfma_f32_32x32x16_bf16 v[112:127], v[240:243], v[72:75], v[112:127]
    v_mfma_f32_32x32x16_bf16 v[96:111], v[244:247], v[72:75], v[96:111]
    s_waitcnt vmcnt(5)
    v_mfma_f32_32x32x16_bf16 v[112:127], v[248:251], v[76:79], v[112:127]
    v_mfma_f32_32x32x16_bf16 v[96:111], v[252:255], v[76:79], v[96:111]
    s_nop 11
    v_cndmask_b32 v112, v112, v96, vcc
    v_cndmask_b32 v113, v113, v97, vcc
    v_cndmask_b32 v114, v114, v98, vcc
    v_cndmask_b32 v115, v115, v99, vcc
    v_cndmask_b32 v116, v116, v100, vcc
    v_cndmask_b32 v117, v117, v101, vcc
    v_cndmask_b32 v118, v118, v102, vcc
    v_cndmask_b32 v119, v119, v103, vcc
    v_cndmask_b32 v120, v120, v104, vcc
    v_cndmask_b32 v121, v121, v105, vcc
    v_cndmask_b32 v122, v122, v106, vcc
    v_cndmask_b32 v123, v123, v107, vcc
    v_cndmask_b32 v124, v124, v108, vcc
    v_cndmask_b32 v125, v125, v109, vcc
    v_cndmask_b32 v126, v126, v110, vcc
    v_cndmask_b32 v127, v127, v111, vcc
    ds_write_b128 v4, v[112:115] offset:0
    ds_write_b128 v4, v[116:119] offset:1024
    ds_write_b128 v4, v[120:123] offset:2048
    ds_write_b128 v4, v[124:127] offset:3072
    s_waitcnt vmcnt(0) lgkmcnt(0)
    s_barrier
    v_readfirstlane_b32 s43, v3
    s_lshr_b32 s17, s20, 2
    s_cmp_lg_u32 s17, s39
    s_cbranch_scc1 mk_st
    v_and_b32 v81, 0xfffffeff, v5
    ds_read_b64 v[48:49], v81 offset:0
    ds_read_b64 v[50:51], v81 offset:256
    ds_read_b64 v[52:53], v81 offset:4096
    ds_read_b64 v[54:55], v81 offset:4352
    ds_read_b64 v[56:57], v81 offset:8192
    ds_read_b64 v[58:59], v81 offset:8448
    ds_read_b64 v[60:61], v81 offset:12288
    ds_read_b64 v[62:63], v81 offset:12544
    ds_read_b64 v[64:65], v81 offset:16384
    ds_read_b64 v[66:67], v81 offset:16640
    ds_read_b64 v[68:69], v81 offset:20480
    ds_read_b64 v[70:71], v81 offset:20736
    ds_read_b64 v[72:73], v81 offset:24576
    ds_read_b64 v[74:75], v81 offset:24832
    ds_read_b64 v[76:77], v81 offset:28672
    ds_read_b64 v[78:79], v81 offset:28928
    v_lshlrev_b32 v32, 16, v8
    v_and_b32 v33, 0xffff0000, v8
    v_lshlrev_b32 v34, 16, v9
    v_and_b32 v35, 0xffff0000, v9
    v_lshlrev_b32 v36, 16, v10
    v_and_b32 v37, 0xffff0000, v10
    v_lshlrev_b32 v38, 16, v11
    v_and_b32 v39, 0xffff0000, v11
    v_lshlrev_b32 v40, 16, v12
    v_and_b32 v41, 0xffff0000, v12
    v_pk_add_f32 v[32:33], v[32:33], v[34:35]
    v_pk_add_f32 v[32:33], v[32:33], v[36:37]
    v_pk_add_f32 v[32:33], v[32:33], v[38:39]
    v_pk_add_f32 v[32:33], v[32:33], v[40:41]
    s_waitcnt lgkmcnt(15)
    v_pk_add_f32 v[32:33], v[32:33], v[48:49]
    s_waitcnt lgkmcnt(14)
    v_pk_add_f32 v[32:33], v[32:33], v[50:51]
    s_waitcnt lgkmcnt(13)
    v_pk_add_f32 v[32:33], v[32:33], v[52:53]
    s_waitcnt lgkmcnt(12)
    v_pk_add_f32 v[32:33], v[32:33], v[54:55]
    s_waitcnt lgkmcnt(11)
    v_pk_add_f32 v[32:33], v[32:33], v[56:57]
    s_waitcnt lgkmcnt(10)
    v_pk_add_f32 v[32:33], v[32:33], v[58:59]
    s_waitcnt lgkmcnt(9)
    v_pk_add_f32 v[32:33], v[32:33], v[60:61]
    s_waitcnt lgkmcnt(8)
    v_pk_add_f32 v[32:33], v[32:33], v[62:63]
    s_waitcnt lgkmcnt(7)
    v_pk_add_f32 v[32:33], v[32:33], v[64:65]
    s_waitcnt lgkmcnt(6)
    v_pk_add_f32 v[32:33], v[32:33], v[66:67]
    s_waitcnt lgkmcnt(5)
    v_pk_add_f32 v[32:33], v[32:33], v[68:69]
    s_waitcnt lgkmcnt(4)
    v_pk_add_f32 v[32:33], v[32:33], v[70:71]
    s_waitcnt lgkmcnt(3)
    v_pk_add_f32 v[32:33], v[32:33], v[72:73]
    s_waitcnt lgkmcnt(2)
    v_pk_add_f32 v[32:33], v[32:33], v[74:75]
    s_waitcnt lgkmcnt(1)
    v_pk_add_f32 v[32:33], v[32:33], v[76:77]
    s_waitcnt lgkmcnt(0)
    v_pk_add_f32 v[32:33], v[32:33], v[78:79]
    v_cvt_pk_bf16_f32 v13, v32, v33
    buffer_store_dword v13, v6, s[12:15], s36 offen
    s_branch mk_st
mk_codeend:
.section .rodata,"a"
.p2align 6
.amdhsa_kernel parallel_sum__memory_aug_recurrent_mem_tr__dense_activation_mish__prompt_kernel
  .amdhsa_next_free_vgpr 256
  .amdhsa_next_free_sgpr 102
  .amdhsa_accum_offset 256
  .amdhsa_group_segment_fixed_size 0
  .amdhsa_kernarg_size 112
  .amdhsa_user_sgpr_count 2
  .amdhsa_user_sgpr_kernarg_segment_ptr 1
  .amdhsa_system_sgpr_workgroup_id_x 1
  .amdhsa_float_denorm_mode_32 3
.end_amdhsa_kernel
```
